```python
import torch

def _softmax(x, axis=-1):
    return torch.softmax(x, dim=axis)
def _gelu(x):
    return torch.nn.functional.gelu(x, approximate="tanh")
def _silu(x):
    return torch.nn.functional.silu(x)
def _sigmoid(x):
    return torch.sigmoid(x)
def _layernorm(x, axis=-1, eps=1e-5):
    m = x.mean(dim=axis, keepdim=True)
    v = x.var(dim=axis, keepdim=True, unbiased=False)
    return (x - m) / torch.sqrt(v + eps)
def _scatter_add(tgt, idx, src, axis=0):
    return tgt.clone().index_add_(axis, idx, src)
def _segment_sum(src, seg, n):
    out = torch.zeros((n,) + src.shape[1:], dtype=src.dtype)
    return out.index_add_(0, seg, src)
def _pad(x, pw):
    flat = tuple(v for pair in reversed(pw) for v in pair)
    return torch.nn.functional.pad(x, flat)

kernel_name = 'recurrent_scan__linear_kernel_hedgehog__mixer_token_mlp__prompt'

def setup_inputs():

    _w = (lambda a: (lambda t: t.to(torch.bfloat16) if t.is_floating_point() else t)(torch.as_tensor(a)))
    def _A_setup():
        B, S, D, H = 1, 2048, 512, 32
        Dh = D // H
        return {
            "x": _w((lambda *s: torch.randn(*s, dtype=torch.bfloat16) * 0.05)(B, S, D)),
            "wqkv": _w((lambda *s: torch.randn(*s, dtype=torch.bfloat16) * 0.4)(D, 3 * D)),
            "w_phi": _w((lambda *s: torch.randn(*s, dtype=torch.bfloat16) * 0.4)(H, Dh, Dh) * (Dh ** -0.5)),
            "wo": _w((lambda *s: torch.randn(*s, dtype=torch.bfloat16) * 0.2)(D, D)),
        }
    _A_in = _A_setup()

    def _B_setup():
        B, S, D, F = 1, 2048, 512, 1376
        return {
            "x": _w((lambda *s: torch.randn(*s, dtype=torch.bfloat16) * 0.05)(B, S, D)),
            "w1": _w((lambda *s: torch.randn(*s, dtype=torch.bfloat16) * 0.4)(S, F) * (S ** -0.5)),
            "b1": _w((lambda *s: torch.randn(*s, dtype=torch.bfloat16) * 3.2)(F) * 0.02),
            "w2": _w((lambda *s: torch.randn(*s, dtype=torch.bfloat16) * 0.4)(F, S) * (F ** -0.5)),
            "b2": _w((lambda *s: torch.randn(*s, dtype=torch.bfloat16) * 0.8)(S) * 0.02),
        }
    _B_in = _B_setup()

    return {
        "A_x": _A_in["x"],
        "A_wqkv": _A_in["wqkv"],
        "A_w_phi": _A_in["w_phi"],
        "A_wo": _A_in["wo"],
        "B_x": _B_in["x"],
        "B_w1": _B_in["w1"],
        "B_b1": _B_in["b1"],
        "B_w2": _B_in["w2"],
        "B_b2": _B_in["b2"],
    }

def reference(A_x, A_wqkv, A_w_phi, A_wo, B_x, B_w1, B_b1, B_w2, B_b2):
    def _A_ref(x, wqkv, w_phi, wo):
        B, S, D = x.shape
        H = 32; Dh = D // H
        qkv = (lambda x, *d: x.permute(*d))((x @ wqkv).reshape(B, S, 3, H, Dh), 2, 0, 3, 1, 4)
        q, k, v = qkv[0], qkv[1], qkv[2]
        pq = torch.einsum("bhsd,hdf->bhsf", q, w_phi)
        pk = torch.einsum("bhsd,hdf->bhsf", k, w_phi)
        phi_q = torch.concatenate([_softmax(pq, axis=-1), _softmax(-pq, axis=-1)], axis=-1)
        phi_k = torch.concatenate([_softmax(pk, axis=-1), _softmax(-pk, axis=-1)], axis=-1)
        kv = torch.einsum("bhsf,bhsd->bhfd", phi_k, v)
        z  = torch.einsum("bhsf->bhf", phi_k)
        num = torch.einsum("bhqf,bhfd->bhqd", phi_q, kv)
        den = torch.einsum("bhqf,bhf->bhq", phi_q, z)[..., None] + 1e-6
        o = num / den
        return (lambda x, *d: x.permute(*d))(o, 0, 2, 1, 3).reshape(B, S, D) @ wo

    def _B_ref(x, w1, b1, w2, b2):
        B, S, D = x.shape
        h = _layernorm(x, axis=-1)
        u = torch.einsum("bsd,sf->bdf", h, w1) + b1
        u = _gelu(u)
        y = torch.einsum("bdf,fs->bds", u, w2) + b2
        return (lambda x, *d: x.permute(*d))(y, 0, 2, 1)

    x = A_x
    xn = _layernorm(x, axis=-1)
    s = _A_ref(xn, A_wqkv, A_w_phi, A_wo)
    g = _silu(_B_ref(xn, B_w1, B_b1, B_w2, B_b2))
    return x + s * g
```

```asm
; @launch grid=(256,1,1) block=(512,1,1) lds=163840
.amdgcn_target "amdgcn-amd-amdhsa--gfx950"
.text
.globl recurrent_scan__linear_kernel_hedgehog__mixer_token_mlp__prompt_kernel
.p2align 8
.type recurrent_scan__linear_kernel_hedgehog__mixer_token_mlp__prompt_kernel,@function
recurrent_scan__linear_kernel_hedgehog__mixer_token_mlp__prompt_kernel:
    s_cmp_ge_u32 s2, 256
    s_cbranch_scc1 L_done
    s_load_dwordx16 s[4:19], s[0:1], 0
    s_load_dwordx8 s[20:27], s[0:1], 64
    v_and_b32 v1, 63, v0
    v_lshrrev_b32 v2, 6, v0
    v_lshlrev_b32 v7, 4, v1
    v_readfirstlane_b32 s48, v2
    v_mov_b32 v16, 0
    v_mov_b32 v17, 148480
    v_lshl_add_u32 v8, v1, 2, v17
    ds_write_b32 v8, v16
    s_and_b32 s50, s2, 7
    s_lshr_b32 s51, s2, 4
    s_lshr_b32 s52, s50, 1
    s_and_b32 s53, s50, 1
    s_and_b32 s49, s48, 3
    v_lshrrev_b32 v3, 4, v1
    v_and_b32 v4, 15, v1
    v_and_b32 v6, 3, v1
    v_bfe_u32 v5, v1, 2, 2
    s_lshl_b32 s3, s53, 2
    s_bfe_u32 s65, s2, 131075
    s_add_u32 s65, s65, s3
    s_lshl_b32 s3, s52, 3
    s_lshr_b32 s64, s2, 5
    s_add_u32 s64, s64, s3
    s_bitcmp1_b32 s2, 3
    s_cbranch_scc1 L_A
    v_and_b32 v2, 3, v2
    s_cmp_eq_u32 s49, 0
    s_cselect_b32 s66, 0, 2130706432
    s_cmp_ge_u32 s48, 4
    s_cbranch_scc1 L_BX
    s_setprio 2
    s_lshl_b32 s55, s50, 4
    s_add_u32 s55, s55, s51
    s_lshr_b32 s70, s55, 1
    s_lshl_b32 s70, s70, 5
    s_and_b32 s3, s55, 1
    s_lshl_b32 s3, s3, 3
    s_add_u32 s70, s70, s3
    s_lshr_b32 s3, s49, 1
    s_lshl_b32 s3, s3, 4
    s_add_u32 s70, s70, s3
    s_and_b32 s3, s49, 1
    s_lshl_b32 s3, s3, 2
    s_add_u32 s70, s70, s3
    s_lshl_b32 s57, s70, 10
    s_waitcnt lgkmcnt(0)
    s_mov_b32 s28, s4
    s_mov_b32 s29, s5
    s_mov_b32 s30, 2097152
    s_mov_b32 s31, 0x20000
    buffer_load_dwordx4 v[64:67], v7, s[28:31], s57 offen offset:0
    buffer_load_dwordx4 v[68:71], v7, s[28:31], s57 offen offset:1024
    buffer_load_dwordx4 v[72:75], v7, s[28:31], s57 offen offset:2048
    buffer_load_dwordx4 v[76:79], v7, s[28:31], s57 offen offset:3072
    s_barrier
    s_mov_b32 s36, s26
    s_mov_b32 s37, s27
    s_mov_b32 s38, 7340032
    s_mov_b32 s39, 0x20000
    s_mov_b32 s40, s24
    s_mov_b32 s41, s25
    s_mov_b32 s42, 256
    s_mov_b32 s43, 0x20000
    v_mov_b32 v48, 0x3f803f80
    v_mov_b32 v50, 0
    v_mov_b32 v51, 0
    v_mov_b32 v52, 0
    v_mov_b32 v53, 0
    v_mov_b32 v54, 0
    v_mov_b32 v55, 0
    v_mov_b32 v56, 0
    v_mov_b32 v57, 0
    v_mul_u32_u24 v12, 4224, v2
    v_add_u32 v12, v12, v7
    v_add_u32 v12, 98304, v12
    v_and_b32 v13, 1, v3
    v_lshl_add_u32 v10, v13, 2, v5
    v_mul_u32_u24 v10, 1056, v10
    v_lshl_add_u32 v10, v6, 4, v10
    v_lshrrev_b32 v11, 1, v3
    v_lshl_add_u32 v10, v11, 3, v10
    v_lshl_add_u32 v10, v2, 8, v10
    v_add_u32 v10, 98304, v10
    v_lshlrev_b32 v11, 16, v11
    v_lshl_add_u32 v11, v13, 8, v11
    v_lshl_add_u32 v11, v4, 4, v11
    s_lshl_b32 s68, s49, 19
    s_lshl_b32 s3, s55, 9
    s_add_u32 s68, s68, s3
    s_lshl_b32 s70, s70, 3
    s_add_u32 s70, s70, 7012352
    v_lshlrev_b32 v22, 3, v3
    s_and_b32 s3, s50, 1
    s_lshl_b32 s3, s3, 7
    s_add_u32 s73, s3, s66
    s_waitcnt vmcnt(3)
    v_dot2c_f32_bf16 v50, v64, v48
    v_dot2c_f32_bf16 v54, v64, v64
    v_dot2c_f32_bf16 v50, v65, v48
    v_dot2c_f32_bf16 v54, v65, v65
    v_dot2c_f32_bf16 v50, v66, v48
    v_dot2c_f32_bf16 v54, v66, v66
    v_dot2c_f32_bf16 v50, v67, v48
    v_dot2c_f32_bf16 v54, v67, v67
    s_waitcnt vmcnt(2)
    v_dot2c_f32_bf16 v51, v68, v48
    v_dot2c_f32_bf16 v55, v68, v68
    v_dot2c_f32_bf16 v51, v69, v48
    v_dot2c_f32_bf16 v55, v69, v69
    v_dot2c_f32_bf16 v51, v70, v48
    v_dot2c_f32_bf16 v55, v70, v70
    v_dot2c_f32_bf16 v51, v71, v48
    v_dot2c_f32_bf16 v55, v71, v71
    s_waitcnt vmcnt(1)
    v_dot2c_f32_bf16 v52, v72, v48
    v_dot2c_f32_bf16 v56, v72, v72
    v_dot2c_f32_bf16 v52, v73, v48
    v_dot2c_f32_bf16 v56, v73, v73
    v_dot2c_f32_bf16 v52, v74, v48
    v_dot2c_f32_bf16 v56, v74, v74
    v_dot2c_f32_bf16 v52, v75, v48
    v_dot2c_f32_bf16 v56, v75, v75
    s_waitcnt vmcnt(0)
    v_dot2c_f32_bf16 v53, v76, v48
    v_dot2c_f32_bf16 v57, v76, v76
    v_dot2c_f32_bf16 v53, v77, v48
    v_dot2c_f32_bf16 v57, v77, v77
    v_dot2c_f32_bf16 v53, v78, v48
    v_dot2c_f32_bf16 v57, v78, v78
    v_dot2c_f32_bf16 v53, v79, v48
    v_dot2c_f32_bf16 v57, v79, v79
    v_permlane32_swap_b32 v50, v52
    s_nop 0
    v_permlane32_swap_b32 v51, v53
    v_permlane32_swap_b32 v54, v56
    v_permlane32_swap_b32 v55, v57
    v_add_f32 v50, v50, v52
    v_add_f32 v51, v51, v53
    v_add_f32 v54, v54, v56
    v_add_f32 v55, v55, v57
    v_permlane16_swap_b32 v50, v51
    s_nop 0
    v_permlane16_swap_b32 v54, v55
    v_add_f32 v50, v50, v51
    v_add_f32 v54, v54, v55
    s_nop 0
    v_add_f32_dpp v50, v50, v50 row_ror:8 row_mask:0xf bank_mask:0xf
    v_add_f32_dpp v54, v54, v54 row_ror:8 row_mask:0xf bank_mask:0xf
    s_nop 0
    v_add_f32_dpp v50, v50, v50 row_ror:4 row_mask:0xf bank_mask:0xf
    v_add_f32_dpp v54, v54, v54 row_ror:4 row_mask:0xf bank_mask:0xf
    s_nop 0
    v_add_f32_dpp v50, v50, v50 row_ror:2 row_mask:0xf bank_mask:0xf
    v_add_f32_dpp v54, v54, v54 row_ror:2 row_mask:0xf bank_mask:0xf
    s_nop 0
    v_add_f32_dpp v50, v50, v50 row_ror:1 row_mask:0xf bank_mask:0xf
    v_add_f32_dpp v54, v54, v54 row_ror:1 row_mask:0xf bank_mask:0xf
    v_mul_f32 v50, 0x3b000000, v50
    v_mul_f32 v51, 0x3b000000, v54
    v_fma_f32 v51, -v50, v50, v51
    v_max_f32 v51, 0, v51
    v_add_f32 v58, 0x3727c5ac, v51
    v_rsq_f32 v58, v58
    s_nop 0
    v_mul_f32 v53, v58, v58
    v_mul_f32 v53, v53, v51
    v_add_f32 v53, 0x3727c5ac, v53
    v_rsq_f32 v53, v53
    v_sub_f32 v59, 0, v50
    v_mul_f32 v50, v58, v53
    v_mul_f32 v54, v59, v50
    v_mov_b32 v51, v50
    v_mov_b32 v55, v54
    s_nop 0
    v_permlane16_swap_b32 v50, v51
    v_permlane16_swap_b32 v54, v55
    v_mov_b32 v52, v50
    v_mov_b32 v53, v51
    v_mov_b32 v56, v54
    v_mov_b32 v57, v55
    v_permlane32_swap_b32 v50, v52
    v_permlane32_swap_b32 v51, v53
    v_permlane32_swap_b32 v54, v56
    v_permlane32_swap_b32 v55, v57
    v_lshlrev_b32 v8, 16, v64
    v_and_b32 v9, 0xffff0000, v64
    v_fma_f32 v8, v8, v50, v54
    v_fma_f32 v9, v9, v50, v54
    v_cvt_pk_bf16_f32 v64, v8, v9
    v_lshlrev_b32 v8, 16, v65
    v_and_b32 v9, 0xffff0000, v65
    v_fma_f32 v8, v8, v50, v54
    v_fma_f32 v9, v9, v50, v54
    v_cvt_pk_bf16_f32 v65, v8, v9
    v_lshlrev_b32 v8, 16, v66
    v_and_b32 v9, 0xffff0000, v66
    v_fma_f32 v8, v8, v50, v54
    v_fma_f32 v9, v9, v50, v54
    v_cvt_pk_bf16_f32 v66, v8, v9
    v_lshlrev_b32 v8, 16, v67
    v_and_b32 v9, 0xffff0000, v67
    v_fma_f32 v8, v8, v50, v54
    v_fma_f32 v9, v9, v50, v54
    v_cvt_pk_bf16_f32 v67, v8, v9
    ds_write_b128 v12, v[64:67] offset:0
    v_lshlrev_b32 v8, 16, v68
    v_and_b32 v9, 0xffff0000, v68
    v_fma_f32 v8, v8, v51, v55
    v_fma_f32 v9, v9, v51, v55
    v_cvt_pk_bf16_f32 v68, v8, v9
    v_lshlrev_b32 v8, 16, v69
    v_and_b32 v9, 0xffff0000, v69
    v_fma_f32 v8, v8, v51, v55
    v_fma_f32 v9, v9, v51, v55
    v_cvt_pk_bf16_f32 v69, v8, v9
    v_lshlrev_b32 v8, 16, v70
    v_and_b32 v9, 0xffff0000, v70
    v_fma_f32 v8, v8, v51, v55
    v_fma_f32 v9, v9, v51, v55
    v_cvt_pk_bf16_f32 v70, v8, v9
    v_lshlrev_b32 v8, 16, v71
    v_and_b32 v9, 0xffff0000, v71
    v_fma_f32 v8, v8, v51, v55
    v_fma_f32 v9, v9, v51, v55
    v_cvt_pk_bf16_f32 v71, v8, v9
    ds_write_b128 v12, v[68:71] offset:1056
    v_lshlrev_b32 v8, 16, v72
    v_and_b32 v9, 0xffff0000, v72
    v_fma_f32 v8, v8, v52, v56
    v_fma_f32 v9, v9, v52, v56
    v_cvt_pk_bf16_f32 v72, v8, v9
    v_lshlrev_b32 v8, 16, v73
    v_and_b32 v9, 0xffff0000, v73
    v_fma_f32 v8, v8, v52, v56
    v_fma_f32 v9, v9, v52, v56
    v_cvt_pk_bf16_f32 v73, v8, v9
    v_lshlrev_b32 v8, 16, v74
    v_and_b32 v9, 0xffff0000, v74
    v_fma_f32 v8, v8, v52, v56
    v_fma_f32 v9, v9, v52, v56
    v_cvt_pk_bf16_f32 v74, v8, v9
    v_lshlrev_b32 v8, 16, v75
    v_and_b32 v9, 0xffff0000, v75
    v_fma_f32 v8, v8, v52, v56
    v_fma_f32 v9, v9, v52, v56
    v_cvt_pk_bf16_f32 v75, v8, v9
    ds_write_b128 v12, v[72:75] offset:2112
    v_lshlrev_b32 v8, 16, v76
    v_and_b32 v9, 0xffff0000, v76
    v_fma_f32 v8, v8, v53, v57
    v_fma_f32 v9, v9, v53, v57
    v_cvt_pk_bf16_f32 v76, v8, v9
    v_lshlrev_b32 v8, 16, v77
    v_and_b32 v9, 0xffff0000, v77
    v_fma_f32 v8, v8, v53, v57
    v_fma_f32 v9, v9, v53, v57
    v_cvt_pk_bf16_f32 v77, v8, v9
    v_lshlrev_b32 v8, 16, v78
    v_and_b32 v9, 0xffff0000, v78
    v_fma_f32 v8, v8, v53, v57
    v_fma_f32 v9, v9, v53, v57
    v_cvt_pk_bf16_f32 v78, v8, v9
    v_lshlrev_b32 v8, 16, v79
    v_and_b32 v9, 0xffff0000, v79
    v_fma_f32 v8, v8, v53, v57
    v_fma_f32 v9, v9, v53, v57
    v_cvt_pk_bf16_f32 v79, v8, v9
    ds_write_b128 v12, v[76:79] offset:3168
    v_mov_b32 v15, 1
    s_mov_b64 exec, 1
    ds_add_u32 v17, v15 offset:0
    s_mov_b64 exec, -1
    s_mov_b32 exec_lo, 0x00010001
    s_mov_b32 exec_hi, 0x00010001
    buffer_store_dwordx2 v[58:59], v22, s[36:39], s70 offen sc0 sc1
    s_mov_b64 exec, -1
    buffer_load_dwordx2 v[18:19], v16, s[40:43], s73 offen sc0 sc1
    s_mov_b32 s53, 0
L_cw1:
    s_sleep 1
    ds_read_b32 v15, v17 offset:0
    s_waitcnt lgkmcnt(0)
    v_readfirstlane_b32 s3, v15
    s_add_u32 s53, s53, 1
    s_cmp_gt_u32 s53, 1000000
    s_nop 2
    s_cbranch_scc1 L_cw1x
    s_cmp_lt_u32 s3, 4
    s_cbranch_scc1 L_cw1
L_cw1x:
    ds_read_b64_tr_b16 v[64:65], v10 offset:0
    ds_read_b64_tr_b16 v[66:67], v10 offset:8448
    ds_read_b64_tr_b16 v[68:69], v10 offset:64
    ds_read_b64_tr_b16 v[70:71], v10 offset:8512
    ds_read_b64_tr_b16 v[72:73], v10 offset:128
    ds_read_b64_tr_b16 v[74:75], v10 offset:8576
    ds_read_b64_tr_b16 v[76:77], v10 offset:192
    ds_read_b64_tr_b16 v[78:79], v10 offset:8640
    s_waitcnt lgkmcnt(6)
    s_add_u32 s3, s68, 0
    buffer_store_dwordx4 v[64:67], v11, s[36:39], s3 offen sc0 sc1
    s_waitcnt lgkmcnt(4)
    s_add_u32 s3, s68, 131072
    buffer_store_dwordx4 v[68:71], v11, s[36:39], s3 offen sc0 sc1
    s_waitcnt lgkmcnt(2)
    s_add_u32 s3, s68, 262144
    buffer_store_dwordx4 v[72:75], v11, s[36:39], s3 offen sc0 sc1
    s_waitcnt lgkmcnt(0)
    s_add_u32 s3, s68, 393216
    buffer_store_dwordx4 v[76:79], v11, s[36:39], s3 offen sc0 sc1
    v_mov_b32 v15, 1
    s_mov_b64 exec, 1
    ds_add_u32 v17, v15 offset:60
    s_mov_b64 exec, -1
    s_waitcnt vmcnt(4)
    s_cmp_lg_u32 s49, 0
    s_cbranch_scc1 L_e2x
    s_mov_b32 s53, 0
L_e2:
    v_readfirstlane_b32 s3, v18
    s_nop 0
    s_cmp_lg_u32 s3, 0
    s_nop 2
    s_cbranch_scc1 L_e2y
    buffer_load_dwordx2 v[18:19], v16, s[40:43], s73 offen sc0 sc1
    s_waitcnt vmcnt(0)
    s_add_u32 s53, s53, 1
    s_cmp_le_u32 s53, 30000
    s_cbranch_scc1 L_e2
L_e2y:
    ds_write_b64 v17, v[18:19] offset:16
L_e2x:
    s_lshr_b32 s52, s55, 5
    s_lshl_b32 s52, s52, 7
    s_add_u32 s52, s52, 7176192
    s_waitcnt vmcnt(0)
    v_mov_b32 v15, 1
    s_mov_b64 exec, 1
    ds_add_u32 v17, v15 offset:8
    s_mov_b64 exec, -1
    s_cmp_lg_u32 s49, 0
    s_cbranch_scc1 L_pb3
    s_mov_b32 s53, 0
L_cw4:
    s_sleep 1
    ds_read_b32 v15, v17 offset:8
    s_waitcnt lgkmcnt(0)
    v_readfirstlane_b32 s3, v15
    s_add_u32 s53, s53, 1
    s_cmp_gt_u32 s53, 1000000
    s_nop 2
    s_cbranch_scc1 L_cw4x
    s_cmp_lt_u32 s3, 4
    s_cbranch_scc1 L_cw4
L_cw4x:
    v_lshlrev_b32 v14, 9, v1
    v_mov_b32 v13, 1
    s_mov_b64 exec, 0xffff
    buffer_atomic_add v13, v14, s[36:39], s52 offen sc1
    s_mov_b64 exec, -1
L_pb3:
    s_waitcnt lgkmcnt(0)
    s_setprio 0
    s_mov_b32 s44, s18
    s_mov_b32 s45, s19
    s_mov_b32 s46, 5636096
    s_mov_b32 s47, 0x20000
    v_lshlrev_b32 v8, 1, v3
    v_and_b32 v10, 7, v1
    v_xor_b32 v8, v8, v10
    v_lshlrev_b32 v8, 4, v8
    v_lshrrev_b32 v11, 3, v1
    v_lshl_add_u32 v28, v11, 12, v8
    v_add_u32 v29, 31744, v28
    v_add_u32 v30, 63488, v28
    v_add_u32 v31, 95232, v28
    s_and_b32 s3, s65, 3
    s_mul_i32 s76, s3, 3
    s_and_b32 s3, s64, 7
    s_add_u32 s76, s76, s3
    s_and_b32 s3, s50, 1
    s_mul_i32 s3, s3, 4
    s_add_u32 s76, s76, s3
    s_cmp_ge_u32 s76, 11
    s_cselect_b32 s3, 11, 0
    s_sub_u32 s76, s76, s3
    s_mov_b32 s77, s76
    s_mul_i32 s78, s49, 1441792
    s_lshl_b32 s3, s64, 7
    s_add_u32 s78, s78, s3
    s_lshl_b32 s74, s49, 14
    s_add_u32 s74, s74, 32768
    s_mul_i32 s75, s49, 11
    s_mov_b32 s53, 0
L_ep5:
    ds_read_b64 v[18:19], v17 offset:16
    s_waitcnt lgkmcnt(0)
    v_readfirstlane_b32 s3, v18
    s_add_u32 s53, s53, 1
    s_cmp_gt_u32 s53, 1000000
    s_nop 2
    s_cbranch_scc1 L_ep5x
    s_cmp_eq_u32 s3, 0
    s_cbranch_scc1 L_ep5
L_ep5x:
    s_mov_b32 s53, 0
L_cw6:
    s_sleep 8
    ds_read_b32 v15, v17 offset:8
    s_waitcnt lgkmcnt(0)
    v_readfirstlane_b32 s3, v15
    s_add_u32 s53, s53, 1
    s_cmp_gt_u32 s53, 1000000
    s_nop 2
    s_cbranch_scc1 L_cw6x
    s_cmp_lt_u32 s3, 4
    s_cbranch_scc1 L_cw6
L_cw6x:
    s_mov_b32 s53, 0
L_cw7:
    s_sleep 8
    ds_read_b32 v15, v17 offset:44
    s_waitcnt lgkmcnt(0)
    v_readfirstlane_b32 s3, v15
    s_add_u32 s53, s53, 1
    s_cmp_gt_u32 s53, 1000000
    s_nop 2
    s_cbranch_scc1 L_cw7x
    s_cmp_lt_u32 s3, 4
    s_cbranch_scc1 L_cw7
L_cw7x:
    s_lshl_b32 s58, s76, 17
    s_add_u32 s58, s58, s78
    buffer_load_dwordx4 v[176:179], v28, s[44:47], s58 offen offset:0
    buffer_load_dwordx4 v[180:183], v29, s[44:47], s58 offen offset:1024
    buffer_load_dwordx4 v[184:187], v30, s[44:47], s58 offen offset:2048
    buffer_load_dwordx4 v[188:191], v31, s[44:47], s58 offen offset:3072
    s_add_u32 s76, s76, 1
    s_cmp_eq_u32 s76, 11
    s_cselect_b32 s76, 0, s76
    s_lshl_b32 s58, s76, 17
    s_add_u32 s58, s58, s78
    buffer_load_dwordx4 v[192:195], v28, s[44:47], s58 offen offset:0
    buffer_load_dwordx4 v[196:199], v29, s[44:47], s58 offen offset:1024
    buffer_load_dwordx4 v[200:203], v30, s[44:47], s58 offen offset:2048
    buffer_load_dwordx4 v[204:207], v31, s[44:47], s58 offen offset:3072
    s_add_u32 s76, s76, 1
    s_cmp_eq_u32 s76, 11
    s_cselect_b32 s76, 0, s76
    s_lshl_b32 s58, s76, 17
    s_add_u32 s58, s58, s78
    buffer_load_dwordx4 v[208:211], v28, s[44:47], s58 offen offset:0
    buffer_load_dwordx4 v[212:215], v29, s[44:47], s58 offen offset:1024
    buffer_load_dwordx4 v[216:219], v30, s[44:47], s58 offen offset:2048
    buffer_load_dwordx4 v[220:223], v31, s[44:47], s58 offen offset:3072
    s_add_u32 s76, s76, 1
    s_cmp_eq_u32 s76, 11
    s_cselect_b32 s76, 0, s76
    s_lshl_b32 s58, s76, 17
    s_add_u32 s58, s58, s78
    buffer_load_dwordx4 v[224:227], v28, s[44:47], s58 offen offset:0
    buffer_load_dwordx4 v[228:231], v29, s[44:47], s58 offen offset:1024
    buffer_load_dwordx4 v[232:235], v30, s[44:47], s58 offen offset:2048
    buffer_load_dwordx4 v[236:239], v31, s[44:47], s58 offen offset:3072
    s_add_u32 s76, s76, 1
    s_cmp_eq_u32 s76, 11
    s_cselect_b32 s76, 0, s76
    s_lshl_b32 s58, s76, 17
    s_add_u32 s58, s58, s78
    buffer_load_dwordx4 v[240:243], v28, s[44:47], s58 offen offset:0
    buffer_load_dwordx4 v[244:247], v29, s[44:47], s58 offen offset:1024
    buffer_load_dwordx4 v[248:251], v30, s[44:47], s58 offen offset:2048
    buffer_load_dwordx4 v[252:255], v31, s[44:47], s58 offen offset:3072
    s_add_u32 s76, s76, 1
    s_cmp_eq_u32 s76, 11
    s_cselect_b32 s76, 0, s76
    s_lshl_b32 s58, s76, 17
    s_add_u32 s58, s58, s78
    buffer_load_dwordx4 v[48:51], v28, s[44:47], s58 offen offset:0
    buffer_load_dwordx4 v[52:55], v29, s[44:47], s58 offen offset:1024
    buffer_load_dwordx4 v[56:59], v30, s[44:47], s58 offen offset:2048
    buffer_load_dwordx4 v[60:63], v31, s[44:47], s58 offen offset:3072
    s_add_u32 s76, s76, 1
    s_cmp_eq_u32 s76, 11
    s_cselect_b32 s76, 0, s76
    s_lshl_b32 s59, s49, 12
    s_add_u32 s59, s59, 98304
    v_add_u32 v23, s59, v7
    v_lshl_add_u32 v10, v3, 2, v5
    v_bfe_u32 v11, v10, 1, 2
    v_lshlrev_b32 v10, 7, v10
    v_lshl_add_u32 v10, v6, 3, v10
    v_lshl_add_u32 v10, v11, 5, v10
    v_xor_b32 v11, 0, v10
    v_add_u32 v36, s59, v11
    v_add_u32 v32, s74, v11
    v_xor_b32 v11, 32, v10
    v_add_u32 v37, s59, v11
    v_add_u32 v33, s74, v11
    v_xor_b32 v11, 64, v10
    v_add_u32 v38, s59, v11
    v_add_u32 v34, s74, v11
    v_xor_b32 v11, 96, v10
    v_add_u32 v39, s59, v11
    v_add_u32 v35, s74, v11
    v_add_u32 v44, 0, v7
    v_add_u32 v45, 44032, v7
    v_add_u32 v46, 88064, v7
    v_add_u32 v47, 132096, v7
    s_mul_i32 s61, s65, 176128
    s_add_u32 s61, s61, 2097152
    s_lshl_b32 s73, s65, 5
    s_add_u32 s73, s73, s64
    s_lshl_b32 s73, s73, 7
    s_add_u32 s73, s73, 7110656
    s_mul_i32 s3, s49, 14
    s_and_b32 s3, s3, -4
    s_add_u32 s73, s73, s3
    s_waitcnt vmcnt(20)
    ds_write_b128 v23, v[176:179] offset:0
    ds_write_b128 v23, v[180:183] offset:1024
    ds_write_b128 v23, v[184:187] offset:2048
    ds_write_b128 v23, v[188:191] offset:3072
    ds_read_b64_tr_b16 v[176:177], v36 offset:0
    ds_read_b64_tr_b16 v[178:179], v36 offset:2048
    ds_read_b64_tr_b16 v[180:181], v37 offset:0
    ds_read_b64_tr_b16 v[182:183], v37 offset:2048
    ds_read_b64_tr_b16 v[184:185], v38 offset:0
    ds_read_b64_tr_b16 v[186:187], v38 offset:2048
    ds_read_b64_tr_b16 v[188:189], v39 offset:0
    ds_read_b64_tr_b16 v[190:191], v39 offset:2048
    s_waitcnt lgkmcnt(0)
    s_lshl_b32 s58, s76, 17
    s_add_u32 s58, s58, s78
    buffer_load_dwordx4 v[64:67], v28, s[44:47], s58 offen offset:0
    buffer_load_dwordx4 v[68:71], v29, s[44:47], s58 offen offset:1024
    buffer_load_dwordx4 v[72:75], v30, s[44:47], s58 offen offset:2048
    buffer_load_dwordx4 v[76:79], v31, s[44:47], s58 offen offset:3072
    s_add_u32 s76, s76, 1
    s_cmp_eq_u32 s76, 11
    s_cselect_b32 s76, 0, s76
    s_waitcnt vmcnt(20)
    ds_write_b128 v23, v[192:195] offset:0
    ds_write_b128 v23, v[196:199] offset:1024
    ds_write_b128 v23, v[200:203] offset:2048
    ds_write_b128 v23, v[204:207] offset:3072
    ds_read_b64_tr_b16 v[192:193], v36 offset:0
    ds_read_b64_tr_b16 v[194:195], v36 offset:2048
    ds_read_b64_tr_b16 v[196:197], v37 offset:0
    ds_read_b64_tr_b16 v[198:199], v37 offset:2048
    ds_read_b64_tr_b16 v[200:201], v38 offset:0
    ds_read_b64_tr_b16 v[202:203], v38 offset:2048
    ds_read_b64_tr_b16 v[204:205], v39 offset:0
    ds_read_b64_tr_b16 v[206:207], v39 offset:2048
    s_waitcnt lgkmcnt(0)
    s_lshl_b32 s58, s76, 17
    s_add_u32 s58, s58, s78
    buffer_load_dwordx4 v[80:83], v28, s[44:47], s58 offen offset:0
    buffer_load_dwordx4 v[84:87], v29, s[44:47], s58 offen offset:1024
    buffer_load_dwordx4 v[88:91], v30, s[44:47], s58 offen offset:2048
    buffer_load_dwordx4 v[92:95], v31, s[44:47], s58 offen offset:3072
    s_add_u32 s76, s76, 1
    s_cmp_eq_u32 s76, 11
    s_cselect_b32 s76, 0, s76
    s_waitcnt vmcnt(20)
    ds_write_b128 v23, v[208:211] offset:0
    ds_write_b128 v23, v[212:215] offset:1024
    ds_write_b128 v23, v[216:219] offset:2048
    ds_write_b128 v23, v[220:223] offset:3072
    ds_read_b64_tr_b16 v[208:209], v36 offset:0
    ds_read_b64_tr_b16 v[210:211], v36 offset:2048
    ds_read_b64_tr_b16 v[212:213], v37 offset:0
    ds_read_b64_tr_b16 v[214:215], v37 offset:2048
    ds_read_b64_tr_b16 v[216:217], v38 offset:0
    ds_read_b64_tr_b16 v[218:219], v38 offset:2048
    ds_read_b64_tr_b16 v[220:221], v39 offset:0
    ds_read_b64_tr_b16 v[222:223], v39 offset:2048
    s_waitcnt lgkmcnt(0)
    s_lshl_b32 s58, s76, 17
    s_add_u32 s58, s58, s78
    buffer_load_dwordx4 v[96:99], v28, s[44:47], s58 offen offset:0
    buffer_load_dwordx4 v[100:103], v29, s[44:47], s58 offen offset:1024
    buffer_load_dwordx4 v[104:107], v30, s[44:47], s58 offen offset:2048
    buffer_load_dwordx4 v[108:111], v31, s[44:47], s58 offen offset:3072
    s_add_u32 s76, s76, 1
    s_cmp_eq_u32 s76, 11
    s_cselect_b32 s76, 0, s76
    s_waitcnt vmcnt(20)
    ds_write_b128 v23, v[224:227] offset:0
    ds_write_b128 v23, v[228:231] offset:1024
    ds_write_b128 v23, v[232:235] offset:2048
    ds_write_b128 v23, v[236:239] offset:3072
    ds_read_b64_tr_b16 v[224:225], v36 offset:0
    ds_read_b64_tr_b16 v[226:227], v36 offset:2048
    ds_read_b64_tr_b16 v[228:229], v37 offset:0
    ds_read_b64_tr_b16 v[230:231], v37 offset:2048
    ds_read_b64_tr_b16 v[232:233], v38 offset:0
    ds_read_b64_tr_b16 v[234:235], v38 offset:2048
    ds_read_b64_tr_b16 v[236:237], v39 offset:0
    ds_read_b64_tr_b16 v[238:239], v39 offset:2048
    s_waitcnt lgkmcnt(0)
    s_lshl_b32 s58, s76, 17
    s_add_u32 s58, s58, s78
    buffer_load_dwordx4 v[112:115], v28, s[44:47], s58 offen offset:0
    buffer_load_dwordx4 v[116:119], v29, s[44:47], s58 offen offset:1024
    buffer_load_dwordx4 v[120:123], v30, s[44:47], s58 offen offset:2048
    buffer_load_dwordx4 v[124:127], v31, s[44:47], s58 offen offset:3072
    s_add_u32 s76, s76, 1
    s_cmp_eq_u32 s76, 11
    s_cselect_b32 s76, 0, s76
    s_waitcnt vmcnt(20)
    ds_write_b128 v23, v[240:243] offset:0
    ds_write_b128 v23, v[244:247] offset:1024
    ds_write_b128 v23, v[248:251] offset:2048
    ds_write_b128 v23, v[252:255] offset:3072
    ds_read_b64_tr_b16 v[240:241], v36 offset:0
    ds_read_b64_tr_b16 v[242:243], v36 offset:2048
    ds_read_b64_tr_b16 v[244:245], v37 offset:0
    ds_read_b64_tr_b16 v[246:247], v37 offset:2048
    ds_read_b64_tr_b16 v[248:249], v38 offset:0
    ds_read_b64_tr_b16 v[250:251], v38 offset:2048
    ds_read_b64_tr_b16 v[252:253], v39 offset:0
    ds_read_b64_tr_b16 v[254:255], v39 offset:2048
    s_waitcnt lgkmcnt(0)
    s_lshl_b32 s58, s76, 17
    s_add_u32 s58, s58, s78
    buffer_load_dwordx4 v[128:131], v28, s[44:47], s58 offen offset:0
    buffer_load_dwordx4 v[132:135], v29, s[44:47], s58 offen offset:1024
    buffer_load_dwordx4 v[136:139], v30, s[44:47], s58 offen offset:2048
    buffer_load_dwordx4 v[140:143], v31, s[44:47], s58 offen offset:3072
    s_add_u32 s76, s76, 1
    s_cmp_eq_u32 s76, 11
    s_cselect_b32 s76, 0, s76
    s_mov_b32 s53, 0
L_cw8:
    s_sleep 2
    ds_read_b32 v15, v17 offset:48
    s_waitcnt lgkmcnt(0)
    v_readfirstlane_b32 s3, v15
    s_add_u32 s53, s53, 1
    s_cmp_gt_u32 s53, 1000000
    s_nop 2
    s_cbranch_scc1 L_cw8x
    s_cmp_lt_u32 s3, 4
    s_cbranch_scc1 L_cw8
L_cw8x:
    v_add_u32 v8, s74, v7
    s_waitcnt vmcnt(20)
    ds_write_b128 v8, v[48:51] offset:0
    ds_write_b128 v8, v[52:55] offset:1024
    ds_write_b128 v8, v[56:59] offset:2048
    ds_write_b128 v8, v[60:63] offset:3072
    s_waitcnt vmcnt(16)
    ds_write_b128 v8, v[64:67] offset:4096
    ds_write_b128 v8, v[68:71] offset:5120
    ds_write_b128 v8, v[72:75] offset:6144
    ds_write_b128 v8, v[76:79] offset:7168
    s_waitcnt vmcnt(12)
    ds_write_b128 v8, v[80:83] offset:8192
    ds_write_b128 v8, v[84:87] offset:9216
    ds_write_b128 v8, v[88:91] offset:10240
    ds_write_b128 v8, v[92:95] offset:11264
    s_waitcnt vmcnt(8)
    ds_write_b128 v8, v[96:99] offset:12288
    ds_write_b128 v8, v[100:103] offset:13312
    ds_write_b128 v8, v[104:107] offset:14336
    s_waitcnt lgkmcnt(14)
    ds_write_b128 v8, v[108:111] offset:15360
    s_waitcnt vmcnt(4)
    s_waitcnt lgkmcnt(14)
    ds_write_b128 v23, v[112:115] offset:0
    s_waitcnt lgkmcnt(14)
    ds_write_b128 v23, v[116:119] offset:1024
    s_waitcnt lgkmcnt(14)
    ds_write_b128 v23, v[120:123] offset:2048
    s_waitcnt lgkmcnt(14)
    ds_write_b128 v23, v[124:127] offset:3072
    s_waitcnt vmcnt(0)
    s_waitcnt lgkmcnt(14)
    ds_write_b128 v23, v[128:131] offset:32768
    s_waitcnt lgkmcnt(14)
    ds_write_b128 v23, v[132:135] offset:33792
    s_waitcnt lgkmcnt(14)
    ds_write_b128 v23, v[136:139] offset:34816
    s_waitcnt lgkmcnt(14)
    ds_write_b128 v23, v[140:143] offset:35840
.p2alignl 6, 0xbf800000
L_Y:
    s_waitcnt lgkmcnt(0)
    v_readfirstlane_b32 s12, v18
    s_add_u32 s100, s26, s73
    s_addc_u32 s101, s27, 0
    s_mov_b32 s53, 0
    s_nop 1
L_sp9:
    s_load_dwordx8 s[84:91], s[100:101], 0 glc
    s_add_u32 s53, s53, 1
    s_waitcnt lgkmcnt(0)
    s_xor_b32 s13, s84, s12
    s_xor_b32 s3, s85, s12
    s_or_b32 s13, s13, s3
    s_xor_b32 s3, s86, s12
    s_or_b32 s13, s13, s3
    s_xor_b32 s3, s87, s12
    s_or_b32 s13, s13, s3
    s_xor_b32 s3, s88, s12
    s_or_b32 s13, s13, s3
    s_cmp_gt_u32 s53, 30000
    s_cbranch_scc1 L_sp9x
    s_cmp_lg_u32 s13, 0
    s_cbranch_scc1 L_sp9
L_sp9x:
L_Y2:
    s_setprio 1
    s_add_u32 s3, s77, s75
    s_lshl_b32 s57, s3, 10
    s_add_u32 s57, s57, s61
    s_cmp_lt_u32 s3, 43
    s_cselect_b32 s57, s57, 2130706432
    buffer_load_dwordx4 v[112:115], v44, s[36:39], s57 offen sc1
    s_add_u32 s77, s77, 1
    s_cmp_eq_u32 s77, 11
    s_cselect_b32 s77, 0, s77
    buffer_load_dwordx4 v[116:119], v45, s[36:39], s57 offen sc1
    buffer_load_dwordx4 v[120:123], v46, s[36:39], s57 offen sc1
    buffer_load_dwordx4 v[124:127], v47, s[36:39], s57 offen sc1
    s_add_u32 s3, s77, s75
    s_lshl_b32 s57, s3, 10
    s_add_u32 s57, s57, s61
    s_cmp_lt_u32 s3, 43
    s_cselect_b32 s57, s57, 2130706432
    buffer_load_dwordx4 v[128:131], v44, s[36:39], s57 offen sc1
    s_add_u32 s77, s77, 1
    s_cmp_eq_u32 s77, 11
    s_cselect_b32 s77, 0, s77
    buffer_load_dwordx4 v[132:135], v45, s[36:39], s57 offen sc1
    buffer_load_dwordx4 v[136:139], v46, s[36:39], s57 offen sc1
    buffer_load_dwordx4 v[140:143], v47, s[36:39], s57 offen sc1
    s_add_u32 s3, s77, s75
    s_lshl_b32 s57, s3, 10
    s_add_u32 s57, s57, s61
    s_cmp_lt_u32 s3, 43
    s_cselect_b32 s57, s57, 2130706432
    buffer_load_dwordx4 v[144:147], v44, s[36:39], s57 offen sc1
    s_add_u32 s77, s77, 1
    s_cmp_eq_u32 s77, 11
    s_cselect_b32 s77, 0, s77
    buffer_load_dwordx4 v[148:151], v45, s[36:39], s57 offen sc1
    buffer_load_dwordx4 v[152:155], v46, s[36:39], s57 offen sc1
    buffer_load_dwordx4 v[156:159], v47, s[36:39], s57 offen sc1
    s_add_u32 s3, s77, s75
    s_lshl_b32 s57, s3, 10
    s_add_u32 s57, s57, s61
    s_cmp_lt_u32 s3, 43
    s_cselect_b32 s57, s57, 2130706432
    buffer_load_dwordx4 v[160:163], v44, s[36:39], s57 offen sc1
    s_add_u32 s77, s77, 1
    s_cmp_eq_u32 s77, 11
    s_cselect_b32 s77, 0, s77
    buffer_load_dwordx4 v[164:167], v45, s[36:39], s57 offen sc1
    buffer_load_dwordx4 v[168:171], v46, s[36:39], s57 offen sc1
    buffer_load_dwordx4 v[172:175], v47, s[36:39], s57 offen sc1
    s_waitcnt vmcnt(15)
    v_mfma_f32_16x16x32_bf16 v[48:51], v[112:115], v[176:179], 0
    v_mfma_f32_16x16x32_bf16 v[64:67], v[112:115], v[180:183], 0
    v_mfma_f32_16x16x32_bf16 v[80:83], v[112:115], v[184:187], 0
    v_mfma_f32_16x16x32_bf16 v[96:99], v[112:115], v[188:191], 0
    s_waitcnt vmcnt(14)
    v_mfma_f32_16x16x32_bf16 v[52:55], v[116:119], v[176:179], 0
    v_mfma_f32_16x16x32_bf16 v[68:71], v[116:119], v[180:183], 0
    v_mfma_f32_16x16x32_bf16 v[84:87], v[116:119], v[184:187], 0
    v_mfma_f32_16x16x32_bf16 v[100:103], v[116:119], v[188:191], 0
    s_waitcnt vmcnt(13)
    v_mfma_f32_16x16x32_bf16 v[56:59], v[120:123], v[176:179], 0
    v_mfma_f32_16x16x32_bf16 v[72:75], v[120:123], v[180:183], 0
    v_mfma_f32_16x16x32_bf16 v[88:91], v[120:123], v[184:187], 0
    v_mfma_f32_16x16x32_bf16 v[104:107], v[120:123], v[188:191], 0
    s_waitcnt vmcnt(12)
    v_mfma_f32_16x16x32_bf16 v[60:63], v[124:127], v[176:179], 0
    v_mfma_f32_16x16x32_bf16 v[76:79], v[124:127], v[180:183], 0
    v_mfma_f32_16x16x32_bf16 v[92:95], v[124:127], v[184:187], 0
    v_mfma_f32_16x16x32_bf16 v[108:111], v[124:127], v[188:191], 0
    s_waitcnt vmcnt(11)
    v_mfma_f32_16x16x32_bf16 v[48:51], v[128:131], v[192:195], v[48:51]
    s_add_u32 s3, s77, s75
    s_lshl_b32 s57, s3, 10
    s_add_u32 s57, s57, s61
    s_cmp_lt_u32 s3, 43
    s_cselect_b32 s57, s57, 2130706432
    buffer_load_dwordx4 v[112:115], v44, s[36:39], s57 offen sc1
    s_add_u32 s77, s77, 1
    s_cmp_eq_u32 s77, 11
    s_cselect_b32 s77, 0, s77
    v_mfma_f32_16x16x32_bf16 v[64:67], v[128:131], v[196:199], v[64:67]
    v_mfma_f32_16x16x32_bf16 v[80:83], v[128:131], v[200:203], v[80:83]
    buffer_load_dwordx4 v[116:119], v45, s[36:39], s57 offen sc1
    v_mfma_f32_16x16x32_bf16 v[96:99], v[128:131], v[204:207], v[96:99]
    s_waitcnt vmcnt(12)
    v_mfma_f32_16x16x32_bf16 v[52:55], v[132:135], v[192:195], v[52:55]
    ds_read_b64_tr_b16 v[176:177], v32 offset:0
    buffer_load_dwordx4 v[120:123], v46, s[36:39], s57 offen sc1
    v_mfma_f32_16x16x32_bf16 v[68:71], v[132:135], v[196:199], v[68:71]
    ds_read_b64_tr_b16 v[178:179], v32 offset:2048
    v_mfma_f32_16x16x32_bf16 v[84:87], v[132:135], v[200:203], v[84:87]
    ds_read_b64_tr_b16 v[180:181], v33 offset:0
    buffer_load_dwordx4 v[124:127], v47, s[36:39], s57 offen sc1
    v_mfma_f32_16x16x32_bf16 v[100:103], v[132:135], v[204:207], v[100:103]
    ds_read_b64_tr_b16 v[182:183], v33 offset:2048
    s_waitcnt vmcnt(13)
    v_mfma_f32_16x16x32_bf16 v[56:59], v[136:139], v[192:195], v[56:59]
    ds_read_b64_tr_b16 v[184:185], v34 offset:0
    v_mfma_f32_16x16x32_bf16 v[72:75], v[136:139], v[196:199], v[72:75]
    ds_read_b64_tr_b16 v[186:187], v34 offset:2048
    v_mfma_f32_16x16x32_bf16 v[88:91], v[136:139], v[200:203], v[88:91]
    ds_read_b64_tr_b16 v[188:189], v35 offset:0
    v_mfma_f32_16x16x32_bf16 v[104:107], v[136:139], v[204:207], v[104:107]
    ds_read_b64_tr_b16 v[190:191], v35 offset:2048
    s_waitcnt vmcnt(12)
    v_mfma_f32_16x16x32_bf16 v[60:63], v[140:143], v[192:195], v[60:63]
    v_mfma_f32_16x16x32_bf16 v[76:79], v[140:143], v[196:199], v[76:79]
    v_mfma_f32_16x16x32_bf16 v[92:95], v[140:143], v[200:203], v[92:95]
    v_mfma_f32_16x16x32_bf16 v[108:111], v[140:143], v[204:207], v[108:111]
    s_waitcnt vmcnt(11)
    v_mfma_f32_16x16x32_bf16 v[48:51], v[144:147], v[208:211], v[48:51]
    s_add_u32 s3, s77, s75
    s_lshl_b32 s57, s3, 10
    s_add_u32 s57, s57, s61
    s_cmp_lt_u32 s3, 43
    s_cselect_b32 s57, s57, 2130706432
    buffer_load_dwordx4 v[128:131], v44, s[36:39], s57 offen sc1
    s_add_u32 s77, s77, 1
    s_cmp_eq_u32 s77, 11
    s_cselect_b32 s77, 0, s77
    v_mfma_f32_16x16x32_bf16 v[64:67], v[144:147], v[212:215], v[64:67]
    v_mfma_f32_16x16x32_bf16 v[80:83], v[144:147], v[216:219], v[80:83]
    buffer_load_dwordx4 v[132:135], v45, s[36:39], s57 offen sc1
    v_mfma_f32_16x16x32_bf16 v[96:99], v[144:147], v[220:223], v[96:99]
    s_waitcnt vmcnt(12)
    v_mfma_f32_16x16x32_bf16 v[52:55], v[148:151], v[208:211], v[52:55]
    ds_read_b64_tr_b16 v[192:193], v32 offset:4096
    buffer_load_dwordx4 v[136:139], v46, s[36:39], s57 offen sc1
    v_mfma_f32_16x16x32_bf16 v[68:71], v[148:151], v[212:215], v[68:71]
    ds_read_b64_tr_b16 v[194:195], v32 offset:6144
    v_mfma_f32_16x16x32_bf16 v[84:87], v[148:151], v[216:219], v[84:87]
    ds_read_b64_tr_b16 v[196:197], v33 offset:4096
    buffer_load_dwordx4 v[140:143], v47, s[36:39], s57 offen sc1
    v_mfma_f32_16x16x32_bf16 v[100:103], v[148:151], v[220:223], v[100:103]
    ds_read_b64_tr_b16 v[198:199], v33 offset:6144
    s_waitcnt vmcnt(13)
    v_mfma_f32_16x16x32_bf16 v[56:59], v[152:155], v[208:211], v[56:59]
    ds_read_b64_tr_b16 v[200:201], v34 offset:4096
    v_mfma_f32_16x16x32_bf16 v[72:75], v[152:155], v[212:215], v[72:75]
    ds_read_b64_tr_b16 v[202:203], v34 offset:6144
    v_mfma_f32_16x16x32_bf16 v[88:91], v[152:155], v[216:219], v[88:91]
    ds_read_b64_tr_b16 v[204:205], v35 offset:4096
    v_mfma_f32_16x16x32_bf16 v[104:107], v[152:155], v[220:223], v[104:107]
    s_waitcnt lgkmcnt(14)
    ds_read_b64_tr_b16 v[206:207], v35 offset:6144
    s_waitcnt vmcnt(12)
    v_mfma_f32_16x16x32_bf16 v[60:63], v[156:159], v[208:211], v[60:63]
    v_mfma_f32_16x16x32_bf16 v[76:79], v[156:159], v[212:215], v[76:79]
    v_mfma_f32_16x16x32_bf16 v[92:95], v[156:159], v[216:219], v[92:95]
    v_mfma_f32_16x16x32_bf16 v[108:111], v[156:159], v[220:223], v[108:111]
    s_waitcnt vmcnt(11)
    v_mfma_f32_16x16x32_bf16 v[48:51], v[160:163], v[224:227], v[48:51]
    s_add_u32 s3, s77, s75
    s_lshl_b32 s57, s3, 10
    s_add_u32 s57, s57, s61
    s_cmp_lt_u32 s3, 43
    s_cselect_b32 s57, s57, 2130706432
    buffer_load_dwordx4 v[144:147], v44, s[36:39], s57 offen sc1
    s_add_u32 s77, s77, 1
    s_cmp_eq_u32 s77, 11
    s_cselect_b32 s77, 0, s77
    v_mfma_f32_16x16x32_bf16 v[64:67], v[160:163], v[228:231], v[64:67]
    v_mfma_f32_16x16x32_bf16 v[80:83], v[160:163], v[232:235], v[80:83]
    buffer_load_dwordx4 v[148:151], v45, s[36:39], s57 offen sc1
    v_mfma_f32_16x16x32_bf16 v[96:99], v[160:163], v[236:239], v[96:99]
    s_waitcnt vmcnt(12)
    v_mfma_f32_16x16x32_bf16 v[52:55], v[164:167], v[224:227], v[52:55]
    s_waitcnt lgkmcnt(14)
    ds_read_b64_tr_b16 v[208:209], v32 offset:8192
    buffer_load_dwordx4 v[152:155], v46, s[36:39], s57 offen sc1
    v_mfma_f32_16x16x32_bf16 v[68:71], v[164:167], v[228:231], v[68:71]
    s_waitcnt lgkmcnt(14)
    ds_read_b64_tr_b16 v[210:211], v32 offset:10240
    v_mfma_f32_16x16x32_bf16 v[84:87], v[164:167], v[232:235], v[84:87]
    s_waitcnt lgkmcnt(14)
    ds_read_b64_tr_b16 v[212:213], v33 offset:8192
    buffer_load_dwordx4 v[156:159], v47, s[36:39], s57 offen sc1
    v_mfma_f32_16x16x32_bf16 v[100:103], v[164:167], v[236:239], v[100:103]
    s_waitcnt lgkmcnt(14)
    ds_read_b64_tr_b16 v[214:215], v33 offset:10240
    s_waitcnt vmcnt(13)
    v_mfma_f32_16x16x32_bf16 v[56:59], v[168:171], v[224:227], v[56:59]
    s_waitcnt lgkmcnt(14)
    ds_read_b64_tr_b16 v[216:217], v34 offset:8192
    v_mfma_f32_16x16x32_bf16 v[72:75], v[168:171], v[228:231], v[72:75]
    s_waitcnt lgkmcnt(14)
    ds_read_b64_tr_b16 v[218:219], v34 offset:10240
    v_mfma_f32_16x16x32_bf16 v[88:91], v[168:171], v[232:235], v[88:91]
    s_waitcnt lgkmcnt(14)
    ds_read_b64_tr_b16 v[220:221], v35 offset:8192
    v_mfma_f32_16x16x32_bf16 v[104:107], v[168:171], v[236:239], v[104:107]
    s_waitcnt lgkmcnt(14)
    ds_read_b64_tr_b16 v[222:223], v35 offset:10240
    s_waitcnt vmcnt(12)
    v_mfma_f32_16x16x32_bf16 v[60:63], v[172:175], v[224:227], v[60:63]
    v_mfma_f32_16x16x32_bf16 v[76:79], v[172:175], v[228:231], v[76:79]
    v_mfma_f32_16x16x32_bf16 v[92:95], v[172:175], v[232:235], v[92:95]
    v_mfma_f32_16x16x32_bf16 v[108:111], v[172:175], v[236:239], v[108:111]
    s_waitcnt vmcnt(11)
    v_mfma_f32_16x16x32_bf16 v[48:51], v[112:115], v[240:243], v[48:51]
    s_add_u32 s3, s77, s75
    s_lshl_b32 s57, s3, 10
    s_add_u32 s57, s57, s61
    s_cmp_lt_u32 s3, 43
    s_cselect_b32 s57, s57, 2130706432
    buffer_load_dwordx4 v[160:163], v44, s[36:39], s57 offen sc1
    s_add_u32 s77, s77, 1
    s_cmp_eq_u32 s77, 11
    s_cselect_b32 s77, 0, s77
    v_mfma_f32_16x16x32_bf16 v[64:67], v[112:115], v[244:247], v[64:67]
    v_mfma_f32_16x16x32_bf16 v[80:83], v[112:115], v[248:251], v[80:83]
    buffer_load_dwordx4 v[164:167], v45, s[36:39], s57 offen sc1
    v_mfma_f32_16x16x32_bf16 v[96:99], v[112:115], v[252:255], v[96:99]
    s_waitcnt vmcnt(12)
    v_mfma_f32_16x16x32_bf16 v[52:55], v[116:119], v[240:243], v[52:55]
    s_waitcnt lgkmcnt(14)
    ds_read_b64_tr_b16 v[224:225], v32 offset:12288
    buffer_load_dwordx4 v[168:171], v46, s[36:39], s57 offen sc1
    v_mfma_f32_16x16x32_bf16 v[68:71], v[116:119], v[244:247], v[68:71]
    s_waitcnt lgkmcnt(14)
    ds_read_b64_tr_b16 v[226:227], v32 offset:14336
    v_mfma_f32_16x16x32_bf16 v[84:87], v[116:119], v[248:251], v[84:87]
    s_waitcnt lgkmcnt(14)
    ds_read_b64_tr_b16 v[228:229], v33 offset:12288
    buffer_load_dwordx4 v[172:175], v47, s[36:39], s57 offen sc1
    v_mfma_f32_16x16x32_bf16 v[100:103], v[116:119], v[252:255], v[100:103]
    s_waitcnt lgkmcnt(14)
    ds_read_b64_tr_b16 v[230:231], v33 offset:14336
    s_waitcnt vmcnt(13)
    v_mfma_f32_16x16x32_bf16 v[56:59], v[120:123], v[240:243], v[56:59]
    s_waitcnt lgkmcnt(14)
    ds_read_b64_tr_b16 v[232:233], v34 offset:12288
    v_mfma_f32_16x16x32_bf16 v[72:75], v[120:123], v[244:247], v[72:75]
    s_waitcnt lgkmcnt(14)
    ds_read_b64_tr_b16 v[234:235], v34 offset:14336
    v_mfma_f32_16x16x32_bf16 v[88:91], v[120:123], v[248:251], v[88:91]
    s_waitcnt lgkmcnt(14)
    ds_read_b64_tr_b16 v[236:237], v35 offset:12288
    v_mfma_f32_16x16x32_bf16 v[104:107], v[120:123], v[252:255], v[104:107]
    s_waitcnt lgkmcnt(14)
    ds_read_b64_tr_b16 v[238:239], v35 offset:14336
    s_waitcnt vmcnt(12)
    v_mfma_f32_16x16x32_bf16 v[60:63], v[124:127], v[240:243], v[60:63]
    v_mfma_f32_16x16x32_bf16 v[76:79], v[124:127], v[244:247], v[76:79]
    v_mfma_f32_16x16x32_bf16 v[92:95], v[124:127], v[248:251], v[92:95]
    v_mfma_f32_16x16x32_bf16 v[108:111], v[124:127], v[252:255], v[108:111]
    s_waitcnt vmcnt(11)
    v_mfma_f32_16x16x32_bf16 v[48:51], v[128:131], v[176:179], v[48:51]
    s_add_u32 s3, s77, s75
    s_lshl_b32 s57, s3, 10
    s_add_u32 s57, s57, s61
    s_cmp_lt_u32 s3, 43
    s_cselect_b32 s57, s57, 2130706432
    buffer_load_dwordx4 v[112:115], v44, s[36:39], s57 offen sc1
    s_add_u32 s77, s77, 1
    s_cmp_eq_u32 s77, 11
    s_cselect_b32 s77, 0, s77
    v_mfma_f32_16x16x32_bf16 v[64:67], v[128:131], v[180:183], v[64:67]
    v_mfma_f32_16x16x32_bf16 v[80:83], v[128:131], v[184:187], v[80:83]
    buffer_load_dwordx4 v[116:119], v45, s[36:39], s57 offen sc1
    v_mfma_f32_16x16x32_bf16 v[96:99], v[128:131], v[188:191], v[96:99]
    s_waitcnt vmcnt(12)
    v_mfma_f32_16x16x32_bf16 v[52:55], v[132:135], v[176:179], v[52:55]
    s_waitcnt lgkmcnt(14)
    ds_read_b64_tr_b16 v[240:241], v36 offset:0
    buffer_load_dwordx4 v[120:123], v46, s[36:39], s57 offen sc1
    v_mfma_f32_16x16x32_bf16 v[68:71], v[132:135], v[180:183], v[68:71]
    s_waitcnt lgkmcnt(14)
    ds_read_b64_tr_b16 v[242:243], v36 offset:2048
    v_mfma_f32_16x16x32_bf16 v[84:87], v[132:135], v[184:187], v[84:87]
    s_waitcnt lgkmcnt(14)
    ds_read_b64_tr_b16 v[244:245], v37 offset:0
    buffer_load_dwordx4 v[124:127], v47, s[36:39], s57 offen sc1
    v_mfma_f32_16x16x32_bf16 v[100:103], v[132:135], v[188:191], v[100:103]
    s_waitcnt lgkmcnt(14)
    ds_read_b64_tr_b16 v[246:247], v37 offset:2048
    s_waitcnt vmcnt(13)
    v_mfma_f32_16x16x32_bf16 v[56:59], v[136:139], v[176:179], v[56:59]
    s_waitcnt lgkmcnt(14)
    ds_read_b64_tr_b16 v[248:249], v38 offset:0
    v_mfma_f32_16x16x32_bf16 v[72:75], v[136:139], v[180:183], v[72:75]
    s_waitcnt lgkmcnt(14)
    ds_read_b64_tr_b16 v[250:251], v38 offset:2048
    v_mfma_f32_16x16x32_bf16 v[88:91], v[136:139], v[184:187], v[88:91]
    s_waitcnt lgkmcnt(14)
    ds_read_b64_tr_b16 v[252:253], v39 offset:0
    v_mfma_f32_16x16x32_bf16 v[104:107], v[136:139], v[188:191], v[104:107]
    s_waitcnt lgkmcnt(14)
    ds_read_b64_tr_b16 v[254:255], v39 offset:2048
    s_waitcnt vmcnt(12)
    v_mfma_f32_16x16x32_bf16 v[60:63], v[140:143], v[176:179], v[60:63]
    v_mfma_f32_16x16x32_bf16 v[76:79], v[140:143], v[180:183], v[76:79]
    v_mfma_f32_16x16x32_bf16 v[92:95], v[140:143], v[184:187], v[92:95]
    v_mfma_f32_16x16x32_bf16 v[108:111], v[140:143], v[188:191], v[108:111]
    s_waitcnt vmcnt(11)
    v_mfma_f32_16x16x32_bf16 v[48:51], v[144:147], v[192:195], v[48:51]
    s_add_u32 s3, s77, s75
    s_lshl_b32 s57, s3, 10
    s_add_u32 s57, s57, s61
    s_cmp_lt_u32 s3, 43
    s_cselect_b32 s57, s57, 2130706432
    buffer_load_dwordx4 v[128:131], v44, s[36:39], s57 offen sc1
    s_add_u32 s77, s77, 1
    s_cmp_eq_u32 s77, 11
    s_cselect_b32 s77, 0, s77
    v_mfma_f32_16x16x32_bf16 v[64:67], v[144:147], v[196:199], v[64:67]
    v_mfma_f32_16x16x32_bf16 v[80:83], v[144:147], v[200:203], v[80:83]
    buffer_load_dwordx4 v[132:135], v45, s[36:39], s57 offen sc1
    v_mfma_f32_16x16x32_bf16 v[96:99], v[144:147], v[204:207], v[96:99]
    s_waitcnt vmcnt(12)
    v_mfma_f32_16x16x32_bf16 v[52:55], v[148:151], v[192:195], v[52:55]
    s_waitcnt lgkmcnt(14)
    ds_read_b64_tr_b16 v[176:177], v36 offset:32768
    buffer_load_dwordx4 v[136:139], v46, s[36:39], s57 offen sc1
    v_mfma_f32_16x16x32_bf16 v[68:71], v[148:151], v[196:199], v[68:71]
    s_waitcnt lgkmcnt(14)
    ds_read_b64_tr_b16 v[178:179], v36 offset:34816
    v_mfma_f32_16x16x32_bf16 v[84:87], v[148:151], v[200:203], v[84:87]
    s_waitcnt lgkmcnt(14)
    ds_read_b64_tr_b16 v[180:181], v37 offset:32768
    buffer_load_dwordx4 v[140:143], v47, s[36:39], s57 offen sc1
    v_mfma_f32_16x16x32_bf16 v[100:103], v[148:151], v[204:207], v[100:103]
    s_waitcnt lgkmcnt(14)
    ds_read_b64_tr_b16 v[182:183], v37 offset:34816
    s_waitcnt vmcnt(13)
    v_mfma_f32_16x16x32_bf16 v[56:59], v[152:155], v[192:195], v[56:59]
    s_waitcnt lgkmcnt(14)
    ds_read_b64_tr_b16 v[184:185], v38 offset:32768
    v_mfma_f32_16x16x32_bf16 v[72:75], v[152:155], v[196:199], v[72:75]
    s_waitcnt lgkmcnt(14)
    ds_read_b64_tr_b16 v[186:187], v38 offset:34816
    v_mfma_f32_16x16x32_bf16 v[88:91], v[152:155], v[200:203], v[88:91]
    s_waitcnt lgkmcnt(14)
    ds_read_b64_tr_b16 v[188:189], v39 offset:32768
    v_mfma_f32_16x16x32_bf16 v[104:107], v[152:155], v[204:207], v[104:107]
    s_waitcnt lgkmcnt(14)
    ds_read_b64_tr_b16 v[190:191], v39 offset:34816
    s_waitcnt vmcnt(12)
    v_mfma_f32_16x16x32_bf16 v[60:63], v[156:159], v[192:195], v[60:63]
    v_mfma_f32_16x16x32_bf16 v[76:79], v[156:159], v[196:199], v[76:79]
    v_mfma_f32_16x16x32_bf16 v[92:95], v[156:159], v[200:203], v[92:95]
    v_mfma_f32_16x16x32_bf16 v[108:111], v[156:159], v[204:207], v[108:111]
    s_waitcnt vmcnt(11)
    v_mfma_f32_16x16x32_bf16 v[48:51], v[160:163], v[208:211], v[48:51]
    s_add_u32 s3, s77, s75
    s_lshl_b32 s57, s3, 10
    s_add_u32 s57, s57, s61
    s_cmp_lt_u32 s3, 43
    s_cselect_b32 s57, s57, 2130706432
    buffer_load_dwordx4 v[144:147], v44, s[36:39], s57 offen sc1
    s_add_u32 s77, s77, 1
    s_cmp_eq_u32 s77, 11
    s_cselect_b32 s77, 0, s77
    v_mfma_f32_16x16x32_bf16 v[64:67], v[160:163], v[212:215], v[64:67]
    v_mfma_f32_16x16x32_bf16 v[80:83], v[160:163], v[216:219], v[80:83]
    buffer_load_dwordx4 v[148:151], v45, s[36:39], s57 offen sc1
    v_mfma_f32_16x16x32_bf16 v[96:99], v[160:163], v[220:223], v[96:99]
    s_waitcnt vmcnt(12)
    v_mfma_f32_16x16x32_bf16 v[52:55], v[164:167], v[208:211], v[52:55]
    buffer_load_dwordx4 v[152:155], v46, s[36:39], s57 offen sc1
    v_mfma_f32_16x16x32_bf16 v[68:71], v[164:167], v[212:215], v[68:71]
    v_mfma_f32_16x16x32_bf16 v[84:87], v[164:167], v[216:219], v[84:87]
    buffer_load_dwordx4 v[156:159], v47, s[36:39], s57 offen sc1
    v_mfma_f32_16x16x32_bf16 v[100:103], v[164:167], v[220:223], v[100:103]
    s_waitcnt vmcnt(13)
    v_mfma_f32_16x16x32_bf16 v[56:59], v[168:171], v[208:211], v[56:59]
    v_mfma_f32_16x16x32_bf16 v[72:75], v[168:171], v[212:215], v[72:75]
    v_mfma_f32_16x16x32_bf16 v[88:91], v[168:171], v[216:219], v[88:91]
    v_mfma_f32_16x16x32_bf16 v[104:107], v[168:171], v[220:223], v[104:107]
    s_waitcnt vmcnt(12)
    v_mfma_f32_16x16x32_bf16 v[60:63], v[172:175], v[208:211], v[60:63]
    v_mfma_f32_16x16x32_bf16 v[76:79], v[172:175], v[212:215], v[76:79]
    v_mfma_f32_16x16x32_bf16 v[92:95], v[172:175], v[216:219], v[92:95]
    v_mfma_f32_16x16x32_bf16 v[108:111], v[172:175], v[220:223], v[108:111]
    s_waitcnt vmcnt(11)
    v_mfma_f32_16x16x32_bf16 v[48:51], v[112:115], v[224:227], v[48:51]
    v_mfma_f32_16x16x32_bf16 v[64:67], v[112:115], v[228:231], v[64:67]
    v_mfma_f32_16x16x32_bf16 v[80:83], v[112:115], v[232:235], v[80:83]
    v_mfma_f32_16x16x32_bf16 v[96:99], v[112:115], v[236:239], v[96:99]
    s_waitcnt vmcnt(10)
    v_mfma_f32_16x16x32_bf16 v[52:55], v[116:119], v[224:227], v[52:55]
    v_mfma_f32_16x16x32_bf16 v[68:71], v[116:119], v[228:231], v[68:71]
    v_mfma_f32_16x16x32_bf16 v[84:87], v[116:119], v[232:235], v[84:87]
    v_mfma_f32_16x16x32_bf16 v[100:103], v[116:119], v[236:239], v[100:103]
    s_waitcnt vmcnt(9)
    v_mfma_f32_16x16x32_bf16 v[56:59], v[120:123], v[224:227], v[56:59]
    v_mfma_f32_16x16x32_bf16 v[72:75], v[120:123], v[228:231], v[72:75]
    v_mfma_f32_16x16x32_bf16 v[88:91], v[120:123], v[232:235], v[88:91]
    v_mfma_f32_16x16x32_bf16 v[104:107], v[120:123], v[236:239], v[104:107]
    s_waitcnt vmcnt(8)
    v_mfma_f32_16x16x32_bf16 v[60:63], v[124:127], v[224:227], v[60:63]
    v_mfma_f32_16x16x32_bf16 v[76:79], v[124:127], v[228:231], v[76:79]
    v_mfma_f32_16x16x32_bf16 v[92:95], v[124:127], v[232:235], v[92:95]
    v_mfma_f32_16x16x32_bf16 v[108:111], v[124:127], v[236:239], v[108:111]
    s_waitcnt vmcnt(7)
    s_waitcnt lgkmcnt(14)
    v_mfma_f32_16x16x32_bf16 v[48:51], v[128:131], v[240:243], v[48:51]
    s_waitcnt lgkmcnt(12)
    v_mfma_f32_16x16x32_bf16 v[64:67], v[128:131], v[244:247], v[64:67]
    s_waitcnt lgkmcnt(10)
    v_mfma_f32_16x16x32_bf16 v[80:83], v[128:131], v[248:251], v[80:83]
    s_waitcnt lgkmcnt(8)
    v_mfma_f32_16x16x32_bf16 v[96:99], v[128:131], v[252:255], v[96:99]
    s_waitcnt vmcnt(6)
    v_mfma_f32_16x16x32_bf16 v[52:55], v[132:135], v[240:243], v[52:55]
    v_mfma_f32_16x16x32_bf16 v[68:71], v[132:135], v[244:247], v[68:71]
    v_mfma_f32_16x16x32_bf16 v[84:87], v[132:135], v[248:251], v[84:87]
    v_mfma_f32_16x16x32_bf16 v[100:103], v[132:135], v[252:255], v[100:103]
    s_waitcnt vmcnt(5)
    v_mfma_f32_16x16x32_bf16 v[56:59], v[136:139], v[240:243], v[56:59]
    v_mfma_f32_16x16x32_bf16 v[72:75], v[136:139], v[244:247], v[72:75]
    v_mfma_f32_16x16x32_bf16 v[88:91], v[136:139], v[248:251], v[88:91]
    v_mfma_f32_16x16x32_bf16 v[104:107], v[136:139], v[252:255], v[104:107]
    s_waitcnt vmcnt(4)
    v_mfma_f32_16x16x32_bf16 v[60:63], v[140:143], v[240:243], v[60:63]
    v_mfma_f32_16x16x32_bf16 v[76:79], v[140:143], v[244:247], v[76:79]
    v_mfma_f32_16x16x32_bf16 v[92:95], v[140:143], v[248:251], v[92:95]
    v_mfma_f32_16x16x32_bf16 v[108:111], v[140:143], v[252:255], v[108:111]
    v_add_u32 v8, s74, v7
    s_waitcnt vmcnt(3)
    s_waitcnt lgkmcnt(6)
    v_mfma_f32_16x16x32_bf16 v[48:51], v[144:147], v[176:179], v[48:51]
    s_waitcnt vmcnt(2)
    v_mfma_f32_16x16x32_bf16 v[52:55], v[148:151], v[176:179], v[52:55]
    s_waitcnt vmcnt(1)
    v_mfma_f32_16x16x32_bf16 v[56:59], v[152:155], v[176:179], v[56:59]
    s_waitcnt vmcnt(0)
    v_mfma_f32_16x16x32_bf16 v[60:63], v[156:159], v[176:179], v[60:63]
    s_waitcnt lgkmcnt(4)
    v_mfma_f32_16x16x32_bf16 v[64:67], v[144:147], v[180:183], v[64:67]
    v_mfma_f32_16x16x32_bf16 v[68:71], v[148:151], v[180:183], v[68:71]
    ds_write_b128 v8, v[48:51] offset:0
    v_mfma_f32_16x16x32_bf16 v[72:75], v[152:155], v[180:183], v[72:75]
    ds_write_b128 v8, v[52:55] offset:1024
    v_mfma_f32_16x16x32_bf16 v[76:79], v[156:159], v[180:183], v[76:79]
    ds_write_b128 v8, v[56:59] offset:2048
    s_waitcnt lgkmcnt(5)
    v_mfma_f32_16x16x32_bf16 v[80:83], v[144:147], v[184:187], v[80:83]
    ds_write_b128 v8, v[60:63] offset:3072
    v_mfma_f32_16x16x32_bf16 v[84:87], v[148:151], v[184:187], v[84:87]
    ds_write_b128 v8, v[64:67] offset:4096
    v_mfma_f32_16x16x32_bf16 v[88:91], v[152:155], v[184:187], v[88:91]
    ds_write_b128 v8, v[68:71] offset:5120
    v_mfma_f32_16x16x32_bf16 v[92:95], v[156:159], v[184:187], v[92:95]
    ds_write_b128 v8, v[72:75] offset:6144
    s_waitcnt lgkmcnt(7)
    v_mfma_f32_16x16x32_bf16 v[96:99], v[144:147], v[188:191], v[96:99]
    ds_write_b128 v8, v[76:79] offset:7168
    v_mfma_f32_16x16x32_bf16 v[100:103], v[148:151], v[188:191], v[100:103]
    ds_write_b128 v8, v[80:83] offset:8192
    v_mfma_f32_16x16x32_bf16 v[104:107], v[152:155], v[188:191], v[104:107]
    ds_write_b128 v8, v[84:87] offset:9216
    v_mfma_f32_16x16x32_bf16 v[108:111], v[156:159], v[188:191], v[108:111]
    ds_write_b128 v8, v[88:91] offset:10240
    ds_write_b128 v8, v[92:95] offset:11264
    ds_write_b128 v8, v[96:99] offset:12288
    s_nop 0
    ds_write_b128 v8, v[100:103] offset:13312
    s_nop 0
    ds_write_b128 v8, v[104:107] offset:14336
    s_waitcnt lgkmcnt(14)
    ds_write_b128 v8, v[108:111] offset:15360
    s_waitcnt lgkmcnt(0)
    s_barrier
    s_endpgm
.p2alignl 6, 0xbf800000
L_BX:
    s_lshl_b32 s3, s2, 3
    s_add_u32 s3, s3, s48
    s_cmp_eq_u32 s3, 1591
    s_cbranch_scc0 L_noep
    s_waitcnt lgkmcnt(0)
    s_mov_b32 s36, s26
    s_mov_b32 s37, s27
    s_mov_b32 s38, 7340032
    s_mov_b32 s39, 0x20000
    s_mov_b32 s40, s24
    s_mov_b32 s41, s25
    s_mov_b32 s42, 256
    s_mov_b32 s43, 0x20000
    s_memrealtime s[96:97]
    v_lshlrev_b32 v8, 7, v1
    s_mov_b32 s3, 7176192
    buffer_store_dword v16, v8, s[36:39], s3 offen sc0 sc1
    s_waitcnt lgkmcnt(0) vmcnt(0)
    s_or_b32 s96, s96, 1
    v_mov_b32 v18, s96
    v_mov_b32 v19, s97
    buffer_store_dwordx2 v[18:19], v8, s[40:43], 0 offen sc0 sc1
    s_nop 1
L_noep:
    s_lshl_b32 s3, s52, 4
    s_add_u32 s3, s3, s51
    s_lshr_b32 s63, s3, 2
    s_and_b32 s62, s3, 3
    s_add_u32 s56, s62, s63
    s_and_b32 s56, s56, 3
    s_lshl_b32 s56, s56, 2
    s_lshl_b32 s3, s53, 1
    s_add_u32 s56, s56, s3
    s_lshl_b32 s3, s53, 2
    s_add_u32 s62, s62, s3
    s_mul_i32 s60, s63, 192
    s_mul_i32 s3, s49, 1409024
    s_add_u32 s60, s60, s3
    v_add_u32 v8, 0, v1
    v_mul_u32_u24 v9, 43691, v8
    v_lshrrev_b32 v9, 19, v9
    v_mul_u32_u24 v10, 12, v9
    v_sub_u32 v10, v8, v10
    v_bfe_u32 v11, v9, 2, 1
    v_lshlrev_b32 v11, 1, v11
    v_xor_b32 v10, v10, v11
    v_mul_u32_u24 v9, 2752, v9
    v_lshl_add_u32 v24, v10, 4, v9
    v_add_u32 v8, 64, v1
    v_mul_u32_u24 v9, 43691, v8
    v_lshrrev_b32 v9, 19, v9
    v_mul_u32_u24 v10, 12, v9
    v_sub_u32 v10, v8, v10
    v_bfe_u32 v11, v9, 2, 1
    v_lshlrev_b32 v11, 1, v11
    v_xor_b32 v10, v10, v11
    v_mul_u32_u24 v9, 2752, v9
    v_lshl_add_u32 v25, v10, 4, v9
    v_subrev_u32 v25, 1024, v25
    v_add_u32 v8, 128, v1
    v_mul_u32_u24 v9, 43691, v8
    v_lshrrev_b32 v9, 19, v9
    v_mul_u32_u24 v10, 12, v9
    v_sub_u32 v10, v8, v10
    v_bfe_u32 v11, v9, 2, 1
    v_lshlrev_b32 v11, 1, v11
    v_xor_b32 v10, v10, v11
    v_mul_u32_u24 v9, 2752, v9
    v_lshl_add_u32 v26, v10, 4, v9
    v_subrev_u32 v26, 2048, v26
    s_mul_i32 s59, s49, 24576
    s_mul_i32 s80, s49, 6144
    s_add_u32 s80, s80, 115712
    s_mov_b32 s71, s56
    s_mov_b32 s72, s56
    s_waitcnt lgkmcnt(0)
    s_mov_b32 s32, s14
    s_mov_b32 s33, s15
    s_mov_b32 s34, 5636096
    s_mov_b32 s35, 0x20000
    s_mov_b32 s28, s4
    s_mov_b32 s29, s5
    s_mov_b32 s30, 2097152
    s_mov_b32 s31, 0x20000
    s_mov_b32 s36, s26
    s_mov_b32 s37, s27
    s_mov_b32 s38, 7340032
    s_mov_b32 s39, 0x20000
    s_barrier
    s_cmp_lg_u32 s51, 15
    s_cbranch_scc1 L_ncp
    s_getpc_b64 s[96:97]
L_pc:
    s_sub_u32 s96, s96, L_pc-recurrent_scan__linear_kernel_hedgehog__mixer_token_mlp__prompt_kernel
    s_subb_u32 s97, s97, 0
    v_lshl_add_u32 v8, v2, 6, v1
    v_lshlrev_b32 v8, 7, v8
    v_min_u32 v8, L_done-recurrent_scan__linear_kernel_hedgehog__mixer_token_mlp__prompt_kernel, v8
    global_load_dword v20, v8, s[96:97]
    v_add_u32 v8, 32768, v8
    v_min_u32 v8, L_done-recurrent_scan__linear_kernel_hedgehog__mixer_token_mlp__prompt_kernel, v8
    global_load_dword v20, v8, s[96:97]
    s_nop 1
L_ncp:
    s_cmp_eq_u32 s63, 15
    s_cbranch_scc0 L_bx1
    s_mov_b32 s53, 0
L_ep10:
    ds_read_b64 v[18:19], v17 offset:16
    s_waitcnt lgkmcnt(0)
    v_readfirstlane_b32 s3, v18
    s_add_u32 s53, s53, 1
    s_cmp_gt_u32 s53, 1000000
    s_nop 2
    s_cbranch_scc1 L_ep10x
    s_cmp_eq_u32 s3, 0
    s_cbranch_scc1 L_ep10
L_ep10x:
    s_lshl_b32 s73, s51, 2
    s_add_u32 s73, s73, s49
    s_lshl_b32 s73, s73, 7
    s_add_u32 s73, s73, 7176192
    s_waitcnt lgkmcnt(0)
    s_mov_b32 s12, 32
    s_add_u32 s100, s26, s73
    s_addc_u32 s101, s27, 0
    s_mov_b32 s53, 0
L_sp11:
    s_load_dword s84, s[100:101], 0 glc
    s_add_u32 s53, s53, 1
    s_waitcnt lgkmcnt(0)
    s_xor_b32 s13, s84, s12
    s_cmp_gt_u32 s53, 30000
    s_cbranch_scc1 L_sp11x
    s_cmp_lg_u32 s13, 0
    s_cbranch_scc1 L_sp11
L_sp11x:
    s_mov_b32 s44, s18
    s_mov_b32 s45, s19
    s_mov_b32 s46, 5636096
    s_mov_b32 s47, 0x20000
    s_and_b32 s68, s51, 3
    s_lshl_b32 s68, s68, 10
    s_and_b32 s3, s50, 1
    s_lshl_b32 s3, s3, 2
    s_add_u32 s3, s3, s49
    s_mul_i32 s3, s3, 704512
    s_add_u32 s68, s68, s3
    v_add_u32 v8, 0, v1
    v_min_u32 v8, 171, v8
    v_lshlrev_b32 v8, 12, v8
    buffer_load_dword v20, v8, s[44:47], s68 offen offset:384
    v_add_u32 v8, 64, v1
    v_min_u32 v8, 171, v8
    v_lshlrev_b32 v8, 12, v8
    buffer_load_dword v20, v8, s[44:47], s68 offen offset:384
    v_add_u32 v8, 128, v1
    v_min_u32 v8, 171, v8
    v_lshlrev_b32 v8, 12, v8
    buffer_load_dword v20, v8, s[44:47], s68 offen offset:384
    v_mov_b32 v15, 1
    s_mov_b64 exec, 1
    ds_add_u32 v17, v15 offset:44
    s_mov_b64 exec, -1
    v_mov_b32 v15, 1
    s_mov_b64 exec, 1
    ds_add_u32 v17, v15 offset:48
    s_mov_b64 exec, -1
    s_branch L_bx2
.p2alignl 6, 0xbf800000
L_bx1:
    s_mul_i32 s58, s71, 88064
    s_add_u32 s58, s58, s60
    s_add_u32 s71, s71, 1
    s_and_b32 s71, s71, 15
    s_add_u32 m0, s59, 0
    s_nop 0
    buffer_load_dwordx4 v24, s[32:35], s58 offen lds
    buffer_load_dwordx4 v25, s[32:35], s58 offen offset:1024 lds
    buffer_load_dwordx4 v26, s[32:35], s58 offen offset:2048 lds
    s_add_u32 s58, s58, 44032
    s_add_u32 m0, s59, 3072
    s_nop 0
    buffer_load_dwordx4 v24, s[32:35], s58 offen lds
    s_waitcnt vmcnt(3)
    buffer_load_dwordx4 v25, s[32:35], s58 offen offset:1024 lds
    s_waitcnt vmcnt(3)
    buffer_load_dwordx4 v26, s[32:35], s58 offen offset:2048 lds
    s_waitcnt vmcnt(3)
    s_mul_i32 s58, s71, 88064
    s_add_u32 s58, s58, s60
    s_add_u32 s71, s71, 1
    s_and_b32 s71, s71, 15
    s_add_u32 m0, s59, 6144
    s_nop 0
    buffer_load_dwordx4 v24, s[32:35], s58 offen lds
    s_waitcnt vmcnt(3)
    buffer_load_dwordx4 v25, s[32:35], s58 offen offset:1024 lds
    s_waitcnt vmcnt(3)
    buffer_load_dwordx4 v26, s[32:35], s58 offen offset:2048 lds
    s_waitcnt vmcnt(3)
    s_add_u32 s58, s58, 44032
    s_add_u32 m0, s59, 9216
    s_nop 0
    buffer_load_dwordx4 v24, s[32:35], s58 offen lds
    s_waitcnt vmcnt(3)
    buffer_load_dwordx4 v25, s[32:35], s58 offen offset:1024 lds
    s_waitcnt vmcnt(3)
    buffer_load_dwordx4 v26, s[32:35], s58 offen offset:2048 lds
    s_mov_b32 s53, 0
L_cw12:
    s_sleep 1
    ds_read_b32 v15, v17 offset:60
    s_waitcnt lgkmcnt(0)
    v_readfirstlane_b32 s3, v15
    s_add_u32 s53, s53, 1
    s_cmp_gt_u32 s53, 1000000
    s_nop 2
    s_cbranch_scc1 L_cw12x
    s_cmp_lt_u32 s3, 4
    s_cbranch_scc1 L_cw12
L_cw12x:
    s_mul_i32 s58, s71, 88064
    s_add_u32 s58, s58, s60
    s_add_u32 s71, s71, 1
    s_and_b32 s71, s71, 15
    s_add_u32 m0, s59, 12288
    s_nop 0
    buffer_load_dwordx4 v24, s[32:35], s58 offen lds
    buffer_load_dwordx4 v25, s[32:35], s58 offen offset:1024 lds
    buffer_load_dwordx4 v26, s[32:35], s58 offen offset:2048 lds
    s_add_u32 s58, s58, 44032
    s_add_u32 m0, s59, 15360
    s_nop 0
    buffer_load_dwordx4 v24, s[32:35], s58 offen lds
    buffer_load_dwordx4 v25, s[32:35], s58 offen offset:1024 lds
    buffer_load_dwordx4 v26, s[32:35], s58 offen offset:2048 lds
    s_mul_i32 s58, s71, 88064
    s_add_u32 s58, s58, s60
    s_add_u32 s71, s71, 1
    s_and_b32 s71, s71, 15
    s_add_u32 m0, s59, 18432
    s_nop 0
    buffer_load_dwordx4 v24, s[32:35], s58 offen lds
    buffer_load_dwordx4 v25, s[32:35], s58 offen offset:1024 lds
    buffer_load_dwordx4 v26, s[32:35], s58 offen offset:2048 lds
    s_add_u32 s58, s58, 44032
    s_add_u32 m0, s59, 21504
    s_nop 0
    buffer_load_dwordx4 v24, s[32:35], s58 offen lds
    buffer_load_dwordx4 v25, s[32:35], s58 offen offset:1024 lds
    buffer_load_dwordx4 v26, s[32:35], s58 offen offset:2048 lds
    s_mul_i32 s58, s71, 88064
    s_add_u32 s58, s58, s60
    s_add_u32 s71, s71, 1
    s_and_b32 s71, s71, 15
    s_add_u32 m0, s80, 0
    s_nop 0
    buffer_load_dwordx4 v24, s[32:35], s58 offen lds
    buffer_load_dwordx4 v25, s[32:35], s58 offen offset:1024 lds
    buffer_load_dwordx4 v26, s[32:35], s58 offen offset:2048 lds
    s_add_u32 s58, s58, 44032
    s_add_u32 m0, s80, 3072
    s_nop 0
    buffer_load_dwordx4 v24, s[32:35], s58 offen lds
    buffer_load_dwordx4 v25, s[32:35], s58 offen offset:1024 lds
    buffer_load_dwordx4 v26, s[32:35], s58 offen offset:2048 lds
    v_lshl_add_u32 v8, v3, 2, v5
    v_mul_u32_u24 v8, 192, v8
    v_lshl_add_u32 v8, v6, 3, v8
    v_add_u32 v8, s59, v8
    v_and_b32 v9, 1, v3
    v_lshl_add_u32 v27, v9, 5, v8
    v_xor_b32 v9, 1, v9
    v_lshl_add_u32 v28, v9, 5, v8
    s_sub_u32 s3, s80, s59
    v_add_u32 v29, s3, v27
    v_add_u32 v30, s3, v28
    v_lshl_add_u32 v8, v2, 16, v7
    v_xor_b32 v32, 0, v8
    v_xor_b32 v33, 65536, v8
    v_xor_b32 v34, 131072, v8
    v_xor_b32 v35, 196608, v8
    s_lshl_b32 s61, s62, 18
    s_lshl_b32 s3, s49, 14
    s_add_u32 s61, s61, s3
    s_mov_b32 s53, 0
L_ep13:
    ds_read_b64 v[18:19], v17 offset:16
    s_waitcnt lgkmcnt(0)
    v_readfirstlane_b32 s3, v18
    s_add_u32 s53, s53, 1
    s_cmp_gt_u32 s53, 1000000
    s_nop 2
    s_cbranch_scc1 L_ep13x
    s_cmp_eq_u32 s3, 0
    s_cbranch_scc1 L_ep13
L_ep13x:
    v_and_b32 v22, 31, v1
    v_lshlrev_b32 v22, 3, v22
    s_lshl_b32 s73, s49, 8
    s_add_u32 s73, s73, 6946816
    s_mov_b32 s40, s16
    s_mov_b32 s41, s17
    s_mov_b32 s42, 2752
    s_mov_b32 s43, 0x20000
    v_lshlrev_b32 v8, 3, v3
    s_mul_i32 s3, s63, 192
    buffer_load_dwordx2 v[244:245], v8, s[40:43], s3 offen offset:0
    buffer_load_dwordx2 v[246:247], v8, s[40:43], s3 offen offset:32
    buffer_load_dwordx2 v[248:249], v8, s[40:43], s3 offen offset:64
    buffer_load_dwordx2 v[250:251], v8, s[40:43], s3 offen offset:96
    buffer_load_dwordx2 v[252:253], v8, s[40:43], s3 offen offset:128
    buffer_load_dwordx2 v[254:255], v8, s[40:43], s3 offen offset:160
    s_lshl_b32 s73, s51, 2
    s_add_u32 s73, s73, s49
    s_lshl_b32 s73, s73, 7
    s_add_u32 s73, s73, 7176192
    s_waitcnt lgkmcnt(0)
    s_mov_b32 s12, 32
    s_add_u32 s100, s26, s73
    s_addc_u32 s101, s27, 0
    s_mov_b32 s53, 0
L_sp14:
    s_load_dword s84, s[100:101], 0 glc
    s_add_u32 s53, s53, 1
    s_waitcnt lgkmcnt(0)
    s_xor_b32 s13, s84, s12
    s_cmp_gt_u32 s53, 30000
    s_cbranch_scc1 L_sp14x
    s_cmp_lg_u32 s13, 0
    s_cbranch_scc1 L_sp14
L_sp14x:
    s_setprio 1
    s_lshl_b32 s57, s72, 10
    s_add_u32 s57, s57, s61
    buffer_load_dwordx4 v[132:135], v32, s[36:39], s57 offen sc1
    s_add_u32 s72, s72, 1
    s_and_b32 s72, s72, 15
    buffer_load_dwordx4 v[136:139], v33, s[36:39], s57 offen sc1
    buffer_load_dwordx4 v[140:143], v34, s[36:39], s57 offen sc1
    buffer_load_dwordx4 v[144:147], v35, s[36:39], s57 offen sc1
    s_lshl_b32 s57, s72, 10
    s_add_u32 s57, s57, s61
    buffer_load_dwordx4 v[148:151], v32, s[36:39], s57 offen sc1
    s_add_u32 s72, s72, 1
    s_and_b32 s72, s72, 15
    buffer_load_dwordx4 v[152:155], v33, s[36:39], s57 offen sc1
    buffer_load_dwordx4 v[156:159], v34, s[36:39], s57 offen sc1
    buffer_load_dwordx4 v[160:163], v35, s[36:39], s57 offen sc1
    s_lshl_b32 s57, s72, 10
    s_add_u32 s57, s57, s61
    buffer_load_dwordx4 v[164:167], v32, s[36:39], s57 offen sc1
    s_add_u32 s72, s72, 1
    s_and_b32 s72, s72, 15
    buffer_load_dwordx4 v[168:171], v33, s[36:39], s57 offen sc1
    buffer_load_dwordx4 v[172:175], v34, s[36:39], s57 offen sc1
    buffer_load_dwordx4 v[176:179], v35, s[36:39], s57 offen sc1
    s_lshl_b32 s57, s72, 10
    s_add_u32 s57, s57, s61
    buffer_load_dwordx4 v[180:183], v32, s[36:39], s57 offen sc1
    s_add_u32 s72, s72, 1
    s_and_b32 s72, s72, 15
    buffer_load_dwordx4 v[184:187], v33, s[36:39], s57 offen sc1
    buffer_load_dwordx4 v[188:191], v34, s[36:39], s57 offen sc1
    buffer_load_dwordx4 v[192:195], v35, s[36:39], s57 offen sc1
    s_waitcnt vmcnt(46)
    ds_read_b64_tr_b16 v[196:197], v27 offset:0
    ds_read_b64_tr_b16 v[198:199], v27 offset:3072
    ds_read_b64_tr_b16 v[200:201], v28 offset:0
    ds_read_b64_tr_b16 v[202:203], v28 offset:3072
    ds_read_b64_tr_b16 v[204:205], v27 offset:64
    ds_read_b64_tr_b16 v[206:207], v27 offset:3136
    ds_read_b64_tr_b16 v[208:209], v28 offset:64
    ds_read_b64_tr_b16 v[210:211], v28 offset:3136
    ds_read_b64_tr_b16 v[212:213], v27 offset:128
    ds_read_b64_tr_b16 v[214:215], v27 offset:3200
    ds_read_b64_tr_b16 v[216:217], v28 offset:128
    ds_read_b64_tr_b16 v[218:219], v28 offset:3200
    s_waitcnt lgkmcnt(0)
    s_mul_i32 s58, s71, 88064
    s_add_u32 s58, s58, s60
    s_add_u32 s71, s71, 1
    s_and_b32 s71, s71, 15
    s_add_u32 m0, s59, 0
    s_nop 0
    buffer_load_dwordx4 v24, s[32:35], s58 offen lds
    buffer_load_dwordx4 v25, s[32:35], s58 offen offset:1024 lds
    buffer_load_dwordx4 v26, s[32:35], s58 offen offset:2048 lds
    s_add_u32 s58, s58, 44032
    s_add_u32 m0, s59, 3072
    s_nop 0
    buffer_load_dwordx4 v24, s[32:35], s58 offen lds
    buffer_load_dwordx4 v25, s[32:35], s58 offen offset:1024 lds
    buffer_load_dwordx4 v26, s[32:35], s58 offen offset:2048 lds
    s_waitcnt vmcnt(46)
    ds_read_b64_tr_b16 v[220:221], v27 offset:6144
    ds_read_b64_tr_b16 v[222:223], v27 offset:9216
    ds_read_b64_tr_b16 v[224:225], v28 offset:6144
    ds_read_b64_tr_b16 v[226:227], v28 offset:9216
    ds_read_b64_tr_b16 v[228:229], v27 offset:6208
    ds_read_b64_tr_b16 v[230:231], v27 offset:9280
    ds_read_b64_tr_b16 v[232:233], v28 offset:6208
    ds_read_b64_tr_b16 v[234:235], v28 offset:9280
    ds_read_b64_tr_b16 v[236:237], v27 offset:6272
    ds_read_b64_tr_b16 v[238:239], v27 offset:9344
    ds_read_b64_tr_b16 v[240:241], v28 offset:6272
    ds_read_b64_tr_b16 v[242:243], v28 offset:9344
    s_waitcnt lgkmcnt(0)
    s_mul_i32 s58, s71, 88064
    s_add_u32 s58, s58, s60
    s_add_u32 s71, s71, 1
    s_and_b32 s71, s71, 15
    s_add_u32 m0, s59, 6144
    s_nop 0
    buffer_load_dwordx4 v24, s[32:35], s58 offen lds
    buffer_load_dwordx4 v25, s[32:35], s58 offen offset:1024 lds
    buffer_load_dwordx4 v26, s[32:35], s58 offen offset:2048 lds
    s_add_u32 s58, s58, 44032
    s_add_u32 m0, s59, 9216
    s_nop 0
    buffer_load_dwordx4 v24, s[32:35], s58 offen lds
    buffer_load_dwordx4 v25, s[32:35], s58 offen offset:1024 lds
    buffer_load_dwordx4 v26, s[32:35], s58 offen offset:2048 lds
    s_waitcnt vmcnt(27)
    v_mfma_f32_16x16x32_bf16 v[36:39], v[196:199], v[132:135], 0
    v_mfma_f32_16x16x32_bf16 v[40:43], v[200:203], v[132:135], 0
    v_mfma_f32_16x16x32_bf16 v[44:47], v[204:207], v[132:135], 0
    v_mfma_f32_16x16x32_bf16 v[48:51], v[208:211], v[132:135], 0
    v_mfma_f32_16x16x32_bf16 v[52:55], v[212:215], v[132:135], 0
    v_mfma_f32_16x16x32_bf16 v[56:59], v[216:219], v[132:135], 0
    s_waitcnt vmcnt(26)
    v_mfma_f32_16x16x32_bf16 v[60:63], v[196:199], v[136:139], 0
    v_mfma_f32_16x16x32_bf16 v[64:67], v[200:203], v[136:139], 0
    v_mfma_f32_16x16x32_bf16 v[68:71], v[204:207], v[136:139], 0
    v_mfma_f32_16x16x32_bf16 v[72:75], v[208:211], v[136:139], 0
    v_mfma_f32_16x16x32_bf16 v[76:79], v[212:215], v[136:139], 0
    v_mfma_f32_16x16x32_bf16 v[80:83], v[216:219], v[136:139], 0
    s_waitcnt vmcnt(25)
    v_mfma_f32_16x16x32_bf16 v[84:87], v[196:199], v[140:143], 0
    v_mfma_f32_16x16x32_bf16 v[88:91], v[200:203], v[140:143], 0
    v_mfma_f32_16x16x32_bf16 v[92:95], v[204:207], v[140:143], 0
    v_mfma_f32_16x16x32_bf16 v[96:99], v[208:211], v[140:143], 0
    v_mfma_f32_16x16x32_bf16 v[100:103], v[212:215], v[140:143], 0
    v_mfma_f32_16x16x32_bf16 v[104:107], v[216:219], v[140:143], 0
    s_waitcnt vmcnt(24)
    v_mfma_f32_16x16x32_bf16 v[108:111], v[196:199], v[144:147], 0
    v_mfma_f32_16x16x32_bf16 v[112:115], v[200:203], v[144:147], 0
    v_mfma_f32_16x16x32_bf16 v[116:119], v[204:207], v[144:147], 0
    v_mfma_f32_16x16x32_bf16 v[120:123], v[208:211], v[144:147], 0
    v_mfma_f32_16x16x32_bf16 v[124:127], v[212:215], v[144:147], 0
    v_mfma_f32_16x16x32_bf16 v[128:131], v[216:219], v[144:147], 0
    s_lshl_b32 s57, s72, 10
    s_add_u32 s57, s57, s61
    buffer_load_dwordx4 v[132:135], v32, s[36:39], s57 offen sc1
    s_add_u32 s72, s72, 1
    s_and_b32 s72, s72, 15
    buffer_load_dwordx4 v[136:139], v33, s[36:39], s57 offen sc1
    s_waitcnt vmcnt(25)
    v_mfma_f32_16x16x32_bf16 v[36:39], v[220:223], v[148:151], v[36:39]
    v_mfma_f32_16x16x32_bf16 v[40:43], v[224:227], v[148:151], v[40:43]
    buffer_load_dwordx4 v[140:143], v34, s[36:39], s57 offen sc1
    v_mfma_f32_16x16x32_bf16 v[44:47], v[228:231], v[148:151], v[44:47]
    v_mfma_f32_16x16x32_bf16 v[48:51], v[232:235], v[148:151], v[48:51]
    buffer_load_dwordx4 v[144:147], v35, s[36:39], s57 offen sc1
    v_mfma_f32_16x16x32_bf16 v[52:55], v[236:239], v[148:151], v[52:55]
    v_mfma_f32_16x16x32_bf16 v[56:59], v[240:243], v[148:151], v[56:59]
    s_waitcnt vmcnt(26)
    v_mfma_f32_16x16x32_bf16 v[60:63], v[220:223], v[152:155], v[60:63]
    ds_read_b64_tr_b16 v[196:197], v27 offset:12288
    v_mfma_f32_16x16x32_bf16 v[64:67], v[224:227], v[152:155], v[64:67]
    ds_read_b64_tr_b16 v[198:199], v27 offset:15360
    v_mfma_f32_16x16x32_bf16 v[68:71], v[228:231], v[152:155], v[68:71]
    ds_read_b64_tr_b16 v[200:201], v28 offset:12288
    v_mfma_f32_16x16x32_bf16 v[72:75], v[232:235], v[152:155], v[72:75]
    ds_read_b64_tr_b16 v[202:203], v28 offset:15360
    v_mfma_f32_16x16x32_bf16 v[76:79], v[236:239], v[152:155], v[76:79]
    ds_read_b64_tr_b16 v[204:205], v27 offset:12352
    v_mfma_f32_16x16x32_bf16 v[80:83], v[240:243], v[152:155], v[80:83]
    ds_read_b64_tr_b16 v[206:207], v27 offset:15424
    s_waitcnt vmcnt(25)
    v_mfma_f32_16x16x32_bf16 v[84:87], v[220:223], v[156:159], v[84:87]
    ds_read_b64_tr_b16 v[208:209], v28 offset:12352
    v_mfma_f32_16x16x32_bf16 v[88:91], v[224:227], v[156:159], v[88:91]
    ds_read_b64_tr_b16 v[210:211], v28 offset:15424
    v_mfma_f32_16x16x32_bf16 v[92:95], v[228:231], v[156:159], v[92:95]
    ds_read_b64_tr_b16 v[212:213], v27 offset:12416
    v_mfma_f32_16x16x32_bf16 v[96:99], v[232:235], v[156:159], v[96:99]
    ds_read_b64_tr_b16 v[214:215], v27 offset:15488
    v_mfma_f32_16x16x32_bf16 v[100:103], v[236:239], v[156:159], v[100:103]
    ds_read_b64_tr_b16 v[216:217], v28 offset:12416
    v_mfma_f32_16x16x32_bf16 v[104:107], v[240:243], v[156:159], v[104:107]
    ds_read_b64_tr_b16 v[218:219], v28 offset:15488
    s_waitcnt vmcnt(24)
    v_mfma_f32_16x16x32_bf16 v[108:111], v[220:223], v[160:163], v[108:111]
    v_mfma_f32_16x16x32_bf16 v[112:115], v[224:227], v[160:163], v[112:115]
    v_mfma_f32_16x16x32_bf16 v[116:119], v[228:231], v[160:163], v[116:119]
    v_mfma_f32_16x16x32_bf16 v[120:123], v[232:235], v[160:163], v[120:123]
    v_mfma_f32_16x16x32_bf16 v[124:127], v[236:239], v[160:163], v[124:127]
    v_mfma_f32_16x16x32_bf16 v[128:131], v[240:243], v[160:163], v[128:131]
    s_lshl_b32 s57, s72, 10
    s_add_u32 s57, s57, s61
    buffer_load_dwordx4 v[148:151], v32, s[36:39], s57 offen sc1
    s_add_u32 s72, s72, 1
    s_and_b32 s72, s72, 15
    buffer_load_dwordx4 v[152:155], v33, s[36:39], s57 offen sc1
    s_waitcnt vmcnt(25)
    s_waitcnt lgkmcnt(10)
    v_mfma_f32_16x16x32_bf16 v[36:39], v[196:199], v[164:167], v[36:39]
    s_waitcnt lgkmcnt(8)
    v_mfma_f32_16x16x32_bf16 v[40:43], v[200:203], v[164:167], v[40:43]
    buffer_load_dwordx4 v[156:159], v34, s[36:39], s57 offen sc1
    s_waitcnt lgkmcnt(6)
    v_mfma_f32_16x16x32_bf16 v[44:47], v[204:207], v[164:167], v[44:47]
    s_waitcnt lgkmcnt(4)
    v_mfma_f32_16x16x32_bf16 v[48:51], v[208:211], v[164:167], v[48:51]
    buffer_load_dwordx4 v[160:163], v35, s[36:39], s57 offen sc1
    s_waitcnt lgkmcnt(2)
    v_mfma_f32_16x16x32_bf16 v[52:55], v[212:215], v[164:167], v[52:55]
    s_waitcnt lgkmcnt(0)
    v_mfma_f32_16x16x32_bf16 v[56:59], v[216:219], v[164:167], v[56:59]
    s_waitcnt vmcnt(26)
    v_mfma_f32_16x16x32_bf16 v[60:63], v[196:199], v[168:171], v[60:63]
    ds_read_b64_tr_b16 v[220:221], v27 offset:18432
    s_mul_i32 s58, s71, 88064
    s_add_u32 s58, s58, s60
    s_add_u32 s71, s71, 1
    s_and_b32 s71, s71, 15
    s_add_u32 m0, s59, 12288
    s_nop 0
    buffer_load_dwordx4 v24, s[32:35], s58 offen lds
    v_mfma_f32_16x16x32_bf16 v[64:67], v[200:203], v[168:171], v[64:67]
    ds_read_b64_tr_b16 v[222:223], v27 offset:21504
    v_mfma_f32_16x16x32_bf16 v[68:71], v[204:207], v[168:171], v[68:71]
    ds_read_b64_tr_b16 v[224:225], v28 offset:18432
    buffer_load_dwordx4 v25, s[32:35], s58 offen offset:1024 lds
    v_mfma_f32_16x16x32_bf16 v[72:75], v[208:211], v[168:171], v[72:75]
    ds_read_b64_tr_b16 v[226:227], v28 offset:21504
    v_mfma_f32_16x16x32_bf16 v[76:79], v[212:215], v[168:171], v[76:79]
    ds_read_b64_tr_b16 v[228:229], v27 offset:18496
    buffer_load_dwordx4 v26, s[32:35], s58 offen offset:2048 lds
    v_mfma_f32_16x16x32_bf16 v[80:83], v[216:219], v[168:171], v[80:83]
    ds_read_b64_tr_b16 v[230:231], v27 offset:21568
    s_waitcnt vmcnt(28)
    v_mfma_f32_16x16x32_bf16 v[84:87], v[196:199], v[172:175], v[84:87]
    ds_read_b64_tr_b16 v[232:233], v28 offset:18496
    s_add_u32 s58, s58, 44032
    s_add_u32 m0, s59, 15360
    s_nop 0
    buffer_load_dwordx4 v24, s[32:35], s58 offen lds
    v_mfma_f32_16x16x32_bf16 v[88:91], v[200:203], v[172:175], v[88:91]
    ds_read_b64_tr_b16 v[234:235], v28 offset:21568
    v_mfma_f32_16x16x32_bf16 v[92:95], v[204:207], v[172:175], v[92:95]
    ds_read_b64_tr_b16 v[236:237], v27 offset:18560
    buffer_load_dwordx4 v25, s[32:35], s58 offen offset:1024 lds
    v_mfma_f32_16x16x32_bf16 v[96:99], v[208:211], v[172:175], v[96:99]
    ds_read_b64_tr_b16 v[238:239], v27 offset:21632
    v_mfma_f32_16x16x32_bf16 v[100:103], v[212:215], v[172:175], v[100:103]
    ds_read_b64_tr_b16 v[240:241], v28 offset:18560
    buffer_load_dwordx4 v26, s[32:35], s58 offen offset:2048 lds
    v_mfma_f32_16x16x32_bf16 v[104:107], v[216:219], v[172:175], v[104:107]
    ds_read_b64_tr_b16 v[242:243], v28 offset:21632
    s_waitcnt vmcnt(30)
    v_mfma_f32_16x16x32_bf16 v[108:111], v[196:199], v[176:179], v[108:111]
    v_mfma_f32_16x16x32_bf16 v[112:115], v[200:203], v[176:179], v[112:115]
    v_mfma_f32_16x16x32_bf16 v[116:119], v[204:207], v[176:179], v[116:119]
    v_mfma_f32_16x16x32_bf16 v[120:123], v[208:211], v[176:179], v[120:123]
    v_mfma_f32_16x16x32_bf16 v[124:127], v[212:215], v[176:179], v[124:127]
    v_mfma_f32_16x16x32_bf16 v[128:131], v[216:219], v[176:179], v[128:131]
    s_lshl_b32 s57, s72, 10
    s_add_u32 s57, s57, s61
    buffer_load_dwordx4 v[164:167], v32, s[36:39], s57 offen sc1
    s_add_u32 s72, s72, 1
    s_and_b32 s72, s72, 15
    buffer_load_dwordx4 v[168:171], v33, s[36:39], s57 offen sc1
    s_waitcnt vmcnt(31)
    s_waitcnt lgkmcnt(10)
    v_mfma_f32_16x16x32_bf16 v[36:39], v[220:223], v[180:183], v[36:39]
    s_waitcnt lgkmcnt(8)
    v_mfma_f32_16x16x32_bf16 v[40:43], v[224:227], v[180:183], v[40:43]
    buffer_load_dwordx4 v[172:175], v34, s[36:39], s57 offen sc1
    s_waitcnt lgkmcnt(6)
    v_mfma_f32_16x16x32_bf16 v[44:47], v[228:231], v[180:183], v[44:47]
    s_waitcnt lgkmcnt(4)
    v_mfma_f32_16x16x32_bf16 v[48:51], v[232:235], v[180:183], v[48:51]
    buffer_load_dwordx4 v[176:179], v35, s[36:39], s57 offen sc1
    s_waitcnt lgkmcnt(2)
    v_mfma_f32_16x16x32_bf16 v[52:55], v[236:239], v[180:183], v[52:55]
    s_waitcnt lgkmcnt(0)
    v_mfma_f32_16x16x32_bf16 v[56:59], v[240:243], v[180:183], v[56:59]
    s_waitcnt vmcnt(32)
    v_mfma_f32_16x16x32_bf16 v[60:63], v[220:223], v[184:187], v[60:63]
    ds_read_b64_tr_b16 v[196:197], v29 offset:0
    s_mul_i32 s58, s71, 88064
    s_add_u32 s58, s58, s60
    s_add_u32 s71, s71, 1
    s_and_b32 s71, s71, 15
    s_add_u32 m0, s59, 18432
    s_nop 0
    buffer_load_dwordx4 v24, s[32:35], s58 offen lds
    v_mfma_f32_16x16x32_bf16 v[64:67], v[224:227], v[184:187], v[64:67]
    ds_read_b64_tr_b16 v[198:199], v29 offset:3072
    v_mfma_f32_16x16x32_bf16 v[68:71], v[228:231], v[184:187], v[68:71]
    ds_read_b64_tr_b16 v[200:201], v30 offset:0
    buffer_load_dwordx4 v25, s[32:35], s58 offen offset:1024 lds
    v_mfma_f32_16x16x32_bf16 v[72:75], v[232:235], v[184:187], v[72:75]
    ds_read_b64_tr_b16 v[202:203], v30 offset:3072
    v_mfma_f32_16x16x32_bf16 v[76:79], v[236:239], v[184:187], v[76:79]
    ds_read_b64_tr_b16 v[204:205], v29 offset:64
    buffer_load_dwordx4 v26, s[32:35], s58 offen offset:2048 lds
    v_mfma_f32_16x16x32_bf16 v[80:83], v[240:243], v[184:187], v[80:83]
    ds_read_b64_tr_b16 v[206:207], v29 offset:3136
    s_waitcnt vmcnt(34)
    v_mfma_f32_16x16x32_bf16 v[84:87], v[220:223], v[188:191], v[84:87]
    ds_read_b64_tr_b16 v[208:209], v30 offset:64
    s_add_u32 s58, s58, 44032
    s_add_u32 m0, s59, 21504
    s_nop 0
    buffer_load_dwordx4 v24, s[32:35], s58 offen lds
    v_mfma_f32_16x16x32_bf16 v[88:91], v[224:227], v[188:191], v[88:91]
    ds_read_b64_tr_b16 v[210:211], v30 offset:3136
    v_mfma_f32_16x16x32_bf16 v[92:95], v[228:231], v[188:191], v[92:95]
    ds_read_b64_tr_b16 v[212:213], v29 offset:128
    buffer_load_dwordx4 v25, s[32:35], s58 offen offset:1024 lds
    v_mfma_f32_16x16x32_bf16 v[96:99], v[232:235], v[188:191], v[96:99]
    ds_read_b64_tr_b16 v[214:215], v29 offset:3200
    v_mfma_f32_16x16x32_bf16 v[100:103], v[236:239], v[188:191], v[100:103]
    ds_read_b64_tr_b16 v[216:217], v30 offset:128
    buffer_load_dwordx4 v26, s[32:35], s58 offen offset:2048 lds
    v_mfma_f32_16x16x32_bf16 v[104:107], v[240:243], v[188:191], v[104:107]
    ds_read_b64_tr_b16 v[218:219], v30 offset:3200
    s_waitcnt vmcnt(36)
    v_mfma_f32_16x16x32_bf16 v[108:111], v[220:223], v[192:195], v[108:111]
    v_mfma_f32_16x16x32_bf16 v[112:115], v[224:227], v[192:195], v[112:115]
    v_mfma_f32_16x16x32_bf16 v[116:119], v[228:231], v[192:195], v[116:119]
    v_mfma_f32_16x16x32_bf16 v[120:123], v[232:235], v[192:195], v[120:123]
    v_mfma_f32_16x16x32_bf16 v[124:127], v[236:239], v[192:195], v[124:127]
    v_mfma_f32_16x16x32_bf16 v[128:131], v[240:243], v[192:195], v[128:131]
    s_waitcnt vmcnt(30)
    s_lshl_b32 s57, s72, 10
    s_add_u32 s57, s57, s61
    buffer_load_dwordx4 v[180:183], v32, s[36:39], s57 offen sc1
    s_add_u32 s72, s72, 1
    s_and_b32 s72, s72, 15
    buffer_load_dwordx4 v[184:187], v33, s[36:39], s57 offen sc1
    s_waitcnt vmcnt(25)
    s_waitcnt lgkmcnt(10)
    v_mfma_f32_16x16x32_bf16 v[36:39], v[196:199], v[132:135], v[36:39]
    s_waitcnt lgkmcnt(8)
    v_mfma_f32_16x16x32_bf16 v[40:43], v[200:203], v[132:135], v[40:43]
    buffer_load_dwordx4 v[188:191], v34, s[36:39], s57 offen sc1
    s_waitcnt lgkmcnt(6)
    v_mfma_f32_16x16x32_bf16 v[44:47], v[204:207], v[132:135], v[44:47]
    s_waitcnt lgkmcnt(4)
    v_mfma_f32_16x16x32_bf16 v[48:51], v[208:211], v[132:135], v[48:51]
    buffer_load_dwordx4 v[192:195], v35, s[36:39], s57 offen sc1
    s_waitcnt lgkmcnt(2)
    v_mfma_f32_16x16x32_bf16 v[52:55], v[212:215], v[132:135], v[52:55]
    s_waitcnt lgkmcnt(0)
    v_mfma_f32_16x16x32_bf16 v[56:59], v[216:219], v[132:135], v[56:59]
    s_waitcnt vmcnt(26)
    v_mfma_f32_16x16x32_bf16 v[60:63], v[196:199], v[136:139], v[60:63]
    ds_read_b64_tr_b16 v[220:221], v27 offset:0
    s_mul_i32 s58, s71, 88064
    s_add_u32 s58, s58, s60
    s_add_u32 s71, s71, 1
    s_and_b32 s71, s71, 15
    s_add_u32 m0, s80, 0
    s_nop 0
    buffer_load_dwordx4 v24, s[32:35], s58 offen lds
    v_mfma_f32_16x16x32_bf16 v[64:67], v[200:203], v[136:139], v[64:67]
    ds_read_b64_tr_b16 v[222:223], v27 offset:3072
    v_mfma_f32_16x16x32_bf16 v[68:71], v[204:207], v[136:139], v[68:71]
    ds_read_b64_tr_b16 v[224:225], v28 offset:0
    buffer_load_dwordx4 v25, s[32:35], s58 offen offset:1024 lds
    v_mfma_f32_16x16x32_bf16 v[72:75], v[208:211], v[136:139], v[72:75]
    ds_read_b64_tr_b16 v[226:227], v28 offset:3072
    v_mfma_f32_16x16x32_bf16 v[76:79], v[212:215], v[136:139], v[76:79]
    ds_read_b64_tr_b16 v[228:229], v27 offset:64
    buffer_load_dwordx4 v26, s[32:35], s58 offen offset:2048 lds
    v_mfma_f32_16x16x32_bf16 v[80:83], v[216:219], v[136:139], v[80:83]
    ds_read_b64_tr_b16 v[230:231], v27 offset:3136
    s_waitcnt vmcnt(28)
    v_mfma_f32_16x16x32_bf16 v[84:87], v[196:199], v[140:143], v[84:87]
    ds_read_b64_tr_b16 v[232:233], v28 offset:64
    s_add_u32 s58, s58, 44032
    s_add_u32 m0, s80, 3072
    s_nop 0
    buffer_load_dwordx4 v24, s[32:35], s58 offen lds
    v_mfma_f32_16x16x32_bf16 v[88:91], v[200:203], v[140:143], v[88:91]
    ds_read_b64_tr_b16 v[234:235], v28 offset:3136
    v_mfma_f32_16x16x32_bf16 v[92:95], v[204:207], v[140:143], v[92:95]
    ds_read_b64_tr_b16 v[236:237], v27 offset:128
    buffer_load_dwordx4 v25, s[32:35], s58 offen offset:1024 lds
    v_mfma_f32_16x16x32_bf16 v[96:99], v[208:211], v[140:143], v[96:99]
    ds_read_b64_tr_b16 v[238:239], v27 offset:3200
    v_mfma_f32_16x16x32_bf16 v[100:103], v[212:215], v[140:143], v[100:103]
    ds_read_b64_tr_b16 v[240:241], v28 offset:128
    buffer_load_dwordx4 v26, s[32:35], s58 offen offset:2048 lds
    v_mfma_f32_16x16x32_bf16 v[104:107], v[216:219], v[140:143], v[104:107]
    ds_read_b64_tr_b16 v[242:243], v28 offset:3200
    s_waitcnt vmcnt(30)
    v_mfma_f32_16x16x32_bf16 v[108:111], v[196:199], v[144:147], v[108:111]
    v_mfma_f32_16x16x32_bf16 v[112:115], v[200:203], v[144:147], v[112:115]
    v_mfma_f32_16x16x32_bf16 v[116:119], v[204:207], v[144:147], v[116:119]
    v_mfma_f32_16x16x32_bf16 v[120:123], v[208:211], v[144:147], v[120:123]
    v_mfma_f32_16x16x32_bf16 v[124:127], v[212:215], v[144:147], v[124:127]
    v_mfma_f32_16x16x32_bf16 v[128:131], v[216:219], v[144:147], v[128:131]
    s_lshl_b32 s57, s72, 10
    s_add_u32 s57, s57, s61
    buffer_load_dwordx4 v[132:135], v32, s[36:39], s57 offen sc1
    s_add_u32 s72, s72, 1
    s_and_b32 s72, s72, 15
    buffer_load_dwordx4 v[136:139], v33, s[36:39], s57 offen sc1
    s_waitcnt vmcnt(31)
    s_waitcnt lgkmcnt(10)
    v_mfma_f32_16x16x32_bf16 v[36:39], v[220:223], v[148:151], v[36:39]
    s_waitcnt lgkmcnt(8)
    v_mfma_f32_16x16x32_bf16 v[40:43], v[224:227], v[148:151], v[40:43]
    buffer_load_dwordx4 v[140:143], v34, s[36:39], s57 offen sc1
    s_waitcnt lgkmcnt(6)
    v_mfma_f32_16x16x32_bf16 v[44:47], v[228:231], v[148:151], v[44:47]
    s_waitcnt lgkmcnt(4)
    v_mfma_f32_16x16x32_bf16 v[48:51], v[232:235], v[148:151], v[48:51]
    buffer_load_dwordx4 v[144:147], v35, s[36:39], s57 offen sc1
    s_waitcnt lgkmcnt(2)
    v_mfma_f32_16x16x32_bf16 v[52:55], v[236:239], v[148:151], v[52:55]
    s_waitcnt lgkmcnt(0)
    v_mfma_f32_16x16x32_bf16 v[56:59], v[240:243], v[148:151], v[56:59]
    s_waitcnt vmcnt(32)
    v_mfma_f32_16x16x32_bf16 v[60:63], v[220:223], v[152:155], v[60:63]
    ds_read_b64_tr_b16 v[196:197], v27 offset:6144
    s_mul_i32 s58, s71, 88064
    s_add_u32 s58, s58, s60
    s_add_u32 s71, s71, 1
    s_and_b32 s71, s71, 15
    s_add_u32 m0, s59, 0
    s_nop 0
    buffer_load_dwordx4 v24, s[32:35], s58 offen lds
    v_mfma_f32_16x16x32_bf16 v[64:67], v[224:227], v[152:155], v[64:67]
    ds_read_b64_tr_b16 v[198:199], v27 offset:9216
    v_mfma_f32_16x16x32_bf16 v[68:71], v[228:231], v[152:155], v[68:71]
    ds_read_b64_tr_b16 v[200:201], v28 offset:6144
    buffer_load_dwordx4 v25, s[32:35], s58 offen offset:1024 lds
    v_mfma_f32_16x16x32_bf16 v[72:75], v[232:235], v[152:155], v[72:75]
    ds_read_b64_tr_b16 v[202:203], v28 offset:9216
    v_mfma_f32_16x16x32_bf16 v[76:79], v[236:239], v[152:155], v[76:79]
    ds_read_b64_tr_b16 v[204:205], v27 offset:6208
    buffer_load_dwordx4 v26, s[32:35], s58 offen offset:2048 lds
    v_mfma_f32_16x16x32_bf16 v[80:83], v[240:243], v[152:155], v[80:83]
    ds_read_b64_tr_b16 v[206:207], v27 offset:9280
    s_waitcnt vmcnt(34)
    v_mfma_f32_16x16x32_bf16 v[84:87], v[220:223], v[156:159], v[84:87]
    ds_read_b64_tr_b16 v[208:209], v28 offset:6208
    s_add_u32 s58, s58, 44032
    s_add_u32 m0, s59, 3072
    s_nop 0
    buffer_load_dwordx4 v24, s[32:35], s58 offen lds
    v_mfma_f32_16x16x32_bf16 v[88:91], v[224:227], v[156:159], v[88:91]
    ds_read_b64_tr_b16 v[210:211], v28 offset:9280
    v_mfma_f32_16x16x32_bf16 v[92:95], v[228:231], v[156:159], v[92:95]
    ds_read_b64_tr_b16 v[212:213], v27 offset:6272
    buffer_load_dwordx4 v25, s[32:35], s58 offen offset:1024 lds
    v_mfma_f32_16x16x32_bf16 v[96:99], v[232:235], v[156:159], v[96:99]
    ds_read_b64_tr_b16 v[214:215], v27 offset:9344
    v_mfma_f32_16x16x32_bf16 v[100:103], v[236:239], v[156:159], v[100:103]
    ds_read_b64_tr_b16 v[216:217], v28 offset:6272
    buffer_load_dwordx4 v26, s[32:35], s58 offen offset:2048 lds
    v_mfma_f32_16x16x32_bf16 v[104:107], v[240:243], v[156:159], v[104:107]
    ds_read_b64_tr_b16 v[218:219], v28 offset:9344
    s_waitcnt vmcnt(36)
    v_mfma_f32_16x16x32_bf16 v[108:111], v[220:223], v[160:163], v[108:111]
    v_mfma_f32_16x16x32_bf16 v[112:115], v[224:227], v[160:163], v[112:115]
    v_mfma_f32_16x16x32_bf16 v[116:119], v[228:231], v[160:163], v[116:119]
    v_mfma_f32_16x16x32_bf16 v[120:123], v[232:235], v[160:163], v[120:123]
    v_mfma_f32_16x16x32_bf16 v[124:127], v[236:239], v[160:163], v[124:127]
    v_mfma_f32_16x16x32_bf16 v[128:131], v[240:243], v[160:163], v[128:131]
    s_waitcnt vmcnt(30)
    s_lshl_b32 s57, s72, 10
    s_add_u32 s57, s57, s61
    buffer_load_dwordx4 v[148:151], v32, s[36:39], s57 offen sc1
    s_add_u32 s72, s72, 1
    s_and_b32 s72, s72, 15
    buffer_load_dwordx4 v[152:155], v33, s[36:39], s57 offen sc1
    s_waitcnt vmcnt(31)
    s_waitcnt lgkmcnt(10)
    v_mfma_f32_16x16x32_bf16 v[36:39], v[196:199], v[164:167], v[36:39]
    s_waitcnt lgkmcnt(8)
    v_mfma_f32_16x16x32_bf16 v[40:43], v[200:203], v[164:167], v[40:43]
    buffer_load_dwordx4 v[156:159], v34, s[36:39], s57 offen sc1
    s_waitcnt lgkmcnt(6)
    v_mfma_f32_16x16x32_bf16 v[44:47], v[204:207], v[164:167], v[44:47]
    s_waitcnt lgkmcnt(4)
    v_mfma_f32_16x16x32_bf16 v[48:51], v[208:211], v[164:167], v[48:51]
    buffer_load_dwordx4 v[160:163], v35, s[36:39], s57 offen sc1
    s_waitcnt lgkmcnt(2)
    v_mfma_f32_16x16x32_bf16 v[52:55], v[212:215], v[164:167], v[52:55]
    s_waitcnt lgkmcnt(0)
    v_mfma_f32_16x16x32_bf16 v[56:59], v[216:219], v[164:167], v[56:59]
    s_waitcnt vmcnt(32)
    v_mfma_f32_16x16x32_bf16 v[60:63], v[196:199], v[168:171], v[60:63]
    ds_read_b64_tr_b16 v[220:221], v27 offset:12288
    s_mul_i32 s58, s71, 88064
    s_add_u32 s58, s58, s60
    s_add_u32 s71, s71, 1
    s_and_b32 s71, s71, 15
    s_add_u32 m0, s59, 6144
    s_nop 0
    buffer_load_dwordx4 v24, s[32:35], s58 offen lds
    v_mfma_f32_16x16x32_bf16 v[64:67], v[200:203], v[168:171], v[64:67]
    ds_read_b64_tr_b16 v[222:223], v27 offset:15360
    v_mfma_f32_16x16x32_bf16 v[68:71], v[204:207], v[168:171], v[68:71]
    ds_read_b64_tr_b16 v[224:225], v28 offset:12288
    buffer_load_dwordx4 v25, s[32:35], s58 offen offset:1024 lds
    v_mfma_f32_16x16x32_bf16 v[72:75], v[208:211], v[168:171], v[72:75]
    ds_read_b64_tr_b16 v[226:227], v28 offset:15360
    v_mfma_f32_16x16x32_bf16 v[76:79], v[212:215], v[168:171], v[76:79]
    ds_read_b64_tr_b16 v[228:229], v27 offset:12352
    buffer_load_dwordx4 v26, s[32:35], s58 offen offset:2048 lds
    v_mfma_f32_16x16x32_bf16 v[80:83], v[216:219], v[168:171], v[80:83]
    ds_read_b64_tr_b16 v[230:231], v27 offset:15424
    s_waitcnt vmcnt(34)
    v_mfma_f32_16x16x32_bf16 v[84:87], v[196:199], v[172:175], v[84:87]
    ds_read_b64_tr_b16 v[232:233], v28 offset:12352
    s_add_u32 s58, s58, 44032
    s_add_u32 m0, s59, 9216
    s_nop 0
    buffer_load_dwordx4 v24, s[32:35], s58 offen lds
    v_mfma_f32_16x16x32_bf16 v[88:91], v[200:203], v[172:175], v[88:91]
    ds_read_b64_tr_b16 v[234:235], v28 offset:15424
    v_mfma_f32_16x16x32_bf16 v[92:95], v[204:207], v[172:175], v[92:95]
    ds_read_b64_tr_b16 v[236:237], v27 offset:12416
    buffer_load_dwordx4 v25, s[32:35], s58 offen offset:1024 lds
    v_mfma_f32_16x16x32_bf16 v[96:99], v[208:211], v[172:175], v[96:99]
    ds_read_b64_tr_b16 v[238:239], v27 offset:15488
    v_mfma_f32_16x16x32_bf16 v[100:103], v[212:215], v[172:175], v[100:103]
    ds_read_b64_tr_b16 v[240:241], v28 offset:12416
    buffer_load_dwordx4 v26, s[32:35], s58 offen offset:2048 lds
    v_mfma_f32_16x16x32_bf16 v[104:107], v[216:219], v[172:175], v[104:107]
    ds_read_b64_tr_b16 v[242:243], v28 offset:15488
    s_waitcnt vmcnt(36)
    v_mfma_f32_16x16x32_bf16 v[108:111], v[196:199], v[176:179], v[108:111]
    v_mfma_f32_16x16x32_bf16 v[112:115], v[200:203], v[176:179], v[112:115]
    v_mfma_f32_16x16x32_bf16 v[116:119], v[204:207], v[176:179], v[116:119]
    v_mfma_f32_16x16x32_bf16 v[120:123], v[208:211], v[176:179], v[120:123]
    v_mfma_f32_16x16x32_bf16 v[124:127], v[212:215], v[176:179], v[124:127]
    v_mfma_f32_16x16x32_bf16 v[128:131], v[216:219], v[176:179], v[128:131]
    s_waitcnt vmcnt(30)
    s_lshl_b32 s57, s72, 10
    s_add_u32 s57, s57, s61
    buffer_load_dwordx4 v[164:167], v32, s[36:39], s57 offen sc1
    s_add_u32 s72, s72, 1
    s_and_b32 s72, s72, 15
    buffer_load_dwordx4 v[168:171], v33, s[36:39], s57 offen sc1
    s_waitcnt vmcnt(31)
    s_waitcnt lgkmcnt(10)
    v_mfma_f32_16x16x32_bf16 v[36:39], v[220:223], v[180:183], v[36:39]
    s_waitcnt lgkmcnt(8)
    v_mfma_f32_16x16x32_bf16 v[40:43], v[224:227], v[180:183], v[40:43]
    buffer_load_dwordx4 v[172:175], v34, s[36:39], s57 offen sc1
    s_waitcnt lgkmcnt(6)
    v_mfma_f32_16x16x32_bf16 v[44:47], v[228:231], v[180:183], v[44:47]
    s_waitcnt lgkmcnt(4)
    v_mfma_f32_16x16x32_bf16 v[48:51], v[232:235], v[180:183], v[48:51]
    buffer_load_dwordx4 v[176:179], v35, s[36:39], s57 offen sc1
    s_waitcnt lgkmcnt(2)
    v_mfma_f32_16x16x32_bf16 v[52:55], v[236:239], v[180:183], v[52:55]
    s_waitcnt lgkmcnt(0)
    v_mfma_f32_16x16x32_bf16 v[56:59], v[240:243], v[180:183], v[56:59]
    s_waitcnt vmcnt(32)
    v_mfma_f32_16x16x32_bf16 v[60:63], v[220:223], v[184:187], v[60:63]
    ds_read_b64_tr_b16 v[196:197], v27 offset:18432
    s_mul_i32 s58, s71, 88064
    s_add_u32 s58, s58, s60
    s_add_u32 s71, s71, 1
    s_and_b32 s71, s71, 15
    s_add_u32 m0, s59, 12288
    s_nop 0
    buffer_load_dwordx4 v24, s[32:35], s58 offen nt lds
    v_mfma_f32_16x16x32_bf16 v[64:67], v[224:227], v[184:187], v[64:67]
    ds_read_b64_tr_b16 v[198:199], v27 offset:21504
    v_mfma_f32_16x16x32_bf16 v[68:71], v[228:231], v[184:187], v[68:71]
    ds_read_b64_tr_b16 v[200:201], v28 offset:18432
    buffer_load_dwordx4 v25, s[32:35], s58 offen offset:1024 nt lds
    v_mfma_f32_16x16x32_bf16 v[72:75], v[232:235], v[184:187], v[72:75]
    ds_read_b64_tr_b16 v[202:203], v28 offset:21504
    v_mfma_f32_16x16x32_bf16 v[76:79], v[236:239], v[184:187], v[76:79]
    ds_read_b64_tr_b16 v[204:205], v27 offset:18496
    buffer_load_dwordx4 v26, s[32:35], s58 offen offset:2048 nt lds
    v_mfma_f32_16x16x32_bf16 v[80:83], v[240:243], v[184:187], v[80:83]
    ds_read_b64_tr_b16 v[206:207], v27 offset:21568
    s_waitcnt vmcnt(34)
    v_mfma_f32_16x16x32_bf16 v[84:87], v[220:223], v[188:191], v[84:87]
    ds_read_b64_tr_b16 v[208:209], v28 offset:18496
    s_add_u32 s58, s58, 44032
    s_add_u32 m0, s59, 15360
    s_nop 0
    buffer_load_dwordx4 v24, s[32:35], s58 offen nt lds
    v_mfma_f32_16x16x32_bf16 v[88:91], v[224:227], v[188:191], v[88:91]
    ds_read_b64_tr_b16 v[210:211], v28 offset:21568
    v_mfma_f32_16x16x32_bf16 v[92:95], v[228:231], v[188:191], v[92:95]
    ds_read_b64_tr_b16 v[212:213], v27 offset:18560
    buffer_load_dwordx4 v25, s[32:35], s58 offen offset:1024 nt lds
    v_mfma_f32_16x16x32_bf16 v[96:99], v[232:235], v[188:191], v[96:99]
    ds_read_b64_tr_b16 v[214:215], v27 offset:21632
    v_mfma_f32_16x16x32_bf16 v[100:103], v[236:239], v[188:191], v[100:103]
    ds_read_b64_tr_b16 v[216:217], v28 offset:18560
    buffer_load_dwordx4 v26, s[32:35], s58 offen offset:2048 nt lds
    v_mfma_f32_16x16x32_bf16 v[104:107], v[240:243], v[188:191], v[104:107]
    ds_read_b64_tr_b16 v[218:219], v28 offset:21632
    s_waitcnt vmcnt(36)
    v_mfma_f32_16x16x32_bf16 v[108:111], v[220:223], v[192:195], v[108:111]
    v_mfma_f32_16x16x32_bf16 v[112:115], v[224:227], v[192:195], v[112:115]
    v_mfma_f32_16x16x32_bf16 v[116:119], v[228:231], v[192:195], v[116:119]
    v_mfma_f32_16x16x32_bf16 v[120:123], v[232:235], v[192:195], v[120:123]
    v_mfma_f32_16x16x32_bf16 v[124:127], v[236:239], v[192:195], v[124:127]
    v_mfma_f32_16x16x32_bf16 v[128:131], v[240:243], v[192:195], v[128:131]
    s_waitcnt vmcnt(30)
    s_lshl_b32 s57, s72, 10
    s_add_u32 s57, s57, s61
    buffer_load_dwordx4 v[180:183], v32, s[36:39], s57 offen sc1
    s_add_u32 s72, s72, 1
    s_and_b32 s72, s72, 15
    buffer_load_dwordx4 v[184:187], v33, s[36:39], s57 offen sc1
    s_waitcnt vmcnt(31)
    s_waitcnt lgkmcnt(10)
    v_mfma_f32_16x16x32_bf16 v[36:39], v[196:199], v[132:135], v[36:39]
    s_waitcnt lgkmcnt(8)
    v_mfma_f32_16x16x32_bf16 v[40:43], v[200:203], v[132:135], v[40:43]
    buffer_load_dwordx4 v[188:191], v34, s[36:39], s57 offen sc1
    s_waitcnt lgkmcnt(6)
    v_mfma_f32_16x16x32_bf16 v[44:47], v[204:207], v[132:135], v[44:47]
    s_waitcnt lgkmcnt(4)
    v_mfma_f32_16x16x32_bf16 v[48:51], v[208:211], v[132:135], v[48:51]
    buffer_load_dwordx4 v[192:195], v35, s[36:39], s57 offen sc1
    s_waitcnt lgkmcnt(2)
    v_mfma_f32_16x16x32_bf16 v[52:55], v[212:215], v[132:135], v[52:55]
    s_waitcnt lgkmcnt(0)
    v_mfma_f32_16x16x32_bf16 v[56:59], v[216:219], v[132:135], v[56:59]
    s_waitcnt vmcnt(32)
    v_mfma_f32_16x16x32_bf16 v[60:63], v[196:199], v[136:139], v[60:63]
    ds_read_b64_tr_b16 v[220:221], v29 offset:0
    s_mul_i32 s58, s71, 88064
    s_add_u32 s58, s58, s60
    s_add_u32 s71, s71, 1
    s_and_b32 s71, s71, 15
    s_add_u32 m0, s59, 18432
    s_nop 0
    buffer_load_dwordx4 v24, s[32:35], s58 offen nt lds
    v_mfma_f32_16x16x32_bf16 v[64:67], v[200:203], v[136:139], v[64:67]
    ds_read_b64_tr_b16 v[222:223], v29 offset:3072
    v_mfma_f32_16x16x32_bf16 v[68:71], v[204:207], v[136:139], v[68:71]
    ds_read_b64_tr_b16 v[224:225], v30 offset:0
    buffer_load_dwordx4 v25, s[32:35], s58 offen offset:1024 nt lds
    v_mfma_f32_16x16x32_bf16 v[72:75], v[208:211], v[136:139], v[72:75]
    ds_read_b64_tr_b16 v[226:227], v30 offset:3072
    v_mfma_f32_16x16x32_bf16 v[76:79], v[212:215], v[136:139], v[76:79]
    ds_read_b64_tr_b16 v[228:229], v29 offset:64
    buffer_load_dwordx4 v26, s[32:35], s58 offen offset:2048 nt lds
    v_mfma_f32_16x16x32_bf16 v[80:83], v[216:219], v[136:139], v[80:83]
    ds_read_b64_tr_b16 v[230:231], v29 offset:3136
    s_waitcnt vmcnt(34)
    v_mfma_f32_16x16x32_bf16 v[84:87], v[196:199], v[140:143], v[84:87]
    ds_read_b64_tr_b16 v[232:233], v30 offset:64
    s_add_u32 s58, s58, 44032
    s_add_u32 m0, s59, 21504
    s_nop 0
    buffer_load_dwordx4 v24, s[32:35], s58 offen nt lds
    v_mfma_f32_16x16x32_bf16 v[88:91], v[200:203], v[140:143], v[88:91]
    ds_read_b64_tr_b16 v[234:235], v30 offset:3136
    v_mfma_f32_16x16x32_bf16 v[92:95], v[204:207], v[140:143], v[92:95]
    ds_read_b64_tr_b16 v[236:237], v29 offset:128
    buffer_load_dwordx4 v25, s[32:35], s58 offen offset:1024 nt lds
    v_mfma_f32_16x16x32_bf16 v[96:99], v[208:211], v[140:143], v[96:99]
    ds_read_b64_tr_b16 v[238:239], v29 offset:3200
    v_mfma_f32_16x16x32_bf16 v[100:103], v[212:215], v[140:143], v[100:103]
    ds_read_b64_tr_b16 v[240:241], v30 offset:128
    buffer_load_dwordx4 v26, s[32:35], s58 offen offset:2048 nt lds
    v_mfma_f32_16x16x32_bf16 v[104:107], v[216:219], v[140:143], v[104:107]
    ds_read_b64_tr_b16 v[242:243], v30 offset:3200
    s_waitcnt vmcnt(36)
    v_mfma_f32_16x16x32_bf16 v[108:111], v[196:199], v[144:147], v[108:111]
    v_mfma_f32_16x16x32_bf16 v[112:115], v[200:203], v[144:147], v[112:115]
    v_mfma_f32_16x16x32_bf16 v[116:119], v[204:207], v[144:147], v[116:119]
    v_mfma_f32_16x16x32_bf16 v[120:123], v[208:211], v[144:147], v[120:123]
    v_mfma_f32_16x16x32_bf16 v[124:127], v[212:215], v[144:147], v[124:127]
    v_mfma_f32_16x16x32_bf16 v[128:131], v[216:219], v[144:147], v[128:131]
    s_waitcnt vmcnt(30)
    s_lshl_b32 s57, s72, 10
    s_add_u32 s57, s57, s61
    buffer_load_dwordx4 v[132:135], v32, s[36:39], s57 offen sc1 nt
    s_add_u32 s72, s72, 1
    s_and_b32 s72, s72, 15
    buffer_load_dwordx4 v[136:139], v33, s[36:39], s57 offen sc1 nt
    s_waitcnt vmcnt(31)
    s_waitcnt lgkmcnt(10)
    v_mfma_f32_16x16x32_bf16 v[36:39], v[220:223], v[148:151], v[36:39]
    s_waitcnt lgkmcnt(8)
    v_mfma_f32_16x16x32_bf16 v[40:43], v[224:227], v[148:151], v[40:43]
    buffer_load_dwordx4 v[140:143], v34, s[36:39], s57 offen sc1 nt
    s_waitcnt lgkmcnt(6)
    v_mfma_f32_16x16x32_bf16 v[44:47], v[228:231], v[148:151], v[44:47]
    s_waitcnt lgkmcnt(4)
    v_mfma_f32_16x16x32_bf16 v[48:51], v[232:235], v[148:151], v[48:51]
    buffer_load_dwordx4 v[144:147], v35, s[36:39], s57 offen sc1 nt
    s_waitcnt lgkmcnt(2)
    v_mfma_f32_16x16x32_bf16 v[52:55], v[236:239], v[148:151], v[52:55]
    s_waitcnt lgkmcnt(0)
    v_mfma_f32_16x16x32_bf16 v[56:59], v[240:243], v[148:151], v[56:59]
    s_waitcnt vmcnt(32)
    v_mfma_f32_16x16x32_bf16 v[60:63], v[220:223], v[152:155], v[60:63]
    ds_read_b64_tr_b16 v[196:197], v27 offset:0
    s_mul_i32 s58, s71, 88064
    s_add_u32 s58, s58, s60
    s_add_u32 s71, s71, 1
    s_and_b32 s71, s71, 15
    s_add_u32 m0, s80, 0
    s_nop 0
    buffer_load_dwordx4 v24, s[32:35], s58 offen nt lds
    v_mfma_f32_16x16x32_bf16 v[64:67], v[224:227], v[152:155], v[64:67]
    ds_read_b64_tr_b16 v[198:199], v27 offset:3072
    v_mfma_f32_16x16x32_bf16 v[68:71], v[228:231], v[152:155], v[68:71]
    ds_read_b64_tr_b16 v[200:201], v28 offset:0
    buffer_load_dwordx4 v25, s[32:35], s58 offen offset:1024 nt lds
    v_mfma_f32_16x16x32_bf16 v[72:75], v[232:235], v[152:155], v[72:75]
    ds_read_b64_tr_b16 v[202:203], v28 offset:3072
    v_mfma_f32_16x16x32_bf16 v[76:79], v[236:239], v[152:155], v[76:79]
    ds_read_b64_tr_b16 v[204:205], v27 offset:64
    buffer_load_dwordx4 v26, s[32:35], s58 offen offset:2048 nt lds
    v_mfma_f32_16x16x32_bf16 v[80:83], v[240:243], v[152:155], v[80:83]
    ds_read_b64_tr_b16 v[206:207], v27 offset:3136
    s_waitcnt vmcnt(34)
    v_mfma_f32_16x16x32_bf16 v[84:87], v[220:223], v[156:159], v[84:87]
    ds_read_b64_tr_b16 v[208:209], v28 offset:64
    s_add_u32 s58, s58, 44032
    s_add_u32 m0, s80, 3072
    s_nop 0
    buffer_load_dwordx4 v24, s[32:35], s58 offen nt lds
    v_mfma_f32_16x16x32_bf16 v[88:91], v[224:227], v[156:159], v[88:91]
    ds_read_b64_tr_b16 v[210:211], v28 offset:3136
    v_mfma_f32_16x16x32_bf16 v[92:95], v[228:231], v[156:159], v[92:95]
    ds_read_b64_tr_b16 v[212:213], v27 offset:128
    buffer_load_dwordx4 v25, s[32:35], s58 offen offset:1024 nt lds
    v_mfma_f32_16x16x32_bf16 v[96:99], v[232:235], v[156:159], v[96:99]
    ds_read_b64_tr_b16 v[214:215], v27 offset:3200
    v_mfma_f32_16x16x32_bf16 v[100:103], v[236:239], v[156:159], v[100:103]
    ds_read_b64_tr_b16 v[216:217], v28 offset:128
    buffer_load_dwordx4 v26, s[32:35], s58 offen offset:2048 nt lds
    v_mfma_f32_16x16x32_bf16 v[104:107], v[240:243], v[156:159], v[104:107]
    ds_read_b64_tr_b16 v[218:219], v28 offset:3200
    s_waitcnt vmcnt(36)
    v_mfma_f32_16x16x32_bf16 v[108:111], v[220:223], v[160:163], v[108:111]
    v_mfma_f32_16x16x32_bf16 v[112:115], v[224:227], v[160:163], v[112:115]
    v_mfma_f32_16x16x32_bf16 v[116:119], v[228:231], v[160:163], v[116:119]
    v_mfma_f32_16x16x32_bf16 v[120:123], v[232:235], v[160:163], v[120:123]
    v_mfma_f32_16x16x32_bf16 v[124:127], v[236:239], v[160:163], v[124:127]
    v_mfma_f32_16x16x32_bf16 v[128:131], v[240:243], v[160:163], v[128:131]
    s_waitcnt vmcnt(30)
    s_lshl_b32 s57, s72, 10
    s_add_u32 s57, s57, s61
    buffer_load_dwordx4 v[148:151], v32, s[36:39], s57 offen sc1 nt
    s_add_u32 s72, s72, 1
    s_and_b32 s72, s72, 15
    buffer_load_dwordx4 v[152:155], v33, s[36:39], s57 offen sc1 nt
    s_waitcnt vmcnt(31)
    s_waitcnt lgkmcnt(10)
    v_mfma_f32_16x16x32_bf16 v[36:39], v[196:199], v[164:167], v[36:39]
    s_waitcnt lgkmcnt(8)
    v_mfma_f32_16x16x32_bf16 v[40:43], v[200:203], v[164:167], v[40:43]
    buffer_load_dwordx4 v[156:159], v34, s[36:39], s57 offen sc1 nt
    s_waitcnt lgkmcnt(6)
    v_mfma_f32_16x16x32_bf16 v[44:47], v[204:207], v[164:167], v[44:47]
    s_waitcnt lgkmcnt(4)
    v_mfma_f32_16x16x32_bf16 v[48:51], v[208:211], v[164:167], v[48:51]
    buffer_load_dwordx4 v[160:163], v35, s[36:39], s57 offen sc1 nt
    s_waitcnt lgkmcnt(2)
    v_mfma_f32_16x16x32_bf16 v[52:55], v[212:215], v[164:167], v[52:55]
    s_waitcnt lgkmcnt(0)
    v_mfma_f32_16x16x32_bf16 v[56:59], v[216:219], v[164:167], v[56:59]
    s_waitcnt vmcnt(32)
    v_mfma_f32_16x16x32_bf16 v[60:63], v[196:199], v[168:171], v[60:63]
    ds_read_b64_tr_b16 v[220:221], v27 offset:6144
    s_mul_i32 s58, s71, 88064
    s_add_u32 s58, s58, s60
    s_add_u32 s71, s71, 1
    s_and_b32 s71, s71, 15
    s_add_u32 m0, s59, 0
    s_nop 0
    buffer_load_dwordx4 v24, s[32:35], s58 offen nt lds
    v_mfma_f32_16x16x32_bf16 v[64:67], v[200:203], v[168:171], v[64:67]
    ds_read_b64_tr_b16 v[222:223], v27 offset:9216
    v_mfma_f32_16x16x32_bf16 v[68:71], v[204:207], v[168:171], v[68:71]
    ds_read_b64_tr_b16 v[224:225], v28 offset:6144
    buffer_load_dwordx4 v25, s[32:35], s58 offen offset:1024 nt lds
    v_mfma_f32_16x16x32_bf16 v[72:75], v[208:211], v[168:171], v[72:75]
    ds_read_b64_tr_b16 v[226:227], v28 offset:9216
    v_mfma_f32_16x16x32_bf16 v[76:79], v[212:215], v[168:171], v[76:79]
    ds_read_b64_tr_b16 v[228:229], v27 offset:6208
    buffer_load_dwordx4 v26, s[32:35], s58 offen offset:2048 nt lds
    v_mfma_f32_16x16x32_bf16 v[80:83], v[216:219], v[168:171], v[80:83]
    ds_read_b64_tr_b16 v[230:231], v27 offset:9280
    s_waitcnt vmcnt(34)
    v_mfma_f32_16x16x32_bf16 v[84:87], v[196:199], v[172:175], v[84:87]
    ds_read_b64_tr_b16 v[232:233], v28 offset:6208
    s_add_u32 s58, s58, 44032
    s_add_u32 m0, s59, 3072
    s_nop 0
    buffer_load_dwordx4 v24, s[32:35], s58 offen nt lds
    v_mfma_f32_16x16x32_bf16 v[88:91], v[200:203], v[172:175], v[88:91]
    ds_read_b64_tr_b16 v[234:235], v28 offset:9280
    v_mfma_f32_16x16x32_bf16 v[92:95], v[204:207], v[172:175], v[92:95]
    ds_read_b64_tr_b16 v[236:237], v27 offset:6272
    buffer_load_dwordx4 v25, s[32:35], s58 offen offset:1024 nt lds
    v_mfma_f32_16x16x32_bf16 v[96:99], v[208:211], v[172:175], v[96:99]
    ds_read_b64_tr_b16 v[238:239], v27 offset:9344
    v_mfma_f32_16x16x32_bf16 v[100:103], v[212:215], v[172:175], v[100:103]
    ds_read_b64_tr_b16 v[240:241], v28 offset:6272
    buffer_load_dwordx4 v26, s[32:35], s58 offen offset:2048 nt lds
    v_mfma_f32_16x16x32_bf16 v[104:107], v[216:219], v[172:175], v[104:107]
    ds_read_b64_tr_b16 v[242:243], v28 offset:9344
    s_waitcnt vmcnt(36)
    v_mfma_f32_16x16x32_bf16 v[108:111], v[196:199], v[176:179], v[108:111]
    v_mfma_f32_16x16x32_bf16 v[112:115], v[200:203], v[176:179], v[112:115]
    v_mfma_f32_16x16x32_bf16 v[116:119], v[204:207], v[176:179], v[116:119]
    v_mfma_f32_16x16x32_bf16 v[120:123], v[208:211], v[176:179], v[120:123]
    v_mfma_f32_16x16x32_bf16 v[124:127], v[212:215], v[176:179], v[124:127]
    v_mfma_f32_16x16x32_bf16 v[128:131], v[216:219], v[176:179], v[128:131]
    s_waitcnt vmcnt(30)
    s_lshl_b32 s57, s72, 10
    s_add_u32 s57, s57, s61
    buffer_load_dwordx4 v[164:167], v32, s[36:39], s57 offen sc1 nt
    s_add_u32 s72, s72, 1
    s_and_b32 s72, s72, 15
    buffer_load_dwordx4 v[168:171], v33, s[36:39], s57 offen sc1 nt
    s_waitcnt vmcnt(31)
    s_waitcnt lgkmcnt(10)
    v_mfma_f32_16x16x32_bf16 v[36:39], v[220:223], v[180:183], v[36:39]
    s_waitcnt lgkmcnt(8)
    v_mfma_f32_16x16x32_bf16 v[40:43], v[224:227], v[180:183], v[40:43]
    buffer_load_dwordx4 v[172:175], v34, s[36:39], s57 offen sc1 nt
    s_waitcnt lgkmcnt(6)
    v_mfma_f32_16x16x32_bf16 v[44:47], v[228:231], v[180:183], v[44:47]
    s_waitcnt lgkmcnt(4)
    v_mfma_f32_16x16x32_bf16 v[48:51], v[232:235], v[180:183], v[48:51]
    buffer_load_dwordx4 v[176:179], v35, s[36:39], s57 offen sc1 nt
    s_waitcnt lgkmcnt(2)
    v_mfma_f32_16x16x32_bf16 v[52:55], v[236:239], v[180:183], v[52:55]
    s_waitcnt lgkmcnt(0)
    v_mfma_f32_16x16x32_bf16 v[56:59], v[240:243], v[180:183], v[56:59]
    s_waitcnt vmcnt(32)
    v_mfma_f32_16x16x32_bf16 v[60:63], v[220:223], v[184:187], v[60:63]
    ds_read_b64_tr_b16 v[196:197], v27 offset:12288
    v_mfma_f32_16x16x32_bf16 v[64:67], v[224:227], v[184:187], v[64:67]
    ds_read_b64_tr_b16 v[198:199], v27 offset:15360
    v_mfma_f32_16x16x32_bf16 v[68:71], v[228:231], v[184:187], v[68:71]
    ds_read_b64_tr_b16 v[200:201], v28 offset:12288
    v_mfma_f32_16x16x32_bf16 v[72:75], v[232:235], v[184:187], v[72:75]
    ds_read_b64_tr_b16 v[202:203], v28 offset:15360
    v_mfma_f32_16x16x32_bf16 v[76:79], v[236:239], v[184:187], v[76:79]
    ds_read_b64_tr_b16 v[204:205], v27 offset:12352
    v_mfma_f32_16x16x32_bf16 v[80:83], v[240:243], v[184:187], v[80:83]
    ds_read_b64_tr_b16 v[206:207], v27 offset:15424
    s_waitcnt vmcnt(31)
    v_mfma_f32_16x16x32_bf16 v[84:87], v[220:223], v[188:191], v[84:87]
    ds_read_b64_tr_b16 v[208:209], v28 offset:12352
    v_mfma_f32_16x16x32_bf16 v[88:91], v[224:227], v[188:191], v[88:91]
    ds_read_b64_tr_b16 v[210:211], v28 offset:15424
    v_mfma_f32_16x16x32_bf16 v[92:95], v[228:231], v[188:191], v[92:95]
    ds_read_b64_tr_b16 v[212:213], v27 offset:12416
    v_mfma_f32_16x16x32_bf16 v[96:99], v[232:235], v[188:191], v[96:99]
    ds_read_b64_tr_b16 v[214:215], v27 offset:15488
    v_mfma_f32_16x16x32_bf16 v[100:103], v[236:239], v[188:191], v[100:103]
    ds_read_b64_tr_b16 v[216:217], v28 offset:12416
    v_mfma_f32_16x16x32_bf16 v[104:107], v[240:243], v[188:191], v[104:107]
    ds_read_b64_tr_b16 v[218:219], v28 offset:15488
    s_waitcnt vmcnt(30)
    v_mfma_f32_16x16x32_bf16 v[108:111], v[220:223], v[192:195], v[108:111]
    v_mfma_f32_16x16x32_bf16 v[112:115], v[224:227], v[192:195], v[112:115]
    v_mfma_f32_16x16x32_bf16 v[116:119], v[228:231], v[192:195], v[116:119]
    v_mfma_f32_16x16x32_bf16 v[120:123], v[232:235], v[192:195], v[120:123]
    v_mfma_f32_16x16x32_bf16 v[124:127], v[236:239], v[192:195], v[124:127]
    v_mfma_f32_16x16x32_bf16 v[128:131], v[240:243], v[192:195], v[128:131]
    s_waitcnt vmcnt(24)
    s_lshl_b32 s57, s72, 10
    s_add_u32 s57, s57, s61
    buffer_load_dwordx4 v[180:183], v32, s[36:39], s57 offen sc1 nt
    s_add_u32 s72, s72, 1
    s_and_b32 s72, s72, 15
    buffer_load_dwordx4 v[184:187], v33, s[36:39], s57 offen sc1 nt
    s_waitcnt vmcnt(25)
    s_waitcnt lgkmcnt(10)
    v_mfma_f32_16x16x32_bf16 v[36:39], v[196:199], v[132:135], v[36:39]
    s_waitcnt lgkmcnt(8)
    v_mfma_f32_16x16x32_bf16 v[40:43], v[200:203], v[132:135], v[40:43]
    buffer_load_dwordx4 v[188:191], v34, s[36:39], s57 offen sc1 nt
    s_waitcnt lgkmcnt(6)
    v_mfma_f32_16x16x32_bf16 v[44:47], v[204:207], v[132:135], v[44:47]
    s_waitcnt lgkmcnt(4)
    v_mfma_f32_16x16x32_bf16 v[48:51], v[208:211], v[132:135], v[48:51]
    buffer_load_dwordx4 v[192:195], v35, s[36:39], s57 offen sc1 nt
    s_waitcnt lgkmcnt(2)
    v_mfma_f32_16x16x32_bf16 v[52:55], v[212:215], v[132:135], v[52:55]
    s_waitcnt lgkmcnt(0)
    v_mfma_f32_16x16x32_bf16 v[56:59], v[216:219], v[132:135], v[56:59]
    s_waitcnt vmcnt(26)
    v_mfma_f32_16x16x32_bf16 v[60:63], v[196:199], v[136:139], v[60:63]
    ds_read_b64_tr_b16 v[220:221], v27 offset:18432
    v_mfma_f32_16x16x32_bf16 v[64:67], v[200:203], v[136:139], v[64:67]
    ds_read_b64_tr_b16 v[222:223], v27 offset:21504
    v_mfma_f32_16x16x32_bf16 v[68:71], v[204:207], v[136:139], v[68:71]
    ds_read_b64_tr_b16 v[224:225], v28 offset:18432
    v_mfma_f32_16x16x32_bf16 v[72:75], v[208:211], v[136:139], v[72:75]
    ds_read_b64_tr_b16 v[226:227], v28 offset:21504
    v_mfma_f32_16x16x32_bf16 v[76:79], v[212:215], v[136:139], v[76:79]
    ds_read_b64_tr_b16 v[228:229], v27 offset:18496
    v_mfma_f32_16x16x32_bf16 v[80:83], v[216:219], v[136:139], v[80:83]
    ds_read_b64_tr_b16 v[230:231], v27 offset:21568
    s_waitcnt vmcnt(25)
    v_mfma_f32_16x16x32_bf16 v[84:87], v[196:199], v[140:143], v[84:87]
    ds_read_b64_tr_b16 v[232:233], v28 offset:18496
    v_mfma_f32_16x16x32_bf16 v[88:91], v[200:203], v[140:143], v[88:91]
    ds_read_b64_tr_b16 v[234:235], v28 offset:21568
    v_mfma_f32_16x16x32_bf16 v[92:95], v[204:207], v[140:143], v[92:95]
    ds_read_b64_tr_b16 v[236:237], v27 offset:18560
    v_mfma_f32_16x16x32_bf16 v[96:99], v[208:211], v[140:143], v[96:99]
    ds_read_b64_tr_b16 v[238:239], v27 offset:21632
    v_mfma_f32_16x16x32_bf16 v[100:103], v[212:215], v[140:143], v[100:103]
    ds_read_b64_tr_b16 v[240:241], v28 offset:18560
    v_mfma_f32_16x16x32_bf16 v[104:107], v[216:219], v[140:143], v[104:107]
    ds_read_b64_tr_b16 v[242:243], v28 offset:21632
    s_waitcnt vmcnt(24)
    v_mfma_f32_16x16x32_bf16 v[108:111], v[196:199], v[144:147], v[108:111]
    v_mfma_f32_16x16x32_bf16 v[112:115], v[200:203], v[144:147], v[112:115]
    v_mfma_f32_16x16x32_bf16 v[116:119], v[204:207], v[144:147], v[116:119]
    v_mfma_f32_16x16x32_bf16 v[120:123], v[208:211], v[144:147], v[120:123]
    v_mfma_f32_16x16x32_bf16 v[124:127], v[212:215], v[144:147], v[124:127]
    v_mfma_f32_16x16x32_bf16 v[128:131], v[216:219], v[144:147], v[128:131]
    v_mov_b32 v15, 1
    s_mov_b64 exec, 1
    ds_add_u32 v17, v15 offset:44
    s_mov_b64 exec, -1
    s_waitcnt vmcnt(18)
    s_waitcnt vmcnt(17)
    s_waitcnt lgkmcnt(10)
    v_mfma_f32_16x16x32_bf16 v[36:39], v[220:223], v[148:151], v[36:39]
    s_waitcnt lgkmcnt(8)
    v_mfma_f32_16x16x32_bf16 v[40:43], v[224:227], v[148:151], v[40:43]
    s_waitcnt lgkmcnt(6)
    v_mfma_f32_16x16x32_bf16 v[44:47], v[228:231], v[148:151], v[44:47]
    s_waitcnt lgkmcnt(4)
    v_mfma_f32_16x16x32_bf16 v[48:51], v[232:235], v[148:151], v[48:51]
    s_waitcnt lgkmcnt(2)
    v_mfma_f32_16x16x32_bf16 v[52:55], v[236:239], v[148:151], v[52:55]
    s_waitcnt lgkmcnt(0)
    v_mfma_f32_16x16x32_bf16 v[56:59], v[240:243], v[148:151], v[56:59]
    s_waitcnt vmcnt(16)
    v_mfma_f32_16x16x32_bf16 v[60:63], v[220:223], v[152:155], v[60:63]
    ds_read_b64_tr_b16 v[196:197], v29 offset:0
    v_mfma_f32_16x16x32_bf16 v[64:67], v[224:227], v[152:155], v[64:67]
    ds_read_b64_tr_b16 v[198:199], v29 offset:3072
    v_mfma_f32_16x16x32_bf16 v[68:71], v[228:231], v[152:155], v[68:71]
    ds_read_b64_tr_b16 v[200:201], v30 offset:0
    v_mfma_f32_16x16x32_bf16 v[72:75], v[232:235], v[152:155], v[72:75]
    ds_read_b64_tr_b16 v[202:203], v30 offset:3072
    v_mfma_f32_16x16x32_bf16 v[76:79], v[236:239], v[152:155], v[76:79]
    ds_read_b64_tr_b16 v[204:205], v29 offset:64
    v_mfma_f32_16x16x32_bf16 v[80:83], v[240:243], v[152:155], v[80:83]
    ds_read_b64_tr_b16 v[206:207], v29 offset:3136
    s_waitcnt vmcnt(15)
    v_mfma_f32_16x16x32_bf16 v[84:87], v[220:223], v[156:159], v[84:87]
    ds_read_b64_tr_b16 v[208:209], v30 offset:64
    v_mfma_f32_16x16x32_bf16 v[88:91], v[224:227], v[156:159], v[88:91]
    ds_read_b64_tr_b16 v[210:211], v30 offset:3136
    v_mfma_f32_16x16x32_bf16 v[92:95], v[228:231], v[156:159], v[92:95]
    ds_read_b64_tr_b16 v[212:213], v29 offset:128
    v_mfma_f32_16x16x32_bf16 v[96:99], v[232:235], v[156:159], v[96:99]
    ds_read_b64_tr_b16 v[214:215], v29 offset:3200
    v_mfma_f32_16x16x32_bf16 v[100:103], v[236:239], v[156:159], v[100:103]
    ds_read_b64_tr_b16 v[216:217], v30 offset:128
    v_mfma_f32_16x16x32_bf16 v[104:107], v[240:243], v[156:159], v[104:107]
    ds_read_b64_tr_b16 v[218:219], v30 offset:3200
    s_waitcnt vmcnt(14)
    v_mfma_f32_16x16x32_bf16 v[108:111], v[220:223], v[160:163], v[108:111]
    v_mfma_f32_16x16x32_bf16 v[112:115], v[224:227], v[160:163], v[112:115]
    v_mfma_f32_16x16x32_bf16 v[116:119], v[228:231], v[160:163], v[116:119]
    v_mfma_f32_16x16x32_bf16 v[120:123], v[232:235], v[160:163], v[120:123]
    v_mfma_f32_16x16x32_bf16 v[124:127], v[236:239], v[160:163], v[124:127]
    v_mfma_f32_16x16x32_bf16 v[128:131], v[240:243], v[160:163], v[128:131]
    s_waitcnt vmcnt(8)
    s_waitcnt vmcnt(7)
    s_waitcnt lgkmcnt(10)
    v_mfma_f32_16x16x32_bf16 v[36:39], v[196:199], v[164:167], v[36:39]
    s_waitcnt lgkmcnt(8)
    v_mfma_f32_16x16x32_bf16 v[40:43], v[200:203], v[164:167], v[40:43]
    s_waitcnt lgkmcnt(6)
    v_mfma_f32_16x16x32_bf16 v[44:47], v[204:207], v[164:167], v[44:47]
    s_waitcnt lgkmcnt(4)
    v_mfma_f32_16x16x32_bf16 v[48:51], v[208:211], v[164:167], v[48:51]
    s_waitcnt lgkmcnt(2)
    v_mfma_f32_16x16x32_bf16 v[52:55], v[212:215], v[164:167], v[52:55]
    s_waitcnt lgkmcnt(0)
    v_mfma_f32_16x16x32_bf16 v[56:59], v[216:219], v[164:167], v[56:59]
    s_waitcnt vmcnt(6)
    v_mfma_f32_16x16x32_bf16 v[60:63], v[196:199], v[168:171], v[60:63]
    ds_read_b64_tr_b16 v[220:221], v27 offset:0
    v_mfma_f32_16x16x32_bf16 v[64:67], v[200:203], v[168:171], v[64:67]
    ds_read_b64_tr_b16 v[222:223], v27 offset:3072
    v_mfma_f32_16x16x32_bf16 v[68:71], v[204:207], v[168:171], v[68:71]
    ds_read_b64_tr_b16 v[224:225], v28 offset:0
    v_mfma_f32_16x16x32_bf16 v[72:75], v[208:211], v[168:171], v[72:75]
    ds_read_b64_tr_b16 v[226:227], v28 offset:3072
    v_mfma_f32_16x16x32_bf16 v[76:79], v[212:215], v[168:171], v[76:79]
    ds_read_b64_tr_b16 v[228:229], v27 offset:64
    v_mfma_f32_16x16x32_bf16 v[80:83], v[216:219], v[168:171], v[80:83]
    ds_read_b64_tr_b16 v[230:231], v27 offset:3136
    s_waitcnt vmcnt(5)
    v_mfma_f32_16x16x32_bf16 v[84:87], v[196:199], v[172:175], v[84:87]
    ds_read_b64_tr_b16 v[232:233], v28 offset:64
    v_mfma_f32_16x16x32_bf16 v[88:91], v[200:203], v[172:175], v[88:91]
    ds_read_b64_tr_b16 v[234:235], v28 offset:3136
    v_mfma_f32_16x16x32_bf16 v[92:95], v[204:207], v[172:175], v[92:95]
    ds_read_b64_tr_b16 v[236:237], v27 offset:128
    v_mfma_f32_16x16x32_bf16 v[96:99], v[208:211], v[172:175], v[96:99]
    ds_read_b64_tr_b16 v[238:239], v27 offset:3200
    v_mfma_f32_16x16x32_bf16 v[100:103], v[212:215], v[172:175], v[100:103]
    ds_read_b64_tr_b16 v[240:241], v28 offset:128
    v_mfma_f32_16x16x32_bf16 v[104:107], v[216:219], v[172:175], v[104:107]
    ds_read_b64_tr_b16 v[242:243], v28 offset:3200
    s_waitcnt vmcnt(4)
    v_mfma_f32_16x16x32_bf16 v[108:111], v[196:199], v[176:179], v[108:111]
    v_mfma_f32_16x16x32_bf16 v[112:115], v[200:203], v[176:179], v[112:115]
    v_mfma_f32_16x16x32_bf16 v[116:119], v[204:207], v[176:179], v[116:119]
    v_mfma_f32_16x16x32_bf16 v[120:123], v[208:211], v[176:179], v[120:123]
    v_mfma_f32_16x16x32_bf16 v[124:127], v[212:215], v[176:179], v[124:127]
    v_mfma_f32_16x16x32_bf16 v[128:131], v[216:219], v[176:179], v[128:131]
    v_add_u32 v8, s59, v7
    s_waitcnt vmcnt(2)
    s_waitcnt lgkmcnt(10)
    v_mfma_f32_16x16x32_bf16 v[60:63], v[220:223], v[184:187], v[60:63]
    s_waitcnt lgkmcnt(8)
    v_mfma_f32_16x16x32_bf16 v[64:67], v[224:227], v[184:187], v[64:67]
    s_waitcnt lgkmcnt(6)
    v_mfma_f32_16x16x32_bf16 v[68:71], v[228:231], v[184:187], v[68:71]
    s_waitcnt lgkmcnt(4)
    v_mfma_f32_16x16x32_bf16 v[72:75], v[232:235], v[184:187], v[72:75]
    s_waitcnt lgkmcnt(2)
    v_mfma_f32_16x16x32_bf16 v[76:79], v[236:239], v[184:187], v[76:79]
    s_waitcnt lgkmcnt(0)
    v_mfma_f32_16x16x32_bf16 v[80:83], v[240:243], v[184:187], v[80:83]
    s_waitcnt vmcnt(1)
    v_mfma_f32_16x16x32_bf16 v[84:87], v[220:223], v[188:191], v[84:87]
    ds_write_b128 v8, v[60:63] offset:0
    v_mfma_f32_16x16x32_bf16 v[88:91], v[224:227], v[188:191], v[88:91]
    ds_write_b128 v8, v[64:67] offset:1024
    v_mfma_f32_16x16x32_bf16 v[92:95], v[228:231], v[188:191], v[92:95]
    ds_write_b128 v8, v[68:71] offset:2048
    v_mfma_f32_16x16x32_bf16 v[96:99], v[232:235], v[188:191], v[96:99]
    ds_write_b128 v8, v[72:75] offset:3072
    v_mfma_f32_16x16x32_bf16 v[100:103], v[236:239], v[188:191], v[100:103]
    ds_write_b128 v8, v[76:79] offset:4096
    v_mfma_f32_16x16x32_bf16 v[104:107], v[240:243], v[188:191], v[104:107]
    ds_write_b128 v8, v[80:83] offset:5120
    s_waitcnt vmcnt(0)
    v_mfma_f32_16x16x32_bf16 v[108:111], v[220:223], v[192:195], v[108:111]
    ds_write_b128 v8, v[84:87] offset:6144
    v_mfma_f32_16x16x32_bf16 v[112:115], v[224:227], v[192:195], v[112:115]
    ds_write_b128 v8, v[88:91] offset:7168
    v_mfma_f32_16x16x32_bf16 v[116:119], v[228:231], v[192:195], v[116:119]
    ds_write_b128 v8, v[92:95] offset:8192
    v_mfma_f32_16x16x32_bf16 v[120:123], v[232:235], v[192:195], v[120:123]
    ds_write_b128 v8, v[96:99] offset:9216
    v_mfma_f32_16x16x32_bf16 v[124:127], v[236:239], v[192:195], v[124:127]
    ds_write_b128 v8, v[100:103] offset:10240
    v_mfma_f32_16x16x32_bf16 v[128:131], v[240:243], v[192:195], v[128:131]
    ds_write_b128 v8, v[104:107] offset:11264
    v_mfma_f32_16x16x32_bf16 v[36:39], v[220:223], v[180:183], v[36:39]
    ds_write_b128 v8, v[108:111] offset:12288
    v_mfma_f32_16x16x32_bf16 v[40:43], v[224:227], v[180:183], v[40:43]
    ds_write_b128 v8, v[112:115] offset:13312
    v_mfma_f32_16x16x32_bf16 v[44:47], v[228:231], v[180:183], v[44:47]
    ds_write_b128 v8, v[116:119] offset:14336
    v_mfma_f32_16x16x32_bf16 v[48:51], v[232:235], v[180:183], v[48:51]
    s_waitcnt lgkmcnt(14)
    ds_write_b128 v8, v[120:123] offset:15360
    v_mfma_f32_16x16x32_bf16 v[52:55], v[236:239], v[180:183], v[52:55]
    s_waitcnt lgkmcnt(14)
    ds_write_b128 v8, v[124:127] offset:16384
    v_mfma_f32_16x16x32_bf16 v[56:59], v[240:243], v[180:183], v[56:59]
    s_waitcnt lgkmcnt(14)
    ds_write_b128 v8, v[128:131] offset:17408
    v_mov_b32 v15, 1
    s_mov_b64 exec, 1
    ds_add_u32 v17, v15 offset:4
    s_mov_b64 exec, -1
    s_waitcnt lgkmcnt(0)
    v_xor_b32 v9, 1, v2
    v_mul_u32_u24 v9, 24576, v9
    v_add_u32 v9, v9, v7
    v_xor_b32 v10, 2, v2
    v_mul_u32_u24 v10, 24576, v10
    v_add_u32 v10, v10, v7
    v_xor_b32 v11, 3, v2
    v_mul_u32_u24 v11, 24576, v11
    v_add_u32 v11, v11, v7
    v_lshlrev_b32 v132, 16, v244
    v_and_b32 v133, 0xffff0000, v244
    v_lshlrev_b32 v134, 16, v245
    v_and_b32 v135, 0xffff0000, v245
    v_lshlrev_b32 v136, 16, v246
    v_and_b32 v137, 0xffff0000, v246
    v_lshlrev_b32 v138, 16, v247
    v_and_b32 v139, 0xffff0000, v247
    v_lshlrev_b32 v140, 16, v248
    v_and_b32 v141, 0xffff0000, v248
    v_lshlrev_b32 v142, 16, v249
    v_and_b32 v143, 0xffff0000, v249
    v_lshlrev_b32 v144, 16, v250
    v_and_b32 v145, 0xffff0000, v250
    v_lshlrev_b32 v146, 16, v251
    v_and_b32 v147, 0xffff0000, v251
    v_lshlrev_b32 v148, 16, v252
    v_and_b32 v149, 0xffff0000, v252
    v_lshlrev_b32 v150, 16, v253
    v_and_b32 v151, 0xffff0000, v253
    v_lshlrev_b32 v152, 16, v254
    v_and_b32 v153, 0xffff0000, v254
    v_lshlrev_b32 v154, 16, v255
    v_and_b32 v155, 0xffff0000, v255
    v_add_f32 v36, v36, v132
    v_add_f32 v37, v37, v133
    v_add_f32 v38, v38, v134
    v_add_f32 v39, v39, v135
    v_add_f32 v40, v40, v136
    v_add_f32 v41, v41, v137
    v_add_f32 v42, v42, v138
    v_add_f32 v43, v43, v139
    v_add_f32 v44, v44, v140
    v_add_f32 v45, v45, v141
    v_add_f32 v46, v46, v142
    v_add_f32 v47, v47, v143
    v_add_f32 v48, v48, v144
    v_add_f32 v49, v49, v145
    v_add_f32 v50, v50, v146
    v_add_f32 v51, v51, v147
    v_add_f32 v52, v52, v148
    v_add_f32 v53, v53, v149
    v_add_f32 v54, v54, v150
    v_add_f32 v55, v55, v151
    v_add_f32 v56, v56, v152
    v_add_f32 v57, v57, v153
    v_add_f32 v58, v58, v154
    v_add_f32 v59, v59, v155
    s_lshl_b32 s68, s62, 2
    s_add_u32 s68, s68, s49
    s_mul_i32 s68, s68, 43
    s_mul_i32 s3, s63, 3
    s_add_u32 s68, s68, s3
    s_lshl_b32 s68, s68, 10
    s_add_u32 s68, s68, 2097152
    s_cmp_eq_u32 s63, 14
    s_cselect_b32 s69, 2130706432, s68
    v_mov_b32 v12, 0xc0135761
    v_mov_b32 v13, 0xbdd2d3e8
    v_mov_b32 v14, 1.0
    s_mov_b32 s53, 0
    s_nop 1
L_cw15:
    s_sleep 1
    ds_read_b32 v15, v17 offset:4
    s_waitcnt lgkmcnt(0)
    v_readfirstlane_b32 s3, v15
    s_add_u32 s53, s53, 1
    s_cmp_gt_u32 s53, 1000000
    s_nop 2
    s_cbranch_scc1 L_cw15x
    s_cmp_lt_u32 s3, 4
    s_cbranch_scc1 L_cw15
L_cw15x:
    ds_read_b128 v[60:63], v9 offset:0
    ds_read_b128 v[64:67], v9 offset:1024
    ds_read_b128 v[84:87], v10 offset:6144
    ds_read_b128 v[88:91], v10 offset:7168
    ds_read_b128 v[108:111], v11 offset:12288
    ds_read_b128 v[112:115], v11 offset:13312
    ds_read_b128 v[68:71], v9 offset:2048
    ds_read_b128 v[72:75], v9 offset:3072
    ds_read_b128 v[92:95], v10 offset:8192
    ds_read_b128 v[96:99], v10 offset:9216
    ds_read_b128 v[116:119], v11 offset:14336
    ds_read_b128 v[120:123], v11 offset:15360
    ds_read_b128 v[76:79], v9 offset:4096
    ds_read_b128 v[80:83], v9 offset:5120
    ds_read_b128 v[100:103], v10 offset:10240
    s_waitcnt lgkmcnt(14)
    ds_read_b128 v[104:107], v10 offset:11264
    s_waitcnt lgkmcnt(14)
    ds_read_b128 v[124:127], v11 offset:16384
    s_waitcnt lgkmcnt(14)
    ds_read_b128 v[128:131], v11 offset:17408
    v_mov_b32 v15, 1
    s_mov_b64 exec, 1
    ds_add_u32 v17, v15 offset:48
    s_mov_b64 exec, -1
    s_waitcnt lgkmcnt(12)
    v_add_f32 v60, v60, v84
    v_add_f32 v61, v61, v85
    v_add_f32 v62, v62, v86
    v_add_f32 v63, v63, v87
    v_add_f32 v64, v64, v88
    v_add_f32 v65, v65, v89
    v_add_f32 v66, v66, v90
    v_add_f32 v67, v67, v91
    v_add_f32 v36, v36, v108
    v_add_f32 v37, v37, v109
    v_add_f32 v38, v38, v110
    v_add_f32 v39, v39, v111
    v_add_f32 v40, v40, v112
    v_add_f32 v41, v41, v113
    v_add_f32 v42, v42, v114
    v_add_f32 v43, v43, v115
    v_add_f32 v36, v36, v60
    v_add_f32 v37, v37, v61
    v_add_f32 v38, v38, v62
    v_add_f32 v39, v39, v63
    v_add_f32 v40, v40, v64
    v_add_f32 v41, v41, v65
    v_add_f32 v42, v42, v66
    v_add_f32 v43, v43, v67
    v_mul_f32 v132, v36, v36
    v_mul_f32 v133, v37, v37
    v_mul_f32 v134, v38, v38
    v_mul_f32 v135, v39, v39
    v_mul_f32 v136, v40, v40
    v_mul_f32 v137, v41, v41
    v_mul_f32 v138, v42, v42
    v_mul_f32 v139, v43, v43
    v_fma_f32 v132, v132, v13, v12
    v_fma_f32 v133, v133, v13, v12
    v_fma_f32 v134, v134, v13, v12
    v_fma_f32 v135, v135, v13, v12
    v_fma_f32 v136, v136, v13, v12
    v_fma_f32 v137, v137, v13, v12
    v_fma_f32 v138, v138, v13, v12
    v_fma_f32 v139, v139, v13, v12
    v_mul_f32 v132, v132, v36
    v_mul_f32 v133, v133, v37
    v_mul_f32 v134, v134, v38
    v_mul_f32 v135, v135, v39
    v_mul_f32 v136, v136, v40
    v_mul_f32 v137, v137, v41
    v_mul_f32 v138, v138, v42
    v_mul_f32 v139, v139, v43
    v_exp_f32 v132, v132
    v_exp_f32 v133, v133
    v_exp_f32 v134, v134
    v_exp_f32 v135, v135
    v_exp_f32 v136, v136
    v_exp_f32 v137, v137
    v_exp_f32 v138, v138
    v_exp_f32 v139, v139
    v_add_f32 v132, v132, v14
    v_add_f32 v133, v133, v14
    v_add_f32 v134, v134, v14
    v_add_f32 v135, v135, v14
    v_add_f32 v136, v136, v14
    v_add_f32 v137, v137, v14
    v_add_f32 v138, v138, v14
    v_add_f32 v139, v139, v14
    v_rcp_f32 v132, v132
    v_rcp_f32 v133, v133
    v_rcp_f32 v134, v134
    v_rcp_f32 v135, v135
    v_rcp_f32 v136, v136
    v_rcp_f32 v137, v137
    v_rcp_f32 v138, v138
    v_rcp_f32 v139, v139
    v_mul_f32 v132, v132, v36
    v_mul_f32 v133, v133, v37
    v_mul_f32 v134, v134, v38
    v_mul_f32 v135, v135, v39
    v_mul_f32 v136, v136, v40
    v_mul_f32 v137, v137, v41
    v_mul_f32 v138, v138, v42
    v_mul_f32 v139, v139, v43
    v_cvt_pk_bf16_f32 v156, v132, v133
    v_cvt_pk_bf16_f32 v157, v134, v135
    v_cvt_pk_bf16_f32 v158, v136, v137
    v_cvt_pk_bf16_f32 v159, v138, v139
    buffer_store_dwordx4 v[156:159], v7, s[36:39], s68 offen offset:0 sc0 sc1
    s_waitcnt lgkmcnt(6)
    v_add_f32 v68, v68, v92
    v_add_f32 v69, v69, v93
    v_add_f32 v70, v70, v94
    v_add_f32 v71, v71, v95
    v_add_f32 v72, v72, v96
    v_add_f32 v73, v73, v97
    v_add_f32 v74, v74, v98
    v_add_f32 v75, v75, v99
    v_add_f32 v44, v44, v116
    v_add_f32 v45, v45, v117
    v_add_f32 v46, v46, v118
    v_add_f32 v47, v47, v119
    v_add_f32 v48, v48, v120
    v_add_f32 v49, v49, v121
    v_add_f32 v50, v50, v122
    v_add_f32 v51, v51, v123
    v_add_f32 v44, v44, v68
    v_add_f32 v45, v45, v69
    v_add_f32 v46, v46, v70
    v_add_f32 v47, v47, v71
    v_add_f32 v48, v48, v72
    v_add_f32 v49, v49, v73
    v_add_f32 v50, v50, v74
    v_add_f32 v51, v51, v75
    v_mul_f32 v140, v44, v44
    v_mul_f32 v141, v45, v45
    v_mul_f32 v142, v46, v46
    v_mul_f32 v143, v47, v47
    v_mul_f32 v144, v48, v48
    v_mul_f32 v145, v49, v49
    v_mul_f32 v146, v50, v50
    v_mul_f32 v147, v51, v51
    v_fma_f32 v140, v140, v13, v12
    v_fma_f32 v141, v141, v13, v12
    v_fma_f32 v142, v142, v13, v12
    v_fma_f32 v143, v143, v13, v12
    v_fma_f32 v144, v144, v13, v12
    v_fma_f32 v145, v145, v13, v12
    v_fma_f32 v146, v146, v13, v12
    v_fma_f32 v147, v147, v13, v12
    v_mul_f32 v140, v140, v44
    v_mul_f32 v141, v141, v45
    v_mul_f32 v142, v142, v46
    v_mul_f32 v143, v143, v47
    v_mul_f32 v144, v144, v48
    v_mul_f32 v145, v145, v49
    v_mul_f32 v146, v146, v50
    v_mul_f32 v147, v147, v51
    v_exp_f32 v140, v140
    v_exp_f32 v141, v141
    v_exp_f32 v142, v142
    v_exp_f32 v143, v143
    v_exp_f32 v144, v144
    v_exp_f32 v145, v145
    v_exp_f32 v146, v146
    v_exp_f32 v147, v147
    v_add_f32 v140, v140, v14
    v_add_f32 v141, v141, v14
    v_add_f32 v142, v142, v14
    v_add_f32 v143, v143, v14
    v_add_f32 v144, v144, v14
    v_add_f32 v145, v145, v14
    v_add_f32 v146, v146, v14
    v_add_f32 v147, v147, v14
    v_rcp_f32 v140, v140
    v_rcp_f32 v141, v141
    v_rcp_f32 v142, v142
    v_rcp_f32 v143, v143
    v_rcp_f32 v144, v144
    v_rcp_f32 v145, v145
    v_rcp_f32 v146, v146
    v_rcp_f32 v147, v147
    v_mul_f32 v140, v140, v44
    v_mul_f32 v141, v141, v45
    v_mul_f32 v142, v142, v46
    v_mul_f32 v143, v143, v47
    v_mul_f32 v144, v144, v48
    v_mul_f32 v145, v145, v49
    v_mul_f32 v146, v146, v50
    v_mul_f32 v147, v147, v51
    v_cvt_pk_bf16_f32 v160, v140, v141
    v_cvt_pk_bf16_f32 v161, v142, v143
    v_cvt_pk_bf16_f32 v162, v144, v145
    v_cvt_pk_bf16_f32 v163, v146, v147
    buffer_store_dwordx4 v[160:163], v7, s[36:39], s69 offen offset:1024 sc0 sc1
    s_waitcnt lgkmcnt(0)
    v_add_f32 v76, v76, v100
    v_add_f32 v77, v77, v101
    v_add_f32 v78, v78, v102
    v_add_f32 v79, v79, v103
    v_add_f32 v80, v80, v104
    v_add_f32 v81, v81, v105
    v_add_f32 v82, v82, v106
    v_add_f32 v83, v83, v107
    v_add_f32 v52, v52, v124
    v_add_f32 v53, v53, v125
    v_add_f32 v54, v54, v126
    v_add_f32 v55, v55, v127
    v_add_f32 v56, v56, v128
    v_add_f32 v57, v57, v129
    v_add_f32 v58, v58, v130
    v_add_f32 v59, v59, v131
    v_add_f32 v52, v52, v76
    v_add_f32 v53, v53, v77
    v_add_f32 v54, v54, v78
    v_add_f32 v55, v55, v79
    v_add_f32 v56, v56, v80
    v_add_f32 v57, v57, v81
    v_add_f32 v58, v58, v82
    v_add_f32 v59, v59, v83
    v_mul_f32 v148, v52, v52
    v_mul_f32 v149, v53, v53
    v_mul_f32 v150, v54, v54
    v_mul_f32 v151, v55, v55
    v_mul_f32 v152, v56, v56
    v_mul_f32 v153, v57, v57
    v_mul_f32 v154, v58, v58
    v_mul_f32 v155, v59, v59
    v_fma_f32 v148, v148, v13, v12
    v_fma_f32 v149, v149, v13, v12
    v_fma_f32 v150, v150, v13, v12
    v_fma_f32 v151, v151, v13, v12
    v_fma_f32 v152, v152, v13, v12
    v_fma_f32 v153, v153, v13, v12
    v_fma_f32 v154, v154, v13, v12
    v_fma_f32 v155, v155, v13, v12
    v_mul_f32 v148, v148, v52
    v_mul_f32 v149, v149, v53
    v_mul_f32 v150, v150, v54
    v_mul_f32 v151, v151, v55
    v_mul_f32 v152, v152, v56
    v_mul_f32 v153, v153, v57
    v_mul_f32 v154, v154, v58
    v_mul_f32 v155, v155, v59
    v_exp_f32 v148, v148
    v_exp_f32 v149, v149
    v_exp_f32 v150, v150
    v_exp_f32 v151, v151
    v_exp_f32 v152, v152
    v_exp_f32 v153, v153
    v_exp_f32 v154, v154
    v_exp_f32 v155, v155
    v_add_f32 v148, v148, v14
    v_add_f32 v149, v149, v14
    v_add_f32 v150, v150, v14
    v_add_f32 v151, v151, v14
    v_add_f32 v152, v152, v14
    v_add_f32 v153, v153, v14
    v_add_f32 v154, v154, v14
    v_add_f32 v155, v155, v14
    v_rcp_f32 v148, v148
    v_rcp_f32 v149, v149
    v_rcp_f32 v150, v150
    v_rcp_f32 v151, v151
    v_rcp_f32 v152, v152
    v_rcp_f32 v153, v153
    v_rcp_f32 v154, v154
    v_rcp_f32 v155, v155
    v_mul_f32 v148, v148, v52
    v_mul_f32 v149, v149, v53
    v_mul_f32 v150, v150, v54
    v_mul_f32 v151, v151, v55
    v_mul_f32 v152, v152, v56
    v_mul_f32 v153, v153, v57
    v_mul_f32 v154, v154, v58
    v_mul_f32 v155, v155, v59
    v_cvt_pk_bf16_f32 v164, v148, v149
    v_cvt_pk_bf16_f32 v165, v150, v151
    v_cvt_pk_bf16_f32 v166, v152, v153
    v_cvt_pk_bf16_f32 v167, v154, v155
    buffer_store_dwordx4 v[164:167], v7, s[36:39], s69 offen offset:2048 sc0 sc1
    s_lshl_b32 s52, s62, 10
    s_add_u32 s52, s52, s63
    s_lshl_b32 s52, s52, 2
    s_add_u32 s52, s52, 7110656
    s_mov_b32 s70, s52
    s_mov_b32 s44, s10
    s_mov_b32 s45, s11
    s_mov_b32 s46, 524288
    s_mov_b32 s47, 0x20000
    v_lshlrev_b32 v8, 1, v3
    v_and_b32 v10, 7, v1
    v_xor_b32 v8, v8, v10
    v_lshlrev_b32 v8, 4, v8
    v_lshrrev_b32 v11, 3, v1
    v_lshl_add_u32 v28, v11, 10, v8
    v_add_u32 v29, 7168, v28
    v_add_u32 v30, 14336, v28
    v_add_u32 v31, 21504, v28
    s_lshl_b32 s79, s49, 17
    s_lshl_b32 s3, s65, 7
    s_add_u32 s79, s79, s3
    s_waitcnt vmcnt(0)
    v_mov_b32 v15, 1
    s_mov_b64 exec, 1
    ds_add_u32 v17, v15 offset:12
    s_mov_b64 exec, -1
    s_cmp_lg_u32 s49, 0
    s_cbranch_scc1 L_pb16
    s_mov_b32 s53, 0
L_cw17:
    s_sleep 1
    ds_read_b32 v15, v17 offset:12
    s_waitcnt lgkmcnt(0)
    v_readfirstlane_b32 s3, v15
    s_add_u32 s53, s53, 1
    s_cmp_gt_u32 s53, 1000000
    s_nop 2
    s_cbranch_scc1 L_cw17x
    s_cmp_lt_u32 s3, 4
    s_cbranch_scc1 L_cw17
L_cw17x:
    v_lshlrev_b32 v14, 7, v1
    s_mov_b64 exec, 0
    s_mov_b32 exec_lo, -1
    buffer_store_dword v18, v14, s[36:39], s70 offen sc0 sc1
    s_mov_b64 exec, -1
L_pb16:
    s_waitcnt lgkmcnt(0)
    s_add_u32 s58, s79, 0
    buffer_load_dwordx4 v[176:179], v28, s[44:47], s58 offen offset:0
    buffer_load_dwordx4 v[180:183], v29, s[44:47], s58 offen offset:1024
    buffer_load_dwordx4 v[184:187], v30, s[44:47], s58 offen offset:2048
    buffer_load_dwordx4 v[188:191], v31, s[44:47], s58 offen offset:3072
    s_add_u32 s58, s79, 32768
    buffer_load_dwordx4 v[192:195], v28, s[44:47], s58 offen offset:0
    buffer_load_dwordx4 v[196:199], v29, s[44:47], s58 offen offset:1024
    buffer_load_dwordx4 v[200:203], v30, s[44:47], s58 offen offset:2048
    buffer_load_dwordx4 v[204:207], v31, s[44:47], s58 offen offset:3072
    s_add_u32 s58, s79, 65536
    buffer_load_dwordx4 v[208:211], v28, s[44:47], s58 offen offset:0
    buffer_load_dwordx4 v[212:215], v29, s[44:47], s58 offen offset:1024
    buffer_load_dwordx4 v[216:219], v30, s[44:47], s58 offen offset:2048
    buffer_load_dwordx4 v[220:223], v31, s[44:47], s58 offen offset:3072
    s_add_u32 s58, s79, 98304
    buffer_load_dwordx4 v[224:227], v28, s[44:47], s58 offen offset:0
    buffer_load_dwordx4 v[228:231], v29, s[44:47], s58 offen offset:1024
    buffer_load_dwordx4 v[232:235], v30, s[44:47], s58 offen offset:2048
    buffer_load_dwordx4 v[236:239], v31, s[44:47], s58 offen offset:3072
    s_lshl_b32 s83, s49, 12
    s_add_u32 s83, s83, 114688
    v_add_u32 v252, s83, v7
    v_mov_b32 v43, 0xbfb8aa3b
    v_lshl_add_u32 v10, v3, 2, v5
    v_bfe_u32 v11, v10, 1, 2
    v_and_b32 v9, 8, v10
    v_add_u32 v10, v10, v9
    v_lshlrev_b32 v10, 7, v10
    v_lshlrev_b32 v11, 1, v11
    v_xor_b32 v11, v11, v6
    v_lshl_add_u32 v10, v11, 4, v10
    v_add_u32 v40, s83, v10
    v_xor_b32 v41, 64, v40
    s_mov_b32 s40, s20
    s_mov_b32 s41, s21
    s_mov_b32 s42, 4096
    s_mov_b32 s43, 0x20000
    v_lshl_add_u32 v39, v2, 4, v4
    v_lshlrev_b32 v38, 1, v39
    v_lshlrev_b32 v39, 10, v39
    v_lshl_add_u32 v39, v3, 4, v39
    s_lshl_b32 s67, s64, 16
    s_lshl_b32 s3, s65, 7
    s_add_u32 s67, s67, s3
    buffer_load_dwordx4 v[240:243], v39, s[28:31], s67 offen
    buffer_load_dwordx4 v[244:247], v39, s[28:31], s67 offen offset:64
    s_lshl_b32 s3, s64, 7
    buffer_load_ushort v38, v38, s[40:43], s3 offen
    s_waitcnt vmcnt(15)
    ds_write_b128 v252, v[176:179] offset:0
    ds_write_b128 v252, v[180:183] offset:1024
    ds_write_b128 v252, v[184:187] offset:2048
    ds_write_b128 v252, v[188:191] offset:3072
    ds_read_b64_tr_b16 v[176:177], v40 offset:0
    ds_read_b64_tr_b16 v[178:179], v40 offset:1024
    ds_read_b64_tr_b16 v[180:181], v40 offset:8
    ds_read_b64_tr_b16 v[182:183], v40 offset:1032
    ds_read_b64_tr_b16 v[184:185], v41 offset:0
    ds_read_b64_tr_b16 v[186:187], v41 offset:1024
    ds_read_b64_tr_b16 v[188:189], v41 offset:8
    ds_read_b64_tr_b16 v[190:191], v41 offset:1032
    s_waitcnt vmcnt(11)
    ds_write_b128 v252, v[192:195] offset:0
    ds_write_b128 v252, v[196:199] offset:1024
    ds_write_b128 v252, v[200:203] offset:2048
    s_waitcnt lgkmcnt(14)
    ds_write_b128 v252, v[204:207] offset:3072
    s_waitcnt lgkmcnt(14)
    ds_read_b64_tr_b16 v[192:193], v40 offset:0
    s_waitcnt lgkmcnt(14)
    ds_read_b64_tr_b16 v[194:195], v40 offset:1024
    s_waitcnt lgkmcnt(14)
    ds_read_b64_tr_b16 v[196:197], v40 offset:8
    s_waitcnt lgkmcnt(14)
    ds_read_b64_tr_b16 v[198:199], v40 offset:1032
    s_waitcnt lgkmcnt(14)
    ds_read_b64_tr_b16 v[200:201], v41 offset:0
    s_waitcnt lgkmcnt(14)
    ds_read_b64_tr_b16 v[202:203], v41 offset:1024
    s_waitcnt lgkmcnt(14)
    ds_read_b64_tr_b16 v[204:205], v41 offset:8
    s_waitcnt lgkmcnt(14)
    ds_read_b64_tr_b16 v[206:207], v41 offset:1032
    s_waitcnt vmcnt(7)
    s_waitcnt lgkmcnt(14)
    ds_write_b128 v252, v[208:211] offset:0
    s_waitcnt lgkmcnt(14)
    ds_write_b128 v252, v[212:215] offset:1024
    s_waitcnt lgkmcnt(14)
    ds_write_b128 v252, v[216:219] offset:2048
    s_waitcnt lgkmcnt(14)
    ds_write_b128 v252, v[220:223] offset:3072
    s_waitcnt lgkmcnt(14)
    ds_read_b64_tr_b16 v[208:209], v40 offset:0
    s_waitcnt lgkmcnt(14)
    ds_read_b64_tr_b16 v[210:211], v40 offset:1024
    s_waitcnt lgkmcnt(14)
    ds_read_b64_tr_b16 v[212:213], v40 offset:8
    s_waitcnt lgkmcnt(14)
    ds_read_b64_tr_b16 v[214:215], v40 offset:1032
    s_waitcnt lgkmcnt(14)
    ds_read_b64_tr_b16 v[216:217], v41 offset:0
    s_waitcnt lgkmcnt(14)
    ds_read_b64_tr_b16 v[218:219], v41 offset:1024
    s_waitcnt lgkmcnt(14)
    ds_read_b64_tr_b16 v[220:221], v41 offset:8
    s_waitcnt lgkmcnt(14)
    ds_read_b64_tr_b16 v[222:223], v41 offset:1032
    s_waitcnt vmcnt(3)
    s_waitcnt lgkmcnt(14)
    ds_write_b128 v252, v[224:227] offset:0
    s_waitcnt lgkmcnt(14)
    ds_write_b128 v252, v[228:231] offset:1024
    s_waitcnt lgkmcnt(14)
    ds_write_b128 v252, v[232:235] offset:2048
    s_waitcnt lgkmcnt(14)
    ds_write_b128 v252, v[236:239] offset:3072
    s_waitcnt lgkmcnt(14)
    ds_read_b64_tr_b16 v[224:225], v40 offset:0
    s_waitcnt lgkmcnt(14)
    ds_read_b64_tr_b16 v[226:227], v40 offset:1024
    s_waitcnt lgkmcnt(14)
    ds_read_b64_tr_b16 v[228:229], v40 offset:8
    s_waitcnt lgkmcnt(14)
    ds_read_b64_tr_b16 v[230:231], v40 offset:1032
    s_waitcnt lgkmcnt(14)
    ds_read_b64_tr_b16 v[232:233], v41 offset:0
    s_waitcnt lgkmcnt(14)
    ds_read_b64_tr_b16 v[234:235], v41 offset:1024
    s_waitcnt lgkmcnt(14)
    ds_read_b64_tr_b16 v[236:237], v41 offset:8
    s_waitcnt lgkmcnt(14)
    ds_read_b64_tr_b16 v[238:239], v41 offset:1032
    v_mov_b32 v15, 1
    s_mov_b64 exec, 1
    ds_add_u32 v17, v15 offset:40
    s_mov_b64 exec, -1
    v_and_b32 v22, 7, v1
    v_lshlrev_b32 v22, 3, v22
    s_lshl_b32 s73, s64, 3
    s_add_u32 s73, s73, s65
    s_lshl_b32 s73, s73, 7
    s_add_u32 s73, s73, 7143424
    v_lshl_add_u32 v8, v2, 14, v7
    v_xor_b32 v24, 0, v8
    v_xor_b32 v25, 16384, v8
    v_xor_b32 v26, 32768, v8
    v_xor_b32 v27, 49152, v8
    s_lshl_b32 s57, s64, 16
    s_lshl_b32 s3, s49, 12
    s_add_u32 s57, s57, s3
    s_add_u32 s57, s57, 4194304
    s_setprio 0
    s_branch L_X
.p2alignl 6, 0xbf800000
L_bx2:
    s_mov_b32 s53, 0
L_cw18:
    s_sleep 1
    ds_read_b32 v15, v17 offset:8
    s_waitcnt lgkmcnt(0)
    v_readfirstlane_b32 s3, v15
    s_add_u32 s53, s53, 1
    s_cmp_gt_u32 s53, 1000000
    s_nop 2
    s_cbranch_scc1 L_cw18x
    s_cmp_lt_u32 s3, 4
    s_cbranch_scc1 L_cw18
L_cw18x:
    s_mov_b32 s44, s10
    s_mov_b32 s45, s11
    s_mov_b32 s46, 524288
    s_mov_b32 s47, 0x20000
    v_lshlrev_b32 v8, 1, v3
    v_and_b32 v10, 7, v1
    v_xor_b32 v8, v8, v10
    v_lshlrev_b32 v8, 4, v8
    v_lshrrev_b32 v11, 3, v1
    v_lshl_add_u32 v28, v11, 10, v8
    v_add_u32 v29, 7168, v28
    v_add_u32 v30, 14336, v28
    v_add_u32 v31, 21504, v28
    s_lshl_b32 s79, s49, 17
    s_lshl_b32 s3, s65, 7
    s_add_u32 s79, s79, s3
    s_add_u32 s58, s79, 0
    buffer_load_dwordx4 v[176:179], v28, s[44:47], s58 offen offset:0
    buffer_load_dwordx4 v[180:183], v29, s[44:47], s58 offen offset:1024
    buffer_load_dwordx4 v[184:187], v30, s[44:47], s58 offen offset:2048
    buffer_load_dwordx4 v[188:191], v31, s[44:47], s58 offen offset:3072
    s_add_u32 s58, s79, 32768
    buffer_load_dwordx4 v[192:195], v28, s[44:47], s58 offen offset:0
    buffer_load_dwordx4 v[196:199], v29, s[44:47], s58 offen offset:1024
    buffer_load_dwordx4 v[200:203], v30, s[44:47], s58 offen offset:2048
    buffer_load_dwordx4 v[204:207], v31, s[44:47], s58 offen offset:3072
    s_add_u32 s58, s79, 65536
    buffer_load_dwordx4 v[208:211], v28, s[44:47], s58 offen offset:0
    buffer_load_dwordx4 v[212:215], v29, s[44:47], s58 offen offset:1024
    buffer_load_dwordx4 v[216:219], v30, s[44:47], s58 offen offset:2048
    buffer_load_dwordx4 v[220:223], v31, s[44:47], s58 offen offset:3072
    s_add_u32 s58, s79, 98304
    buffer_load_dwordx4 v[224:227], v28, s[44:47], s58 offen offset:0
    buffer_load_dwordx4 v[228:231], v29, s[44:47], s58 offen offset:1024
    buffer_load_dwordx4 v[232:235], v30, s[44:47], s58 offen offset:2048
    buffer_load_dwordx4 v[236:239], v31, s[44:47], s58 offen offset:3072
    s_lshl_b32 s83, s49, 12
    s_add_u32 s83, s83, 114688
    v_add_u32 v252, s83, v7
    v_mov_b32 v43, 0xbfb8aa3b
    v_lshl_add_u32 v10, v3, 2, v5
    v_bfe_u32 v11, v10, 1, 2
    v_and_b32 v9, 8, v10
    v_add_u32 v10, v10, v9
    v_lshlrev_b32 v10, 7, v10
    v_lshlrev_b32 v11, 1, v11
    v_xor_b32 v11, v11, v6
    v_lshl_add_u32 v10, v11, 4, v10
    v_add_u32 v40, s83, v10
    v_xor_b32 v41, 64, v40
    s_mov_b32 s40, s20
    s_mov_b32 s41, s21
    s_mov_b32 s42, 4096
    s_mov_b32 s43, 0x20000
    v_lshl_add_u32 v39, v2, 4, v4
    v_lshlrev_b32 v38, 1, v39
    v_lshlrev_b32 v39, 10, v39
    v_lshl_add_u32 v39, v3, 4, v39
    s_lshl_b32 s67, s64, 16
    s_lshl_b32 s3, s65, 7
    s_add_u32 s67, s67, s3
    buffer_load_dwordx4 v[240:243], v39, s[28:31], s67 offen
    buffer_load_dwordx4 v[244:247], v39, s[28:31], s67 offen offset:64
    s_lshl_b32 s3, s64, 7
    buffer_load_ushort v38, v38, s[40:43], s3 offen
    s_waitcnt vmcnt(15)
    ds_write_b128 v252, v[176:179] offset:0
    ds_write_b128 v252, v[180:183] offset:1024
    ds_write_b128 v252, v[184:187] offset:2048
    ds_write_b128 v252, v[188:191] offset:3072
    ds_read_b64_tr_b16 v[176:177], v40 offset:0
    ds_read_b64_tr_b16 v[178:179], v40 offset:1024
    ds_read_b64_tr_b16 v[180:181], v40 offset:8
    ds_read_b64_tr_b16 v[182:183], v40 offset:1032
    ds_read_b64_tr_b16 v[184:185], v41 offset:0
    ds_read_b64_tr_b16 v[186:187], v41 offset:1024
    ds_read_b64_tr_b16 v[188:189], v41 offset:8
    ds_read_b64_tr_b16 v[190:191], v41 offset:1032
    s_waitcnt vmcnt(11)
    ds_write_b128 v252, v[192:195] offset:0
    ds_write_b128 v252, v[196:199] offset:1024
    ds_write_b128 v252, v[200:203] offset:2048
    s_waitcnt lgkmcnt(14)
    ds_write_b128 v252, v[204:207] offset:3072
    s_waitcnt lgkmcnt(14)
    ds_read_b64_tr_b16 v[192:193], v40 offset:0
    s_waitcnt lgkmcnt(14)
    ds_read_b64_tr_b16 v[194:195], v40 offset:1024
    s_waitcnt lgkmcnt(14)
    ds_read_b64_tr_b16 v[196:197], v40 offset:8
    s_waitcnt lgkmcnt(14)
    ds_read_b64_tr_b16 v[198:199], v40 offset:1032
    s_waitcnt lgkmcnt(14)
    ds_read_b64_tr_b16 v[200:201], v41 offset:0
    s_waitcnt lgkmcnt(14)
    ds_read_b64_tr_b16 v[202:203], v41 offset:1024
    s_waitcnt lgkmcnt(14)
    ds_read_b64_tr_b16 v[204:205], v41 offset:8
    s_waitcnt lgkmcnt(14)
    ds_read_b64_tr_b16 v[206:207], v41 offset:1032
    s_waitcnt vmcnt(7)
    s_waitcnt lgkmcnt(14)
    ds_write_b128 v252, v[208:211] offset:0
    s_waitcnt lgkmcnt(14)
    ds_write_b128 v252, v[212:215] offset:1024
    s_waitcnt lgkmcnt(14)
    ds_write_b128 v252, v[216:219] offset:2048
    s_waitcnt lgkmcnt(14)
    ds_write_b128 v252, v[220:223] offset:3072
    s_waitcnt lgkmcnt(14)
    ds_read_b64_tr_b16 v[208:209], v40 offset:0
    s_waitcnt lgkmcnt(14)
    ds_read_b64_tr_b16 v[210:211], v40 offset:1024
    s_waitcnt lgkmcnt(14)
    ds_read_b64_tr_b16 v[212:213], v40 offset:8
    s_waitcnt lgkmcnt(14)
    ds_read_b64_tr_b16 v[214:215], v40 offset:1032
    s_waitcnt lgkmcnt(14)
    ds_read_b64_tr_b16 v[216:217], v41 offset:0
    s_waitcnt lgkmcnt(14)
    ds_read_b64_tr_b16 v[218:219], v41 offset:1024
    s_waitcnt lgkmcnt(14)
    ds_read_b64_tr_b16 v[220:221], v41 offset:8
    s_waitcnt lgkmcnt(14)
    ds_read_b64_tr_b16 v[222:223], v41 offset:1032
    s_waitcnt vmcnt(3)
    s_waitcnt lgkmcnt(14)
    ds_write_b128 v252, v[224:227] offset:0
    s_waitcnt lgkmcnt(14)
    ds_write_b128 v252, v[228:231] offset:1024
    s_waitcnt lgkmcnt(14)
    ds_write_b128 v252, v[232:235] offset:2048
    s_waitcnt lgkmcnt(14)
    ds_write_b128 v252, v[236:239] offset:3072
    s_waitcnt lgkmcnt(14)
    ds_read_b64_tr_b16 v[224:225], v40 offset:0
    s_waitcnt lgkmcnt(14)
    ds_read_b64_tr_b16 v[226:227], v40 offset:1024
    s_waitcnt lgkmcnt(14)
    ds_read_b64_tr_b16 v[228:229], v40 offset:8
    s_waitcnt lgkmcnt(14)
    ds_read_b64_tr_b16 v[230:231], v40 offset:1032
    s_waitcnt lgkmcnt(14)
    ds_read_b64_tr_b16 v[232:233], v41 offset:0
    s_waitcnt lgkmcnt(14)
    ds_read_b64_tr_b16 v[234:235], v41 offset:1024
    s_waitcnt lgkmcnt(14)
    ds_read_b64_tr_b16 v[236:237], v41 offset:8
    s_waitcnt lgkmcnt(14)
    ds_read_b64_tr_b16 v[238:239], v41 offset:1032
    v_mov_b32 v15, 1
    s_mov_b64 exec, 1
    ds_add_u32 v17, v15 offset:40
    s_mov_b64 exec, -1
    v_and_b32 v22, 7, v1
    v_lshlrev_b32 v22, 3, v22
    s_lshl_b32 s73, s64, 3
    s_add_u32 s73, s73, s65
    s_lshl_b32 s73, s73, 7
    s_add_u32 s73, s73, 7143424
    v_lshl_add_u32 v8, v2, 14, v7
    v_xor_b32 v24, 0, v8
    v_xor_b32 v25, 16384, v8
    v_xor_b32 v26, 32768, v8
    v_xor_b32 v27, 49152, v8
    s_lshl_b32 s57, s64, 16
    s_lshl_b32 s3, s49, 12
    s_add_u32 s57, s57, s3
    s_add_u32 s57, s57, 4194304
.p2alignl 6, 0xbf800000
L_X:
    s_lshl_b32 s3, s49, 3
    s_add_u32 s73, s73, s3
    s_waitcnt lgkmcnt(0)
    v_readfirstlane_b32 s12, v18
    s_add_u32 s100, s26, s73
    s_addc_u32 s101, s27, 0
    s_mov_b32 s53, 0
    s_nop 1
L_sp19:
    s_load_dwordx2 s[84:85], s[100:101], 0 glc
    s_add_u32 s53, s53, 1
    s_waitcnt lgkmcnt(0)
    s_xor_b32 s13, s84, s12
    s_xor_b32 s3, s85, s12
    s_or_b32 s13, s13, s3
    s_cmp_gt_u32 s53, 30000
    s_cbranch_scc1 L_sp19x
    s_cmp_lg_u32 s13, 0
    s_cbranch_scc1 L_sp19
L_sp19x:
    s_setprio 2
    buffer_load_dwordx4 v[112:115], v24, s[36:39], s57 offen offset:0 sc1
    buffer_load_dwordx4 v[116:119], v25, s[36:39], s57 offen offset:0 sc1
    buffer_load_dwordx4 v[120:123], v26, s[36:39], s57 offen offset:0 sc1
    buffer_load_dwordx4 v[124:127], v27, s[36:39], s57 offen offset:0 sc1
    buffer_load_dwordx4 v[128:131], v24, s[36:39], s57 offen offset:1024 sc1
    buffer_load_dwordx4 v[132:135], v25, s[36:39], s57 offen offset:1024 sc1
    buffer_load_dwordx4 v[136:139], v26, s[36:39], s57 offen offset:1024 sc1
    buffer_load_dwordx4 v[140:143], v27, s[36:39], s57 offen offset:1024 sc1
    buffer_load_dwordx4 v[144:147], v24, s[36:39], s57 offen offset:2048 sc1
    buffer_load_dwordx4 v[148:151], v25, s[36:39], s57 offen offset:2048 sc1
    buffer_load_dwordx4 v[152:155], v26, s[36:39], s57 offen offset:2048 sc1
    buffer_load_dwordx4 v[156:159], v27, s[36:39], s57 offen offset:2048 sc1
    buffer_load_dwordx4 v[160:163], v24, s[36:39], s57 offen offset:3072 sc1
    buffer_load_dwordx4 v[164:167], v25, s[36:39], s57 offen offset:3072 sc1
    buffer_load_dwordx4 v[168:171], v26, s[36:39], s57 offen offset:3072 sc1
    buffer_load_dwordx4 v[172:175], v27, s[36:39], s57 offen offset:3072 sc1
    s_waitcnt vmcnt(15)
    v_mfma_f32_16x16x32_bf16 v[48:51], v[176:179], v[112:115], 0
    v_mfma_f32_16x16x32_bf16 v[52:55], v[180:183], v[112:115], 0
    v_mfma_f32_16x16x32_bf16 v[56:59], v[184:187], v[112:115], 0
    v_mfma_f32_16x16x32_bf16 v[60:63], v[188:191], v[112:115], 0
    s_waitcnt vmcnt(14)
    v_mfma_f32_16x16x32_bf16 v[64:67], v[176:179], v[116:119], 0
    v_mfma_f32_16x16x32_bf16 v[68:71], v[180:183], v[116:119], 0
    v_mfma_f32_16x16x32_bf16 v[72:75], v[184:187], v[116:119], 0
    v_mfma_f32_16x16x32_bf16 v[76:79], v[188:191], v[116:119], 0
    s_waitcnt vmcnt(13)
    v_mfma_f32_16x16x32_bf16 v[80:83], v[176:179], v[120:123], 0
    v_mfma_f32_16x16x32_bf16 v[84:87], v[180:183], v[120:123], 0
    v_mfma_f32_16x16x32_bf16 v[88:91], v[184:187], v[120:123], 0
    v_mfma_f32_16x16x32_bf16 v[92:95], v[188:191], v[120:123], 0
    s_waitcnt vmcnt(12)
    v_mfma_f32_16x16x32_bf16 v[96:99], v[176:179], v[124:127], 0
    v_mfma_f32_16x16x32_bf16 v[100:103], v[180:183], v[124:127], 0
    v_mfma_f32_16x16x32_bf16 v[104:107], v[184:187], v[124:127], 0
    v_mfma_f32_16x16x32_bf16 v[108:111], v[188:191], v[124:127], 0
    s_waitcnt vmcnt(11)
    v_mfma_f32_16x16x32_bf16 v[48:51], v[192:195], v[128:131], v[48:51]
    v_mfma_f32_16x16x32_bf16 v[52:55], v[196:199], v[128:131], v[52:55]
    v_mfma_f32_16x16x32_bf16 v[56:59], v[200:203], v[128:131], v[56:59]
    v_mfma_f32_16x16x32_bf16 v[60:63], v[204:207], v[128:131], v[60:63]
    s_waitcnt vmcnt(10)
    v_mfma_f32_16x16x32_bf16 v[64:67], v[192:195], v[132:135], v[64:67]
    v_mfma_f32_16x16x32_bf16 v[68:71], v[196:199], v[132:135], v[68:71]
    v_mfma_f32_16x16x32_bf16 v[72:75], v[200:203], v[132:135], v[72:75]
    v_mfma_f32_16x16x32_bf16 v[76:79], v[204:207], v[132:135], v[76:79]
    s_waitcnt vmcnt(9)
    v_mfma_f32_16x16x32_bf16 v[80:83], v[192:195], v[136:139], v[80:83]
    v_mfma_f32_16x16x32_bf16 v[84:87], v[196:199], v[136:139], v[84:87]
    v_mfma_f32_16x16x32_bf16 v[88:91], v[200:203], v[136:139], v[88:91]
    v_mfma_f32_16x16x32_bf16 v[92:95], v[204:207], v[136:139], v[92:95]
    s_waitcnt vmcnt(8)
    v_mfma_f32_16x16x32_bf16 v[96:99], v[192:195], v[140:143], v[96:99]
    v_mfma_f32_16x16x32_bf16 v[100:103], v[196:199], v[140:143], v[100:103]
    v_mfma_f32_16x16x32_bf16 v[104:107], v[200:203], v[140:143], v[104:107]
    v_mfma_f32_16x16x32_bf16 v[108:111], v[204:207], v[140:143], v[108:111]
    s_waitcnt vmcnt(7)
    v_mfma_f32_16x16x32_bf16 v[48:51], v[208:211], v[144:147], v[48:51]
    v_mfma_f32_16x16x32_bf16 v[52:55], v[212:215], v[144:147], v[52:55]
    v_mfma_f32_16x16x32_bf16 v[56:59], v[216:219], v[144:147], v[56:59]
    v_mfma_f32_16x16x32_bf16 v[60:63], v[220:223], v[144:147], v[60:63]
    s_waitcnt vmcnt(6)
    v_mfma_f32_16x16x32_bf16 v[64:67], v[208:211], v[148:151], v[64:67]
    v_mfma_f32_16x16x32_bf16 v[68:71], v[212:215], v[148:151], v[68:71]
    v_mfma_f32_16x16x32_bf16 v[72:75], v[216:219], v[148:151], v[72:75]
    v_mfma_f32_16x16x32_bf16 v[76:79], v[220:223], v[148:151], v[76:79]
    s_waitcnt vmcnt(5)
    v_mfma_f32_16x16x32_bf16 v[80:83], v[208:211], v[152:155], v[80:83]
    v_mfma_f32_16x16x32_bf16 v[84:87], v[212:215], v[152:155], v[84:87]
    v_mfma_f32_16x16x32_bf16 v[88:91], v[216:219], v[152:155], v[88:91]
    v_mfma_f32_16x16x32_bf16 v[92:95], v[220:223], v[152:155], v[92:95]
    s_waitcnt vmcnt(4)
    v_mfma_f32_16x16x32_bf16 v[96:99], v[208:211], v[156:159], v[96:99]
    v_mfma_f32_16x16x32_bf16 v[100:103], v[212:215], v[156:159], v[100:103]
    v_mfma_f32_16x16x32_bf16 v[104:107], v[216:219], v[156:159], v[104:107]
    v_mfma_f32_16x16x32_bf16 v[108:111], v[220:223], v[156:159], v[108:111]
    s_waitcnt vmcnt(3)
    v_mfma_f32_16x16x32_bf16 v[48:51], v[224:227], v[160:163], v[48:51]
    v_mfma_f32_16x16x32_bf16 v[52:55], v[228:231], v[160:163], v[52:55]
    v_mfma_f32_16x16x32_bf16 v[56:59], v[232:235], v[160:163], v[56:59]
    v_mfma_f32_16x16x32_bf16 v[60:63], v[236:239], v[160:163], v[60:63]
    s_waitcnt vmcnt(2)
    v_mfma_f32_16x16x32_bf16 v[64:67], v[224:227], v[164:167], v[64:67]
    v_mfma_f32_16x16x32_bf16 v[68:71], v[228:231], v[164:167], v[68:71]
    v_mfma_f32_16x16x32_bf16 v[72:75], v[232:235], v[164:167], v[72:75]
    v_mfma_f32_16x16x32_bf16 v[76:79], v[236:239], v[164:167], v[76:79]
    s_waitcnt vmcnt(1)
    v_mfma_f32_16x16x32_bf16 v[80:83], v[224:227], v[168:171], v[80:83]
    v_mfma_f32_16x16x32_bf16 v[84:87], v[228:231], v[168:171], v[84:87]
    v_mfma_f32_16x16x32_bf16 v[88:91], v[232:235], v[168:171], v[88:91]
    v_mfma_f32_16x16x32_bf16 v[92:95], v[236:239], v[168:171], v[92:95]
    s_waitcnt vmcnt(0)
    v_mfma_f32_16x16x32_bf16 v[96:99], v[224:227], v[172:175], v[96:99]
    v_mfma_f32_16x16x32_bf16 v[100:103], v[228:231], v[172:175], v[100:103]
    v_mfma_f32_16x16x32_bf16 v[104:107], v[232:235], v[172:175], v[104:107]
    v_mfma_f32_16x16x32_bf16 v[108:111], v[236:239], v[172:175], v[108:111]
    s_setprio 0
    s_mov_b32 s53, 0
    s_nop 5
L_cw20:
    s_sleep 1
    ds_read_b32 v15, v17 offset:40
    s_waitcnt lgkmcnt(0)
    v_readfirstlane_b32 s3, v15
    s_add_u32 s53, s53, 1
    s_cmp_gt_u32 s53, 1000000
    s_nop 2
    s_cbranch_scc1 L_cw20x
    s_cmp_lt_u32 s3, 4
    s_cbranch_scc1 L_cw20
L_cw20x:
    v_lshl_add_u32 v12, v2, 13, v7
    v_xor_b32 v9, 8192, v12
    v_xor_b32 v10, 16384, v12
    v_xor_b32 v11, 12288, v252
    ds_write_b128 v9, v[64:67] offset:0
    ds_write_b128 v9, v[68:71] offset:1024
    ds_write_b128 v9, v[72:75] offset:2048
    ds_write_b128 v9, v[76:79] offset:3072
    ds_write_b128 v10, v[80:83] offset:4096
    ds_write_b128 v10, v[84:87] offset:5120
    ds_write_b128 v10, v[88:91] offset:6144
    ds_write_b128 v10, v[92:95] offset:7168
    ds_write_b128 v11, v[96:99] offset:0
    ds_write_b128 v11, v[100:103] offset:1024
    ds_write_b128 v11, v[104:107] offset:2048
    ds_write_b128 v11, v[108:111] offset:3072
    s_waitcnt lgkmcnt(0)
    v_mov_b32 v15, 1
    s_mov_b64 exec, 1
    ds_add_u32 v17, v15 offset:52
    s_mov_b64 exec, -1
    s_mov_b32 s53, 0
L_cw21:
    s_sleep 1
    ds_read_b32 v15, v17 offset:52
    s_waitcnt lgkmcnt(0)
    v_readfirstlane_b32 s3, v15
    s_add_u32 s53, s53, 1
    s_cmp_gt_u32 s53, 1000000
    s_nop 2
    s_cbranch_scc1 L_cw21x
    s_cmp_lt_u32 s3, 4
    s_cbranch_scc1 L_cw21
L_cw21x:
    ds_read_b128 v[180:183], v12 offset:0
    ds_read_b128 v[184:187], v12 offset:1024
    ds_read_b128 v[188:191], v12 offset:2048
    ds_read_b128 v[192:195], v12 offset:3072
    ds_read_b128 v[196:199], v12 offset:4096
    ds_read_b128 v[200:203], v12 offset:5120
    ds_read_b128 v[204:207], v12 offset:6144
    ds_read_b128 v[208:211], v12 offset:7168
    ds_read_b128 v[212:215], v252 offset:0
    ds_read_b128 v[216:219], v252 offset:1024
    ds_read_b128 v[220:223], v252 offset:2048
    ds_read_b128 v[224:227], v252 offset:3072
    v_lshl_add_u32 v8, v2, 12, v7
    v_add_u32 v8, 32768, v8
    s_waitcnt lgkmcnt(0)
    v_add_f32 v180, v180, v196
    v_add_f32 v181, v181, v197
    v_add_f32 v182, v182, v198
    v_add_f32 v183, v183, v199
    v_add_f32 v184, v184, v200
    v_add_f32 v185, v185, v201
    v_add_f32 v186, v186, v202
    v_add_f32 v187, v187, v203
    v_add_f32 v188, v188, v204
    v_add_f32 v189, v189, v205
    v_add_f32 v190, v190, v206
    v_add_f32 v191, v191, v207
    v_add_f32 v192, v192, v208
    v_add_f32 v193, v193, v209
    v_add_f32 v194, v194, v210
    v_add_f32 v195, v195, v211
    v_add_f32 v48, v48, v212
    v_add_f32 v49, v49, v213
    v_add_f32 v50, v50, v214
    v_add_f32 v51, v51, v215
    v_add_f32 v52, v52, v216
    v_add_f32 v53, v53, v217
    v_add_f32 v54, v54, v218
    v_add_f32 v55, v55, v219
    v_add_f32 v56, v56, v220
    v_add_f32 v57, v57, v221
    v_add_f32 v58, v58, v222
    v_add_f32 v59, v59, v223
    v_add_f32 v60, v60, v224
    v_add_f32 v61, v61, v225
    v_add_f32 v62, v62, v226
    v_add_f32 v63, v63, v227
    v_add_f32 v48, v48, v180
    v_add_f32 v49, v49, v181
    v_add_f32 v50, v50, v182
    v_add_f32 v51, v51, v183
    v_add_f32 v52, v52, v184
    v_add_f32 v53, v53, v185
    v_add_f32 v54, v54, v186
    v_add_f32 v55, v55, v187
    v_add_f32 v56, v56, v188
    v_add_f32 v57, v57, v189
    v_add_f32 v58, v58, v190
    v_add_f32 v59, v59, v191
    v_add_f32 v60, v60, v192
    v_add_f32 v61, v61, v193
    v_add_f32 v62, v62, v194
    v_add_f32 v63, v63, v195
    v_lshlrev_b32 v38, 16, v38
    v_mov_b32 v42, 1.0
    v_lshlrev_b32 v68, 16, v240
    v_and_b32 v69, 0xffff0000, v240
    v_lshlrev_b32 v70, 16, v241
    v_and_b32 v71, 0xffff0000, v241
    v_lshlrev_b32 v72, 16, v242
    v_and_b32 v73, 0xffff0000, v242
    v_lshlrev_b32 v74, 16, v243
    v_and_b32 v75, 0xffff0000, v243
    v_lshlrev_b32 v76, 16, v244
    v_and_b32 v77, 0xffff0000, v244
    v_lshlrev_b32 v78, 16, v245
    v_and_b32 v79, 0xffff0000, v245
    v_lshlrev_b32 v80, 16, v246
    v_and_b32 v81, 0xffff0000, v246
    v_lshlrev_b32 v82, 16, v247
    v_and_b32 v83, 0xffff0000, v247
    s_mov_b32 s32, s22
    s_mov_b32 s33, s23
    s_mov_b32 s34, 2097152
    s_mov_b32 s35, 0x20000
    s_lshl_b32 s3, s2, 3
    s_add_u32 s3, s3, s48
    s_cmp_lg_u32 s3, 1591
    s_cbranch_scc1 L_rs22
    s_mov_b32 s40, s24
    s_mov_b32 s41, s25
    s_mov_b32 s42, 256
    s_mov_b32 s43, 0x20000
    v_lshlrev_b32 v9, 2, v1
    buffer_store_dword v16, v9, s[40:43], 0 offen sc0 sc1
    s_nop 1
L_rs22:
    s_barrier
    ds_read_b128 v[116:119], v8 offset:0
    ds_read_b128 v[132:135], v8 offset:16384
    ds_read_b128 v[148:151], v8 offset:32768
    ds_read_b128 v[164:167], v8 offset:49152
    ds_read_b128 v[120:123], v8 offset:1024
    ds_read_b128 v[136:139], v8 offset:17408
    ds_read_b128 v[152:155], v8 offset:33792
    ds_read_b128 v[168:171], v8 offset:50176
    ds_read_b128 v[124:127], v8 offset:2048
    ds_read_b128 v[140:143], v8 offset:18432
    ds_read_b128 v[156:159], v8 offset:34816
    ds_read_b128 v[172:175], v8 offset:51200
    ds_read_b128 v[128:131], v8 offset:3072
    ds_read_b128 v[144:147], v8 offset:19456
    ds_read_b128 v[160:163], v8 offset:35840
    s_waitcnt lgkmcnt(14)
    ds_read_b128 v[176:179], v8 offset:52224
    s_waitcnt lgkmcnt(8)
    v_add_f32 v116, v116, v132
    v_add_f32 v117, v117, v133
    v_add_f32 v148, v148, v164
    v_add_f32 v149, v149, v165
    v_add_f32 v118, v118, v134
    v_add_f32 v119, v119, v135
    v_add_f32 v150, v150, v166
    v_add_f32 v151, v151, v167
    v_add_f32 v120, v120, v136
    v_add_f32 v121, v121, v137
    v_add_f32 v152, v152, v168
    v_add_f32 v153, v153, v169
    v_add_f32 v122, v122, v138
    v_add_f32 v123, v123, v139
    v_add_f32 v154, v154, v170
    v_add_f32 v155, v155, v171
    v_add_f32 v116, v116, v38
    v_add_f32 v117, v117, v38
    v_add_f32 v118, v118, v38
    v_add_f32 v119, v119, v38
    v_add_f32 v120, v120, v38
    v_add_f32 v121, v121, v38
    v_add_f32 v122, v122, v38
    v_add_f32 v123, v123, v38
    v_add_f32 v116, v116, v148
    v_add_f32 v117, v117, v149
    v_add_f32 v118, v118, v150
    v_add_f32 v119, v119, v151
    v_add_f32 v120, v120, v152
    v_add_f32 v121, v121, v153
    v_add_f32 v122, v122, v154
    v_add_f32 v123, v123, v155
    v_mul_f32 v132, v116, v43
    v_mul_f32 v133, v117, v43
    v_mul_f32 v134, v118, v43
    v_mul_f32 v135, v119, v43
    v_mul_f32 v136, v120, v43
    v_mul_f32 v137, v121, v43
    v_mul_f32 v138, v122, v43
    v_mul_f32 v139, v123, v43
    v_exp_f32 v132, v132
    v_exp_f32 v133, v133
    v_exp_f32 v134, v134
    v_exp_f32 v135, v135
    v_exp_f32 v136, v136
    v_exp_f32 v137, v137
    v_exp_f32 v138, v138
    v_exp_f32 v139, v139
    v_mul_f32 v116, v116, v48
    v_mul_f32 v117, v117, v49
    v_mul_f32 v118, v118, v50
    v_mul_f32 v119, v119, v51
    v_mul_f32 v120, v120, v52
    v_mul_f32 v121, v121, v53
    v_mul_f32 v122, v122, v54
    v_mul_f32 v123, v123, v55
    v_add_f32 v132, v132, v42
    v_add_f32 v133, v133, v42
    v_add_f32 v134, v134, v42
    v_add_f32 v135, v135, v42
    v_add_f32 v136, v136, v42
    v_add_f32 v137, v137, v42
    v_add_f32 v138, v138, v42
    v_add_f32 v139, v139, v42
    v_rcp_f32 v132, v132
    v_rcp_f32 v133, v133
    v_rcp_f32 v134, v134
    v_rcp_f32 v135, v135
    v_rcp_f32 v136, v136
    v_rcp_f32 v137, v137
    v_rcp_f32 v138, v138
    v_rcp_f32 v139, v139
    v_fma_f32 v116, v116, v132, v68
    v_fma_f32 v117, v117, v133, v69
    v_fma_f32 v118, v118, v134, v70
    v_fma_f32 v119, v119, v135, v71
    v_fma_f32 v120, v120, v136, v72
    v_fma_f32 v121, v121, v137, v73
    v_fma_f32 v122, v122, v138, v74
    v_fma_f32 v123, v123, v139, v75
    v_cvt_pk_bf16_f32 v240, v116, v117
    v_cvt_pk_bf16_f32 v241, v118, v119
    v_cvt_pk_bf16_f32 v242, v120, v121
    v_cvt_pk_bf16_f32 v243, v122, v123
    buffer_store_dwordx4 v[240:243], v39, s[32:35], s67 offen offset:0
    s_waitcnt lgkmcnt(0)
    v_add_f32 v124, v124, v140
    v_add_f32 v125, v125, v141
    v_add_f32 v156, v156, v172
    v_add_f32 v157, v157, v173
    v_add_f32 v126, v126, v142
    v_add_f32 v127, v127, v143
    v_add_f32 v158, v158, v174
    v_add_f32 v159, v159, v175
    v_add_f32 v128, v128, v144
    v_add_f32 v129, v129, v145
    v_add_f32 v160, v160, v176
    v_add_f32 v161, v161, v177
    v_add_f32 v130, v130, v146
    v_add_f32 v131, v131, v147
    v_add_f32 v162, v162, v178
    v_add_f32 v163, v163, v179
    v_add_f32 v124, v124, v38
    v_add_f32 v125, v125, v38
    v_add_f32 v126, v126, v38
    v_add_f32 v127, v127, v38
    v_add_f32 v128, v128, v38
    v_add_f32 v129, v129, v38
    v_add_f32 v130, v130, v38
    v_add_f32 v131, v131, v38
    v_add_f32 v124, v124, v156
    v_add_f32 v125, v125, v157
    v_add_f32 v126, v126, v158
    v_add_f32 v127, v127, v159
    v_add_f32 v128, v128, v160
    v_add_f32 v129, v129, v161
    v_add_f32 v130, v130, v162
    v_add_f32 v131, v131, v163
    v_mul_f32 v140, v124, v43
    v_mul_f32 v141, v125, v43
    v_mul_f32 v142, v126, v43
    v_mul_f32 v143, v127, v43
    v_mul_f32 v144, v128, v43
    v_mul_f32 v145, v129, v43
    v_mul_f32 v146, v130, v43
    v_mul_f32 v147, v131, v43
    v_exp_f32 v140, v140
    v_exp_f32 v141, v141
    v_exp_f32 v142, v142
    v_exp_f32 v143, v143
    v_exp_f32 v144, v144
    v_exp_f32 v145, v145
    v_exp_f32 v146, v146
    v_exp_f32 v147, v147
    v_mul_f32 v124, v124, v56
    v_mul_f32 v125, v125, v57
    v_mul_f32 v126, v126, v58
    v_mul_f32 v127, v127, v59
    v_mul_f32 v128, v128, v60
    v_mul_f32 v129, v129, v61
    v_mul_f32 v130, v130, v62
    v_mul_f32 v131, v131, v63
    v_add_f32 v140, v140, v42
    v_add_f32 v141, v141, v42
    v_add_f32 v142, v142, v42
    v_add_f32 v143, v143, v42
    v_add_f32 v144, v144, v42
    v_add_f32 v145, v145, v42
    v_add_f32 v146, v146, v42
    v_add_f32 v147, v147, v42
    v_rcp_f32 v140, v140
    v_rcp_f32 v141, v141
    v_rcp_f32 v142, v142
    v_rcp_f32 v143, v143
    v_rcp_f32 v144, v144
    v_rcp_f32 v145, v145
    v_rcp_f32 v146, v146
    v_rcp_f32 v147, v147
    v_fma_f32 v124, v124, v140, v76
    v_fma_f32 v125, v125, v141, v77
    v_fma_f32 v126, v126, v142, v78
    v_fma_f32 v127, v127, v143, v79
    v_fma_f32 v128, v128, v144, v80
    v_fma_f32 v129, v129, v145, v81
    v_fma_f32 v130, v130, v146, v82
    v_fma_f32 v131, v131, v147, v83
    v_cvt_pk_bf16_f32 v244, v124, v125
    v_cvt_pk_bf16_f32 v245, v126, v127
    v_cvt_pk_bf16_f32 v246, v128, v129
    v_cvt_pk_bf16_f32 v247, v130, v131
    buffer_store_dwordx4 v[244:247], v39, s[32:35], s67 offen offset:64
    s_endpgm
    s_nop 0
.p2alignl 6, 0xbf800000
L_A:
    s_lshl_b32 s54, s52, 2
    s_lshr_b32 s3, s51, 2
    s_add_u32 s54, s54, s3
    s_lshl_b32 s55, s53, 2
    s_and_b32 s3, s51, 3
    s_add_u32 s55, s55, s3
    s_add_u32 s56, s55, s54
    s_add_u32 s3, s56, 0
    s_and_b32 s96, s3, 3
    s_add_u32 s3, s56, 1
    s_and_b32 s97, s3, 3
    s_add_u32 s3, s56, 2
    s_and_b32 s98, s3, 3
    s_add_u32 s3, s56, 3
    s_and_b32 s99, s3, 3
    v_lshrrev_b32 v8, 3, v1
    v_and_b32 v10, 7, v1
    v_xor_b32 v9, v10, v3
    v_lshlrev_b32 v9, 4, v9
    v_lshl_add_u32 v24, v8, 10, v9
    v_xor_b32 v25, 64, v24
    v_add_u32 v25, 7168, v25
    v_and_b32 v9, 1, v3
    v_and_b32 v11, 1, v2
    v_lshl_or_b32 v9, v11, 1, v9
    v_lshlrev_b32 v9, 1, v9
    v_xor_b32 v9, v9, v10
    v_mul_u32_u24 v8, 3072, v8
    v_lshl_add_u32 v26, v9, 4, v8
    s_lshl_b32 s60, s54, 17
    s_lshl_b32 s3, s48, 14
    s_add_u32 s60, s60, s3
    s_lshl_b32 s61, s55, 7
    s_mul_i32 s3, s48, 24576
    s_add_u32 s61, s61, s3
    s_xor_b32 s3, s52, s50
    s_and_b32 s3, s3, 0
    s_lshl_b32 s68, s3, 7
    s_mul_i32 s69, s3, 196608
    s_sub_u32 s62, s60, s68
    s_add_u32 s62, s62, 128
    s_add_u32 s60, s60, s68
    s_sub_u32 s63, s61, s69
    s_add_u32 s63, s63, 196608
    s_add_u32 s61, s61, s69
    s_lshl_b32 s59, s48, 11
    s_mul_i32 s82, s48, 3072
    s_add_u32 s82, s82, 16384
    s_waitcnt lgkmcnt(0)
    s_mov_b32 s28, s4
    s_mov_b32 s29, s5
    s_mov_b32 s30, 2097152
    s_mov_b32 s31, 0x20000
    s_mov_b32 s32, s6
    s_mov_b32 s33, s7
    s_mov_b32 s34, 1572864
    s_mov_b32 s35, 0x20000
    s_lshl_b32 s57, s96, 8
    s_add_u32 s57, s57, s60
    s_add_u32 m0, s59, 0
    s_nop 0
    buffer_load_dwordx4 v24, s[28:31], s57 offen lds
    buffer_load_dwordx4 v25, s[28:31], s57 offen offset:1024 lds
    s_mul_i32 s58, s96, 393216
    s_add_u32 s58, s58, s61
    s_add_u32 m0, s82, 0
    s_nop 0
    buffer_load_dwordx4 v26, s[32:35], s58 offen lds
    buffer_load_dwordx4 v26, s[32:35], s58 offen offset:1024 lds
    buffer_load_dwordx4 v26, s[32:35], s58 offen offset:2048 lds
    s_barrier
    s_lshl_b32 s57, s96, 8
    s_add_u32 s57, s57, s62
    s_add_u32 m0, s59, 40960
    s_nop 0
    buffer_load_dwordx4 v24, s[28:31], s57 offen lds
    buffer_load_dwordx4 v25, s[28:31], s57 offen offset:1024 lds
    s_mul_i32 s58, s96, 393216
    s_add_u32 s58, s58, s63
    s_add_u32 m0, s82, 40960
    s_nop 0
    buffer_load_dwordx4 v26, s[32:35], s58 offen lds
    buffer_load_dwordx4 v26, s[32:35], s58 offen offset:1024 lds
    buffer_load_dwordx4 v26, s[32:35], s58 offen offset:2048 lds
L_A2:
    s_mov_b32 s36, s26
    s_mov_b32 s37, s27
    s_mov_b32 s38, 7340032
    s_mov_b32 s39, 0x20000
    s_mov_b32 s40, s24
    s_mov_b32 s41, s25
    s_mov_b32 s42, 256
    s_mov_b32 s43, 0x20000
    v_and_b32 v2, 3, v2
    s_lshl_b32 s81, s55, 2
    s_add_u32 s81, s81, s49
    v_lshrrev_b32 v8, 1, v4
    v_xor_b32 v8, v8, v3
    v_lshlrev_b32 v8, 4, v8
    v_lshl_add_u32 v32, v4, 7, v8
    v_xor_b32 v33, 64, v32
    v_add_u32 v34, 81920, v32
    v_add_u32 v35, 81920, v33
    v_and_b32 v8, 1, v3
    v_lshrrev_b32 v9, 1, v5
    v_lshl_or_b32 v9, v8, 1, v9
    v_xor_b32 v9, v2, v9
    v_lshlrev_b32 v9, 5, v9
    v_lshl_add_u32 v9, v6, 3, v9
    v_lshl_add_u32 v9, v5, 7, v9
    v_mul_u32_u24 v8, 3072, v3
    v_add_u32 v9, v9, v8
    v_add_u32 v36, 16384, v9
    v_add_u32 v37, 81920, v36
    v_mov_b32 v44, 0x3f803f80
    v_mov_b32 v45, 0x3f803f80
    v_mov_b32 v46, 0x3f803f80
    v_mov_b32 v47, 0x3f803f80
    v_lshlrev_b32 v12, 2, v3
    v_sub_u32 v12, v4, v12
    v_mov_b32 v13, 0x3f80
    v_mov_b32 v14, 0x3f800000
    v_cmp_eq_u32 vcc, 0, v12
    s_nop 1
    v_cndmask_b32 v40, 0, v13, vcc
    v_cmp_eq_u32 vcc, 1, v12
    s_nop 1
    v_cndmask_b32 v40, v40, v14, vcc
    v_cmp_eq_u32 vcc, 2, v12
    s_nop 1
    v_cndmask_b32 v41, 0, v13, vcc
    v_cmp_eq_u32 vcc, 3, v12
    s_nop 1
    v_cndmask_b32 v41, v41, v14, vcc
    v_lshlrev_b32 v42, 7, v3
    v_lshl_add_u32 v42, v4, 1, v42
    v_lshlrev_b32 v22, 3, v4
    v_add_u32 v22, 147456, v22
    v_lshlrev_b32 v23, 4, v3
    v_add_u32 v23, 149504, v23
    s_cmp_ge_u32 s48, 4
    s_nop 1
    s_cbranch_scc1 L_AQ
    s_mov_b32 s44, s18
    s_mov_b32 s45, s19
    s_mov_b32 s46, 5636096
    s_mov_b32 s47, 0x20000
    v_lshlrev_b32 v8, 1, v3
    v_and_b32 v10, 7, v1
    v_xor_b32 v8, v8, v10
    v_lshlrev_b32 v8, 4, v8
    v_lshrrev_b32 v11, 3, v1
    v_lshl_add_u32 v28, v11, 12, v8
    v_add_u32 v29, 31744, v28
    v_add_u32 v30, 63488, v28
    v_add_u32 v31, 95232, v28
    s_and_b32 s3, s65, 3
    s_mul_i32 s76, s3, 3
    s_and_b32 s3, s64, 7
    s_add_u32 s76, s76, s3
    s_and_b32 s3, s50, 1
    s_mul_i32 s3, s3, 4
    s_add_u32 s76, s76, s3
    s_cmp_ge_u32 s76, 11
    s_cselect_b32 s3, 11, 0
    s_sub_u32 s76, s76, s3
    s_mov_b32 s77, s76
    s_mul_i32 s78, s49, 1441792
    s_lshl_b32 s3, s64, 7
    s_add_u32 s78, s78, s3
    s_lshl_b32 s74, s49, 14
    s_add_u32 s74, s74, 32768
    s_mul_i32 s75, s49, 11
    s_cmp_eq_u32 s49, 0
    s_cselect_b32 s66, 0, 2130706432
    s_setprio 1
    s_waitcnt vmcnt(5)
    s_barrier
    ds_read_b64_tr_b16 v[240:241], v36 offset:1024
    ds_read_b64_tr_b16 v[242:243], v36 offset:1536
    ds_read_b64_tr_b16 v[244:245], v36 offset:2048
    ds_read_b64_tr_b16 v[246:247], v36 offset:2560
    ds_read_b128 v[176:179], v32 offset:0
    ds_read_b128 v[180:183], v32 offset:2048
    ds_read_b128 v[184:187], v32 offset:4096
    ds_read_b128 v[188:191], v32 offset:6144
    ds_read_b128 v[192:195], v32 offset:8192
    ds_read_b128 v[196:199], v32 offset:10240
    ds_read_b128 v[200:203], v32 offset:12288
    ds_read_b128 v[204:207], v32 offset:14336
    s_waitcnt lgkmcnt(8)
    v_mfma_f32_16x16x32_bf16 v[112:115], v[240:243], v[44:47], 0
    ds_read_b64_tr_b16 v[248:249], v36 offset:13312
    ds_read_b64_tr_b16 v[250:251], v36 offset:13824
    v_mfma_f32_16x16x32_bf16 v[116:119], v[44:47], v[244:247], 0
    ds_read_b64_tr_b16 v[252:253], v36 offset:14336
    ds_read_b64_tr_b16 v[254:255], v36 offset:14848
    s_waitcnt lgkmcnt(11)
    v_mfma_f32_16x16x32_bf16 v[48:51], v[240:243], v[176:179], 0
    ds_read_b128 v[208:211], v33 offset:0
    v_mfma_f32_16x16x32_bf16 v[80:83], v[176:179], v[244:247], 0
    ds_read_b128 v[212:215], v33 offset:2048
    s_lshl_b32 s57, s97, 8
    s_add_u32 s57, s57, s60
    s_add_u32 m0, s59, 81920
    s_nop 0
    buffer_load_dwordx4 v24, s[28:31], s57 offen lds
    s_waitcnt lgkmcnt(12)
    v_mfma_f32_16x16x32_bf16 v[52:55], v[240:243], v[180:183], 0
    ds_read_b128 v[216:219], v33 offset:4096
    v_mfma_f32_16x16x32_bf16 v[84:87], v[180:183], v[244:247], 0
    ds_read_b128 v[220:223], v33 offset:6144
    buffer_load_dwordx4 v25, s[28:31], s57 offen offset:1024 lds
    s_waitcnt lgkmcnt(13)
    v_mfma_f32_16x16x32_bf16 v[56:59], v[240:243], v[184:187], 0
    ds_read_b128 v[224:227], v33 offset:8192
    v_mfma_f32_16x16x32_bf16 v[88:91], v[184:187], v[244:247], 0
    ds_read_b128 v[228:231], v33 offset:10240
    s_mul_i32 s58, s97, 393216
    s_add_u32 s58, s58, s61
    s_add_u32 m0, s82, 81920
    s_nop 0
    buffer_load_dwordx4 v26, s[32:35], s58 offen lds
    s_waitcnt lgkmcnt(14)
    v_mfma_f32_16x16x32_bf16 v[60:63], v[240:243], v[188:191], 0
    ds_read_b128 v[232:235], v33 offset:12288
    v_mfma_f32_16x16x32_bf16 v[92:95], v[188:191], v[244:247], 0
    buffer_load_dwordx4 v26, s[32:35], s58 offen offset:1024 lds
    s_waitcnt lgkmcnt(14)
    v_mfma_f32_16x16x32_bf16 v[64:67], v[240:243], v[192:195], 0
    ds_read_b128 v[236:239], v33 offset:14336
    v_mfma_f32_16x16x32_bf16 v[96:99], v[192:195], v[244:247], 0
    buffer_load_dwordx4 v26, s[32:35], s58 offen offset:2048 lds
    s_waitcnt lgkmcnt(14)
    v_mfma_f32_16x16x32_bf16 v[68:71], v[240:243], v[196:199], 0
    v_mfma_f32_16x16x32_bf16 v[100:103], v[196:199], v[244:247], 0
    s_waitcnt lgkmcnt(13)
    v_mfma_f32_16x16x32_bf16 v[72:75], v[240:243], v[200:203], 0
    v_mfma_f32_16x16x32_bf16 v[104:107], v[200:203], v[244:247], 0
    s_waitcnt lgkmcnt(12)
    v_mfma_f32_16x16x32_bf16 v[76:79], v[240:243], v[204:207], 0
    v_mfma_f32_16x16x32_bf16 v[108:111], v[204:207], v[244:247], 0
    s_waitcnt lgkmcnt(0)
    s_waitcnt vmcnt(5)
    s_barrier
    v_mfma_f32_16x16x32_bf16 v[112:115], v[248:251], v[44:47], v[112:115]
    ds_read_b64_tr_b16 v[240:241], v36 offset:41984
    ds_read_b64_tr_b16 v[242:243], v36 offset:42496
    v_mfma_f32_16x16x32_bf16 v[116:119], v[44:47], v[252:255], v[116:119]
    ds_read_b64_tr_b16 v[244:245], v36 offset:43008
    ds_read_b64_tr_b16 v[246:247], v36 offset:43520
    v_mfma_f32_16x16x32_bf16 v[48:51], v[248:251], v[208:211], v[48:51]
    ds_read_b128 v[176:179], v32 offset:40960
    v_mfma_f32_16x16x32_bf16 v[80:83], v[208:211], v[252:255], v[80:83]
    ds_read_b128 v[180:183], v32 offset:43008
    v_mfma_f32_16x16x32_bf16 v[52:55], v[248:251], v[212:215], v[52:55]
    ds_read_b128 v[184:187], v32 offset:45056
    v_mfma_f32_16x16x32_bf16 v[84:87], v[212:215], v[252:255], v[84:87]
    ds_read_b128 v[188:191], v32 offset:47104
    v_mfma_f32_16x16x32_bf16 v[56:59], v[248:251], v[216:219], v[56:59]
    ds_read_b128 v[192:195], v32 offset:49152
    v_mfma_f32_16x16x32_bf16 v[88:91], v[216:219], v[252:255], v[88:91]
    ds_read_b128 v[196:199], v32 offset:51200
    v_mfma_f32_16x16x32_bf16 v[60:63], v[248:251], v[220:223], v[60:63]
    ds_read_b128 v[200:203], v32 offset:53248
    v_mfma_f32_16x16x32_bf16 v[92:95], v[220:223], v[252:255], v[92:95]
    v_mfma_f32_16x16x32_bf16 v[64:67], v[248:251], v[224:227], v[64:67]
    ds_read_b128 v[204:207], v32 offset:55296
    v_mfma_f32_16x16x32_bf16 v[96:99], v[224:227], v[252:255], v[96:99]
    v_mfma_f32_16x16x32_bf16 v[68:71], v[248:251], v[228:231], v[68:71]
    v_mfma_f32_16x16x32_bf16 v[100:103], v[228:231], v[252:255], v[100:103]
    v_mfma_f32_16x16x32_bf16 v[72:75], v[248:251], v[232:235], v[72:75]
    v_mfma_f32_16x16x32_bf16 v[104:107], v[232:235], v[252:255], v[104:107]
    v_mfma_f32_16x16x32_bf16 v[76:79], v[248:251], v[236:239], v[76:79]
    v_mfma_f32_16x16x32_bf16 v[108:111], v[236:239], v[252:255], v[108:111]
    s_waitcnt lgkmcnt(8)
    v_mfma_f32_16x16x32_bf16 v[112:115], v[240:243], v[44:47], v[112:115]
    ds_read_b64_tr_b16 v[248:249], v36 offset:54272
    ds_read_b64_tr_b16 v[250:251], v36 offset:54784
    v_mfma_f32_16x16x32_bf16 v[116:119], v[44:47], v[244:247], v[116:119]
    ds_read_b64_tr_b16 v[252:253], v36 offset:55296
    ds_read_b64_tr_b16 v[254:255], v36 offset:55808
    s_waitcnt lgkmcnt(11)
    v_mfma_f32_16x16x32_bf16 v[48:51], v[240:243], v[176:179], v[48:51]
    ds_read_b128 v[208:211], v33 offset:40960
    v_mfma_f32_16x16x32_bf16 v[80:83], v[176:179], v[244:247], v[80:83]
    ds_read_b128 v[212:215], v33 offset:43008
    s_waitcnt lgkmcnt(12)
    v_mfma_f32_16x16x32_bf16 v[52:55], v[240:243], v[180:183], v[52:55]
    ds_read_b128 v[216:219], v33 offset:45056
    v_mfma_f32_16x16x32_bf16 v[84:87], v[180:183], v[244:247], v[84:87]
    ds_read_b128 v[220:223], v33 offset:47104
    s_waitcnt lgkmcnt(13)
    v_mfma_f32_16x16x32_bf16 v[56:59], v[240:243], v[184:187], v[56:59]
    ds_read_b128 v[224:227], v33 offset:49152
    v_mfma_f32_16x16x32_bf16 v[88:91], v[184:187], v[244:247], v[88:91]
    ds_read_b128 v[228:231], v33 offset:51200
    s_waitcnt lgkmcnt(14)
    v_mfma_f32_16x16x32_bf16 v[60:63], v[240:243], v[188:191], v[60:63]
    ds_read_b128 v[232:235], v33 offset:53248
    v_mfma_f32_16x16x32_bf16 v[92:95], v[188:191], v[244:247], v[92:95]
    s_waitcnt lgkmcnt(14)
    v_mfma_f32_16x16x32_bf16 v[64:67], v[240:243], v[192:195], v[64:67]
    ds_read_b128 v[236:239], v33 offset:55296
    v_mfma_f32_16x16x32_bf16 v[96:99], v[192:195], v[244:247], v[96:99]
    s_waitcnt lgkmcnt(14)
    v_mfma_f32_16x16x32_bf16 v[68:71], v[240:243], v[196:199], v[68:71]
    v_mfma_f32_16x16x32_bf16 v[100:103], v[196:199], v[244:247], v[100:103]
    s_waitcnt lgkmcnt(13)
    v_mfma_f32_16x16x32_bf16 v[72:75], v[240:243], v[200:203], v[72:75]
    v_mfma_f32_16x16x32_bf16 v[104:107], v[200:203], v[244:247], v[104:107]
    s_waitcnt lgkmcnt(12)
    v_mfma_f32_16x16x32_bf16 v[76:79], v[240:243], v[204:207], v[76:79]
    v_mfma_f32_16x16x32_bf16 v[108:111], v[204:207], v[244:247], v[108:111]
    s_waitcnt lgkmcnt(0)
    s_waitcnt vmcnt(0)
    s_barrier
    v_mfma_f32_16x16x32_bf16 v[112:115], v[248:251], v[44:47], v[112:115]
    ds_read_b64_tr_b16 v[240:241], v37 offset:1024
    ds_read_b64_tr_b16 v[242:243], v37 offset:1536
    v_mfma_f32_16x16x32_bf16 v[116:119], v[44:47], v[252:255], v[116:119]
    ds_read_b64_tr_b16 v[244:245], v37 offset:2048
    ds_read_b64_tr_b16 v[246:247], v37 offset:2560
    v_mfma_f32_16x16x32_bf16 v[48:51], v[248:251], v[208:211], v[48:51]
    ds_read_b128 v[176:179], v34 offset:0
    v_mfma_f32_16x16x32_bf16 v[80:83], v[208:211], v[252:255], v[80:83]
    ds_read_b128 v[180:183], v34 offset:2048
    v_mfma_f32_16x16x32_bf16 v[52:55], v[248:251], v[212:215], v[52:55]
    ds_read_b128 v[184:187], v34 offset:4096
    v_mfma_f32_16x16x32_bf16 v[84:87], v[212:215], v[252:255], v[84:87]
    ds_read_b128 v[188:191], v34 offset:6144
    v_mfma_f32_16x16x32_bf16 v[56:59], v[248:251], v[216:219], v[56:59]
    ds_read_b128 v[192:195], v34 offset:8192
    v_mfma_f32_16x16x32_bf16 v[88:91], v[216:219], v[252:255], v[88:91]
    ds_read_b128 v[196:199], v34 offset:10240
    v_mfma_f32_16x16x32_bf16 v[60:63], v[248:251], v[220:223], v[60:63]
    ds_read_b128 v[200:203], v34 offset:12288
    v_mfma_f32_16x16x32_bf16 v[92:95], v[220:223], v[252:255], v[92:95]
    v_mfma_f32_16x16x32_bf16 v[64:67], v[248:251], v[224:227], v[64:67]
    ds_read_b128 v[204:207], v34 offset:14336
    v_mfma_f32_16x16x32_bf16 v[96:99], v[224:227], v[252:255], v[96:99]
    v_mfma_f32_16x16x32_bf16 v[68:71], v[248:251], v[228:231], v[68:71]
    v_mfma_f32_16x16x32_bf16 v[100:103], v[228:231], v[252:255], v[100:103]
    v_mfma_f32_16x16x32_bf16 v[72:75], v[248:251], v[232:235], v[72:75]
    v_mfma_f32_16x16x32_bf16 v[104:107], v[232:235], v[252:255], v[104:107]
    v_mfma_f32_16x16x32_bf16 v[76:79], v[248:251], v[236:239], v[76:79]
    v_mfma_f32_16x16x32_bf16 v[108:111], v[236:239], v[252:255], v[108:111]
    s_waitcnt lgkmcnt(8)
    v_mfma_f32_16x16x32_bf16 v[112:115], v[240:243], v[44:47], v[112:115]
    ds_read_b64_tr_b16 v[248:249], v37 offset:13312
    ds_read_b64_tr_b16 v[250:251], v37 offset:13824
    v_mfma_f32_16x16x32_bf16 v[116:119], v[44:47], v[244:247], v[116:119]
    ds_read_b64_tr_b16 v[252:253], v37 offset:14336
    ds_read_b64_tr_b16 v[254:255], v37 offset:14848
    s_waitcnt lgkmcnt(11)
    v_mfma_f32_16x16x32_bf16 v[48:51], v[240:243], v[176:179], v[48:51]
    ds_read_b128 v[208:211], v35 offset:0
    v_mfma_f32_16x16x32_bf16 v[80:83], v[176:179], v[244:247], v[80:83]
    ds_read_b128 v[212:215], v35 offset:2048
    s_waitcnt lgkmcnt(12)
    v_mfma_f32_16x16x32_bf16 v[52:55], v[240:243], v[180:183], v[52:55]
    ds_read_b128 v[216:219], v35 offset:4096
    v_mfma_f32_16x16x32_bf16 v[84:87], v[180:183], v[244:247], v[84:87]
    ds_read_b128 v[220:223], v35 offset:6144
    s_waitcnt lgkmcnt(13)
    v_mfma_f32_16x16x32_bf16 v[56:59], v[240:243], v[184:187], v[56:59]
    ds_read_b128 v[224:227], v35 offset:8192
    v_mfma_f32_16x16x32_bf16 v[88:91], v[184:187], v[244:247], v[88:91]
    ds_read_b128 v[228:231], v35 offset:10240
    s_waitcnt lgkmcnt(14)
    v_mfma_f32_16x16x32_bf16 v[60:63], v[240:243], v[188:191], v[60:63]
    ds_read_b128 v[232:235], v35 offset:12288
    v_mfma_f32_16x16x32_bf16 v[92:95], v[188:191], v[244:247], v[92:95]
    s_waitcnt lgkmcnt(14)
    v_mfma_f32_16x16x32_bf16 v[64:67], v[240:243], v[192:195], v[64:67]
    ds_read_b128 v[236:239], v35 offset:14336
    v_mfma_f32_16x16x32_bf16 v[96:99], v[192:195], v[244:247], v[96:99]
    s_waitcnt lgkmcnt(14)
    v_mfma_f32_16x16x32_bf16 v[68:71], v[240:243], v[196:199], v[68:71]
    v_mfma_f32_16x16x32_bf16 v[100:103], v[196:199], v[244:247], v[100:103]
    s_waitcnt lgkmcnt(13)
    v_mfma_f32_16x16x32_bf16 v[72:75], v[240:243], v[200:203], v[72:75]
    v_mfma_f32_16x16x32_bf16 v[104:107], v[200:203], v[244:247], v[104:107]
    s_waitcnt lgkmcnt(12)
    v_mfma_f32_16x16x32_bf16 v[76:79], v[240:243], v[204:207], v[76:79]
    v_mfma_f32_16x16x32_bf16 v[108:111], v[204:207], v[244:247], v[108:111]
    s_waitcnt lgkmcnt(0)
    s_barrier
    v_mfma_f32_16x16x32_bf16 v[112:115], v[248:251], v[44:47], v[112:115]
    ds_read_b64_tr_b16 v[240:241], v36 offset:1024
    ds_read_b64_tr_b16 v[242:243], v36 offset:1536
    v_mfma_f32_16x16x32_bf16 v[116:119], v[44:47], v[252:255], v[116:119]
    ds_read_b64_tr_b16 v[244:245], v36 offset:2048
    ds_read_b64_tr_b16 v[246:247], v36 offset:2560
    v_mfma_f32_16x16x32_bf16 v[48:51], v[248:251], v[208:211], v[48:51]
    ds_read_b128 v[176:179], v32 offset:0
    v_mfma_f32_16x16x32_bf16 v[80:83], v[208:211], v[252:255], v[80:83]
    ds_read_b128 v[180:183], v32 offset:2048
    v_mfma_f32_16x16x32_bf16 v[52:55], v[248:251], v[212:215], v[52:55]
    ds_read_b128 v[184:187], v32 offset:4096
    v_mfma_f32_16x16x32_bf16 v[84:87], v[212:215], v[252:255], v[84:87]
    ds_read_b128 v[188:191], v32 offset:6144
    v_mfma_f32_16x16x32_bf16 v[56:59], v[248:251], v[216:219], v[56:59]
    ds_read_b128 v[192:195], v32 offset:8192
    v_mfma_f32_16x16x32_bf16 v[88:91], v[216:219], v[252:255], v[88:91]
    ds_read_b128 v[196:199], v32 offset:10240
    v_mfma_f32_16x16x32_bf16 v[60:63], v[248:251], v[220:223], v[60:63]
    ds_read_b128 v[200:203], v32 offset:12288
    v_mfma_f32_16x16x32_bf16 v[92:95], v[220:223], v[252:255], v[92:95]
    v_mfma_f32_16x16x32_bf16 v[64:67], v[248:251], v[224:227], v[64:67]
    ds_read_b128 v[204:207], v32 offset:14336
    v_mfma_f32_16x16x32_bf16 v[96:99], v[224:227], v[252:255], v[96:99]
    v_mfma_f32_16x16x32_bf16 v[68:71], v[248:251], v[228:231], v[68:71]
    v_mfma_f32_16x16x32_bf16 v[100:103], v[228:231], v[252:255], v[100:103]
    v_mfma_f32_16x16x32_bf16 v[72:75], v[248:251], v[232:235], v[72:75]
    v_mfma_f32_16x16x32_bf16 v[104:107], v[232:235], v[252:255], v[104:107]
    v_mfma_f32_16x16x32_bf16 v[76:79], v[248:251], v[236:239], v[76:79]
    v_mfma_f32_16x16x32_bf16 v[108:111], v[236:239], v[252:255], v[108:111]
    s_waitcnt lgkmcnt(8)
    v_mfma_f32_16x16x32_bf16 v[112:115], v[240:243], v[44:47], v[112:115]
    ds_read_b64_tr_b16 v[248:249], v36 offset:13312
    ds_read_b64_tr_b16 v[250:251], v36 offset:13824
    v_mfma_f32_16x16x32_bf16 v[116:119], v[44:47], v[244:247], v[116:119]
    ds_read_b64_tr_b16 v[252:253], v36 offset:14336
    ds_read_b64_tr_b16 v[254:255], v36 offset:14848
    s_waitcnt lgkmcnt(11)
    v_mfma_f32_16x16x32_bf16 v[48:51], v[240:243], v[176:179], v[48:51]
    ds_read_b128 v[208:211], v33 offset:0
    v_mfma_f32_16x16x32_bf16 v[80:83], v[176:179], v[244:247], v[80:83]
    ds_read_b128 v[212:215], v33 offset:2048
    s_waitcnt lgkmcnt(12)
    v_mfma_f32_16x16x32_bf16 v[52:55], v[240:243], v[180:183], v[52:55]
    ds_read_b128 v[216:219], v33 offset:4096
    v_mfma_f32_16x16x32_bf16 v[84:87], v[180:183], v[244:247], v[84:87]
    ds_read_b128 v[220:223], v33 offset:6144
    s_waitcnt lgkmcnt(13)
    v_mfma_f32_16x16x32_bf16 v[56:59], v[240:243], v[184:187], v[56:59]
    ds_read_b128 v[224:227], v33 offset:8192
    v_mfma_f32_16x16x32_bf16 v[88:91], v[184:187], v[244:247], v[88:91]
    ds_read_b128 v[228:231], v33 offset:10240
    s_waitcnt lgkmcnt(14)
    v_mfma_f32_16x16x32_bf16 v[60:63], v[240:243], v[188:191], v[60:63]
    ds_read_b128 v[232:235], v33 offset:12288
    v_mfma_f32_16x16x32_bf16 v[92:95], v[188:191], v[244:247], v[92:95]
    s_waitcnt lgkmcnt(14)
    v_mfma_f32_16x16x32_bf16 v[64:67], v[240:243], v[192:195], v[64:67]
    ds_read_b128 v[236:239], v33 offset:14336
    v_mfma_f32_16x16x32_bf16 v[96:99], v[192:195], v[244:247], v[96:99]
    s_waitcnt lgkmcnt(14)
    v_mfma_f32_16x16x32_bf16 v[68:71], v[240:243], v[196:199], v[68:71]
    v_mfma_f32_16x16x32_bf16 v[100:103], v[196:199], v[244:247], v[100:103]
    s_waitcnt lgkmcnt(13)
    v_mfma_f32_16x16x32_bf16 v[72:75], v[240:243], v[200:203], v[72:75]
    v_mfma_f32_16x16x32_bf16 v[104:107], v[200:203], v[244:247], v[104:107]
    s_waitcnt lgkmcnt(12)
    v_mfma_f32_16x16x32_bf16 v[76:79], v[240:243], v[204:207], v[76:79]
    v_mfma_f32_16x16x32_bf16 v[108:111], v[204:207], v[244:247], v[108:111]
    s_waitcnt lgkmcnt(0)
    s_barrier
    v_mfma_f32_16x16x32_bf16 v[112:115], v[248:251], v[44:47], v[112:115]
    ds_read_b64_tr_b16 v[240:241], v36 offset:41984
    ds_read_b64_tr_b16 v[242:243], v36 offset:42496
    v_mfma_f32_16x16x32_bf16 v[116:119], v[44:47], v[252:255], v[116:119]
    ds_read_b64_tr_b16 v[244:245], v36 offset:43008
    ds_read_b64_tr_b16 v[246:247], v36 offset:43520
    v_mfma_f32_16x16x32_bf16 v[48:51], v[248:251], v[208:211], v[48:51]
    ds_read_b128 v[176:179], v32 offset:40960
    v_mfma_f32_16x16x32_bf16 v[80:83], v[208:211], v[252:255], v[80:83]
    ds_read_b128 v[180:183], v32 offset:43008
    v_mfma_f32_16x16x32_bf16 v[52:55], v[248:251], v[212:215], v[52:55]
    ds_read_b128 v[184:187], v32 offset:45056
    v_mfma_f32_16x16x32_bf16 v[84:87], v[212:215], v[252:255], v[84:87]
    ds_read_b128 v[188:191], v32 offset:47104
    v_mfma_f32_16x16x32_bf16 v[56:59], v[248:251], v[216:219], v[56:59]
    ds_read_b128 v[192:195], v32 offset:49152
    v_mfma_f32_16x16x32_bf16 v[88:91], v[216:219], v[252:255], v[88:91]
    ds_read_b128 v[196:199], v32 offset:51200
    v_mfma_f32_16x16x32_bf16 v[60:63], v[248:251], v[220:223], v[60:63]
    ds_read_b128 v[200:203], v32 offset:53248
    v_mfma_f32_16x16x32_bf16 v[92:95], v[220:223], v[252:255], v[92:95]
    v_mfma_f32_16x16x32_bf16 v[64:67], v[248:251], v[224:227], v[64:67]
    ds_read_b128 v[204:207], v32 offset:55296
    v_mfma_f32_16x16x32_bf16 v[96:99], v[224:227], v[252:255], v[96:99]
    v_mfma_f32_16x16x32_bf16 v[68:71], v[248:251], v[228:231], v[68:71]
    v_mfma_f32_16x16x32_bf16 v[100:103], v[228:231], v[252:255], v[100:103]
    v_mfma_f32_16x16x32_bf16 v[72:75], v[248:251], v[232:235], v[72:75]
    v_mfma_f32_16x16x32_bf16 v[104:107], v[232:235], v[252:255], v[104:107]
    v_mfma_f32_16x16x32_bf16 v[76:79], v[248:251], v[236:239], v[76:79]
    v_mfma_f32_16x16x32_bf16 v[108:111], v[236:239], v[252:255], v[108:111]
    s_waitcnt lgkmcnt(8)
    v_mfma_f32_16x16x32_bf16 v[112:115], v[240:243], v[44:47], v[112:115]
    ds_read_b64_tr_b16 v[248:249], v36 offset:54272
    ds_read_b64_tr_b16 v[250:251], v36 offset:54784
    v_mfma_f32_16x16x32_bf16 v[116:119], v[44:47], v[244:247], v[116:119]
    ds_read_b64_tr_b16 v[252:253], v36 offset:55296
    ds_read_b64_tr_b16 v[254:255], v36 offset:55808
    s_waitcnt lgkmcnt(11)
    v_mfma_f32_16x16x32_bf16 v[48:51], v[240:243], v[176:179], v[48:51]
    ds_read_b128 v[208:211], v33 offset:40960
    v_mfma_f32_16x16x32_bf16 v[80:83], v[176:179], v[244:247], v[80:83]
    ds_read_b128 v[212:215], v33 offset:43008
    s_waitcnt lgkmcnt(12)
    v_mfma_f32_16x16x32_bf16 v[52:55], v[240:243], v[180:183], v[52:55]
    ds_read_b128 v[216:219], v33 offset:45056
    v_mfma_f32_16x16x32_bf16 v[84:87], v[180:183], v[244:247], v[84:87]
    ds_read_b128 v[220:223], v33 offset:47104
    s_waitcnt lgkmcnt(13)
    v_mfma_f32_16x16x32_bf16 v[56:59], v[240:243], v[184:187], v[56:59]
    ds_read_b128 v[224:227], v33 offset:49152
    v_mfma_f32_16x16x32_bf16 v[88:91], v[184:187], v[244:247], v[88:91]
    ds_read_b128 v[228:231], v33 offset:51200
    s_waitcnt lgkmcnt(14)
    v_mfma_f32_16x16x32_bf16 v[60:63], v[240:243], v[188:191], v[60:63]
    ds_read_b128 v[232:235], v33 offset:53248
    v_mfma_f32_16x16x32_bf16 v[92:95], v[188:191], v[244:247], v[92:95]
    s_waitcnt lgkmcnt(14)
    v_mfma_f32_16x16x32_bf16 v[64:67], v[240:243], v[192:195], v[64:67]
    ds_read_b128 v[236:239], v33 offset:55296
    v_mfma_f32_16x16x32_bf16 v[96:99], v[192:195], v[244:247], v[96:99]
    s_waitcnt lgkmcnt(14)
    v_mfma_f32_16x16x32_bf16 v[68:71], v[240:243], v[196:199], v[68:71]
    v_mfma_f32_16x16x32_bf16 v[100:103], v[196:199], v[244:247], v[100:103]
    s_waitcnt lgkmcnt(13)
    v_mfma_f32_16x16x32_bf16 v[72:75], v[240:243], v[200:203], v[72:75]
    v_mfma_f32_16x16x32_bf16 v[104:107], v[200:203], v[244:247], v[104:107]
    s_waitcnt lgkmcnt(12)
    v_mfma_f32_16x16x32_bf16 v[76:79], v[240:243], v[204:207], v[76:79]
    v_mfma_f32_16x16x32_bf16 v[108:111], v[204:207], v[244:247], v[108:111]
    s_waitcnt lgkmcnt(0)
    s_barrier
    v_mfma_f32_16x16x32_bf16 v[112:115], v[248:251], v[44:47], v[112:115]
    ds_read_b64_tr_b16 v[240:241], v37 offset:1024
    ds_read_b64_tr_b16 v[242:243], v37 offset:1536
    v_mfma_f32_16x16x32_bf16 v[116:119], v[44:47], v[252:255], v[116:119]
    ds_read_b64_tr_b16 v[244:245], v37 offset:2048
    ds_read_b64_tr_b16 v[246:247], v37 offset:2560
    v_mfma_f32_16x16x32_bf16 v[48:51], v[248:251], v[208:211], v[48:51]
    ds_read_b128 v[176:179], v34 offset:0
    v_mfma_f32_16x16x32_bf16 v[80:83], v[208:211], v[252:255], v[80:83]
    ds_read_b128 v[180:183], v34 offset:2048
    v_mfma_f32_16x16x32_bf16 v[52:55], v[248:251], v[212:215], v[52:55]
    ds_read_b128 v[184:187], v34 offset:4096
    v_mfma_f32_16x16x32_bf16 v[84:87], v[212:215], v[252:255], v[84:87]
    ds_read_b128 v[188:191], v34 offset:6144
    v_mfma_f32_16x16x32_bf16 v[56:59], v[248:251], v[216:219], v[56:59]
    ds_read_b128 v[192:195], v34 offset:8192
    v_mfma_f32_16x16x32_bf16 v[88:91], v[216:219], v[252:255], v[88:91]
    ds_read_b128 v[196:199], v34 offset:10240
    v_mfma_f32_16x16x32_bf16 v[60:63], v[248:251], v[220:223], v[60:63]
    ds_read_b128 v[200:203], v34 offset:12288
    v_mfma_f32_16x16x32_bf16 v[92:95], v[220:223], v[252:255], v[92:95]
    v_mfma_f32_16x16x32_bf16 v[64:67], v[248:251], v[224:227], v[64:67]
    ds_read_b128 v[204:207], v34 offset:14336
    v_mfma_f32_16x16x32_bf16 v[96:99], v[224:227], v[252:255], v[96:99]
    v_mfma_f32_16x16x32_bf16 v[68:71], v[248:251], v[228:231], v[68:71]
    v_mfma_f32_16x16x32_bf16 v[100:103], v[228:231], v[252:255], v[100:103]
    v_mfma_f32_16x16x32_bf16 v[72:75], v[248:251], v[232:235], v[72:75]
    v_mfma_f32_16x16x32_bf16 v[104:107], v[232:235], v[252:255], v[104:107]
    v_mfma_f32_16x16x32_bf16 v[76:79], v[248:251], v[236:239], v[76:79]
    v_mfma_f32_16x16x32_bf16 v[108:111], v[236:239], v[252:255], v[108:111]
    s_waitcnt lgkmcnt(8)
    v_mfma_f32_16x16x32_bf16 v[112:115], v[240:243], v[44:47], v[112:115]
    ds_read_b64_tr_b16 v[248:249], v37 offset:13312
    ds_read_b64_tr_b16 v[250:251], v37 offset:13824
    v_mfma_f32_16x16x32_bf16 v[116:119], v[44:47], v[244:247], v[116:119]
    ds_read_b64_tr_b16 v[252:253], v37 offset:14336
    ds_read_b64_tr_b16 v[254:255], v37 offset:14848
    s_waitcnt lgkmcnt(11)
    v_mfma_f32_16x16x32_bf16 v[48:51], v[240:243], v[176:179], v[48:51]
    ds_read_b128 v[208:211], v35 offset:0
    v_mfma_f32_16x16x32_bf16 v[80:83], v[176:179], v[244:247], v[80:83]
    ds_read_b128 v[212:215], v35 offset:2048
    s_waitcnt lgkmcnt(12)
    v_mfma_f32_16x16x32_bf16 v[52:55], v[240:243], v[180:183], v[52:55]
    ds_read_b128 v[216:219], v35 offset:4096
    v_mfma_f32_16x16x32_bf16 v[84:87], v[180:183], v[244:247], v[84:87]
    ds_read_b128 v[220:223], v35 offset:6144
    s_waitcnt lgkmcnt(13)
    v_mfma_f32_16x16x32_bf16 v[56:59], v[240:243], v[184:187], v[56:59]
    ds_read_b128 v[224:227], v35 offset:8192
    v_mfma_f32_16x16x32_bf16 v[88:91], v[184:187], v[244:247], v[88:91]
    ds_read_b128 v[228:231], v35 offset:10240
    s_waitcnt lgkmcnt(14)
    v_mfma_f32_16x16x32_bf16 v[60:63], v[240:243], v[188:191], v[60:63]
    ds_read_b128 v[232:235], v35 offset:12288
    v_mfma_f32_16x16x32_bf16 v[92:95], v[188:191], v[244:247], v[92:95]
    s_waitcnt lgkmcnt(14)
    v_mfma_f32_16x16x32_bf16 v[64:67], v[240:243], v[192:195], v[64:67]
    ds_read_b128 v[236:239], v35 offset:14336
    v_mfma_f32_16x16x32_bf16 v[96:99], v[192:195], v[244:247], v[96:99]
    s_waitcnt lgkmcnt(14)
    v_mfma_f32_16x16x32_bf16 v[68:71], v[240:243], v[196:199], v[68:71]
    v_mfma_f32_16x16x32_bf16 v[100:103], v[196:199], v[244:247], v[100:103]
    s_waitcnt lgkmcnt(13)
    v_mfma_f32_16x16x32_bf16 v[72:75], v[240:243], v[200:203], v[72:75]
    v_mfma_f32_16x16x32_bf16 v[104:107], v[200:203], v[244:247], v[104:107]
    s_waitcnt lgkmcnt(12)
    v_mfma_f32_16x16x32_bf16 v[76:79], v[240:243], v[204:207], v[76:79]
    v_mfma_f32_16x16x32_bf16 v[108:111], v[204:207], v[244:247], v[108:111]
    s_waitcnt lgkmcnt(0)
    s_barrier
    s_mov_b32 s32, s8
    s_mov_b32 s33, s9
    s_mov_b32 s34, 16384
    s_mov_b32 s35, 0x20000
    s_lshl_b32 s52, s81, 9
    v_mfma_f32_16x16x32_bf16 v[112:115], v[248:251], v[44:47], v[112:115]
    ds_read_b64_tr_b16 v[240:241], v36 offset:1024
    ds_read_b64_tr_b16 v[242:243], v36 offset:1536
    v_mfma_f32_16x16x32_bf16 v[116:119], v[44:47], v[252:255], v[116:119]
    ds_read_b64_tr_b16 v[244:245], v36 offset:2048
    ds_read_b64_tr_b16 v[246:247], v36 offset:2560
    v_mfma_f32_16x16x32_bf16 v[48:51], v[248:251], v[208:211], v[48:51]
    ds_read_b128 v[176:179], v32 offset:0
    v_mfma_f32_16x16x32_bf16 v[80:83], v[208:211], v[252:255], v[80:83]
    ds_read_b128 v[180:183], v32 offset:2048
    buffer_load_ushort v120, v42, s[32:35], s52 offen offset:0
    v_mfma_f32_16x16x32_bf16 v[52:55], v[248:251], v[212:215], v[52:55]
    ds_read_b128 v[184:187], v32 offset:4096
    v_mfma_f32_16x16x32_bf16 v[84:87], v[212:215], v[252:255], v[84:87]
    ds_read_b128 v[188:191], v32 offset:6144
    buffer_load_ushort v121, v42, s[32:35], s52 offen offset:32
    v_mfma_f32_16x16x32_bf16 v[56:59], v[248:251], v[216:219], v[56:59]
    ds_read_b128 v[192:195], v32 offset:8192
    v_mfma_f32_16x16x32_bf16 v[88:91], v[216:219], v[252:255], v[88:91]
    ds_read_b128 v[196:199], v32 offset:10240
    buffer_load_ushort v122, v42, s[32:35], s52 offen offset:64
    v_mfma_f32_16x16x32_bf16 v[60:63], v[248:251], v[220:223], v[60:63]
    ds_read_b128 v[200:203], v32 offset:12288
    v_mfma_f32_16x16x32_bf16 v[92:95], v[220:223], v[252:255], v[92:95]
    buffer_load_ushort v123, v42, s[32:35], s52 offen offset:96
    v_mfma_f32_16x16x32_bf16 v[64:67], v[248:251], v[224:227], v[64:67]
    ds_read_b128 v[204:207], v32 offset:14336
    v_mfma_f32_16x16x32_bf16 v[96:99], v[224:227], v[252:255], v[96:99]
    v_mfma_f32_16x16x32_bf16 v[68:71], v[248:251], v[228:231], v[68:71]
    v_mfma_f32_16x16x32_bf16 v[100:103], v[228:231], v[252:255], v[100:103]
    v_mfma_f32_16x16x32_bf16 v[72:75], v[248:251], v[232:235], v[72:75]
    v_mfma_f32_16x16x32_bf16 v[104:107], v[232:235], v[252:255], v[104:107]
    v_mfma_f32_16x16x32_bf16 v[76:79], v[248:251], v[236:239], v[76:79]
    v_mfma_f32_16x16x32_bf16 v[108:111], v[236:239], v[252:255], v[108:111]
    s_waitcnt lgkmcnt(8)
    v_mfma_f32_16x16x32_bf16 v[112:115], v[240:243], v[44:47], v[112:115]
    ds_read_b64_tr_b16 v[248:249], v36 offset:13312
    ds_read_b64_tr_b16 v[250:251], v36 offset:13824
    v_mfma_f32_16x16x32_bf16 v[116:119], v[44:47], v[244:247], v[116:119]
    ds_read_b64_tr_b16 v[252:253], v36 offset:14336
    ds_read_b64_tr_b16 v[254:255], v36 offset:14848
    s_waitcnt lgkmcnt(11)
    v_mfma_f32_16x16x32_bf16 v[48:51], v[240:243], v[176:179], v[48:51]
    ds_read_b128 v[208:211], v33 offset:0
    v_mfma_f32_16x16x32_bf16 v[80:83], v[176:179], v[244:247], v[80:83]
    ds_read_b128 v[212:215], v33 offset:2048
    s_waitcnt lgkmcnt(12)
    v_mfma_f32_16x16x32_bf16 v[52:55], v[240:243], v[180:183], v[52:55]
    ds_read_b128 v[216:219], v33 offset:4096
    v_mfma_f32_16x16x32_bf16 v[84:87], v[180:183], v[244:247], v[84:87]
    ds_read_b128 v[220:223], v33 offset:6144
    s_waitcnt lgkmcnt(13)
    v_mfma_f32_16x16x32_bf16 v[56:59], v[240:243], v[184:187], v[56:59]
    ds_read_b128 v[224:227], v33 offset:8192
    v_mfma_f32_16x16x32_bf16 v[88:91], v[184:187], v[244:247], v[88:91]
    ds_read_b128 v[228:231], v33 offset:10240
    s_waitcnt lgkmcnt(14)
    v_mfma_f32_16x16x32_bf16 v[60:63], v[240:243], v[188:191], v[60:63]
    ds_read_b128 v[232:235], v33 offset:12288
    v_mfma_f32_16x16x32_bf16 v[92:95], v[188:191], v[244:247], v[92:95]
    s_waitcnt lgkmcnt(14)
    v_mfma_f32_16x16x32_bf16 v[64:67], v[240:243], v[192:195], v[64:67]
    ds_read_b128 v[236:239], v33 offset:14336
    v_mfma_f32_16x16x32_bf16 v[96:99], v[192:195], v[244:247], v[96:99]
    s_waitcnt lgkmcnt(14)
    v_mfma_f32_16x16x32_bf16 v[68:71], v[240:243], v[196:199], v[68:71]
    v_mfma_f32_16x16x32_bf16 v[100:103], v[196:199], v[244:247], v[100:103]
    s_waitcnt lgkmcnt(13)
    v_mfma_f32_16x16x32_bf16 v[72:75], v[240:243], v[200:203], v[72:75]
    v_mfma_f32_16x16x32_bf16 v[104:107], v[200:203], v[244:247], v[104:107]
    s_waitcnt lgkmcnt(12)
    v_mfma_f32_16x16x32_bf16 v[76:79], v[240:243], v[204:207], v[76:79]
    v_mfma_f32_16x16x32_bf16 v[108:111], v[204:207], v[244:247], v[108:111]
    s_waitcnt lgkmcnt(0)
    s_barrier
    v_mfma_f32_16x16x32_bf16 v[112:115], v[248:251], v[44:47], v[112:115]
    ds_read_b64_tr_b16 v[240:241], v36 offset:41984
    ds_read_b64_tr_b16 v[242:243], v36 offset:42496
    v_mfma_f32_16x16x32_bf16 v[116:119], v[44:47], v[252:255], v[116:119]
    ds_read_b64_tr_b16 v[244:245], v36 offset:43008
    ds_read_b64_tr_b16 v[246:247], v36 offset:43520
    v_mfma_f32_16x16x32_bf16 v[48:51], v[248:251], v[208:211], v[48:51]
    ds_read_b128 v[176:179], v32 offset:40960
    v_mfma_f32_16x16x32_bf16 v[80:83], v[208:211], v[252:255], v[80:83]
    ds_read_b128 v[180:183], v32 offset:43008
    v_mfma_f32_16x16x32_bf16 v[52:55], v[248:251], v[212:215], v[52:55]
    ds_read_b128 v[184:187], v32 offset:45056
    v_mfma_f32_16x16x32_bf16 v[84:87], v[212:215], v[252:255], v[84:87]
    ds_read_b128 v[188:191], v32 offset:47104
    v_mfma_f32_16x16x32_bf16 v[56:59], v[248:251], v[216:219], v[56:59]
    ds_read_b128 v[192:195], v32 offset:49152
    v_mfma_f32_16x16x32_bf16 v[88:91], v[216:219], v[252:255], v[88:91]
    ds_read_b128 v[196:199], v32 offset:51200
    v_mfma_f32_16x16x32_bf16 v[60:63], v[248:251], v[220:223], v[60:63]
    ds_read_b128 v[200:203], v32 offset:53248
    v_mfma_f32_16x16x32_bf16 v[92:95], v[220:223], v[252:255], v[92:95]
    v_mfma_f32_16x16x32_bf16 v[64:67], v[248:251], v[224:227], v[64:67]
    ds_read_b128 v[204:207], v32 offset:55296
    v_mfma_f32_16x16x32_bf16 v[96:99], v[224:227], v[252:255], v[96:99]
    v_mfma_f32_16x16x32_bf16 v[68:71], v[248:251], v[228:231], v[68:71]
    v_mfma_f32_16x16x32_bf16 v[100:103], v[228:231], v[252:255], v[100:103]
    v_mfma_f32_16x16x32_bf16 v[72:75], v[248:251], v[232:235], v[72:75]
    v_mfma_f32_16x16x32_bf16 v[104:107], v[232:235], v[252:255], v[104:107]
    v_mfma_f32_16x16x32_bf16 v[76:79], v[248:251], v[236:239], v[76:79]
    v_mfma_f32_16x16x32_bf16 v[108:111], v[236:239], v[252:255], v[108:111]
    s_waitcnt lgkmcnt(8)
    v_mfma_f32_16x16x32_bf16 v[112:115], v[240:243], v[44:47], v[112:115]
    ds_read_b64_tr_b16 v[248:249], v36 offset:54272
    ds_read_b64_tr_b16 v[250:251], v36 offset:54784
    v_mfma_f32_16x16x32_bf16 v[116:119], v[44:47], v[244:247], v[116:119]
    ds_read_b64_tr_b16 v[252:253], v36 offset:55296
    ds_read_b64_tr_b16 v[254:255], v36 offset:55808
    s_waitcnt lgkmcnt(11)
    v_mfma_f32_16x16x32_bf16 v[48:51], v[240:243], v[176:179], v[48:51]
    ds_read_b128 v[208:211], v33 offset:40960
    v_mfma_f32_16x16x32_bf16 v[80:83], v[176:179], v[244:247], v[80:83]
    ds_read_b128 v[212:215], v33 offset:43008
    s_waitcnt lgkmcnt(12)
    v_mfma_f32_16x16x32_bf16 v[52:55], v[240:243], v[180:183], v[52:55]
    ds_read_b128 v[216:219], v33 offset:45056
    v_mfma_f32_16x16x32_bf16 v[84:87], v[180:183], v[244:247], v[84:87]
    ds_read_b128 v[220:223], v33 offset:47104
    s_waitcnt lgkmcnt(13)
    v_mfma_f32_16x16x32_bf16 v[56:59], v[240:243], v[184:187], v[56:59]
    ds_read_b128 v[224:227], v33 offset:49152
    v_mfma_f32_16x16x32_bf16 v[88:91], v[184:187], v[244:247], v[88:91]
    ds_read_b128 v[228:231], v33 offset:51200
    s_waitcnt lgkmcnt(14)
    v_mfma_f32_16x16x32_bf16 v[60:63], v[240:243], v[188:191], v[60:63]
    ds_read_b128 v[232:235], v33 offset:53248
    v_mfma_f32_16x16x32_bf16 v[92:95], v[188:191], v[244:247], v[92:95]
    s_waitcnt lgkmcnt(14)
    v_mfma_f32_16x16x32_bf16 v[64:67], v[240:243], v[192:195], v[64:67]
    ds_read_b128 v[236:239], v33 offset:55296
    v_mfma_f32_16x16x32_bf16 v[96:99], v[192:195], v[244:247], v[96:99]
    s_waitcnt lgkmcnt(14)
    v_mfma_f32_16x16x32_bf16 v[68:71], v[240:243], v[196:199], v[68:71]
    v_mfma_f32_16x16x32_bf16 v[100:103], v[196:199], v[244:247], v[100:103]
    s_waitcnt lgkmcnt(13)
    v_mfma_f32_16x16x32_bf16 v[72:75], v[240:243], v[200:203], v[72:75]
    v_mfma_f32_16x16x32_bf16 v[104:107], v[200:203], v[244:247], v[104:107]
    s_waitcnt lgkmcnt(12)
    v_mfma_f32_16x16x32_bf16 v[76:79], v[240:243], v[204:207], v[76:79]
    v_mfma_f32_16x16x32_bf16 v[108:111], v[204:207], v[244:247], v[108:111]
    s_waitcnt lgkmcnt(0)
    s_barrier
    v_mfma_f32_16x16x32_bf16 v[112:115], v[248:251], v[44:47], v[112:115]
    ds_read_b64 v[18:19], v17 offset:16
    ds_read_b64 v[124:125], v22 offset:0
    v_mfma_f32_16x16x32_bf16 v[116:119], v[44:47], v[252:255], v[116:119]
    ds_read_b64 v[126:127], v22 offset:128
    ds_read_b64 v[128:129], v22 offset:256
    v_mfma_f32_16x16x32_bf16 v[48:51], v[248:251], v[208:211], v[48:51]
    ds_read_b64 v[130:131], v22 offset:384
    v_mfma_f32_16x16x32_bf16 v[80:83], v[208:211], v[252:255], v[80:83]
    ds_read_b64 v[132:133], v22 offset:512
    v_mfma_f32_16x16x32_bf16 v[52:55], v[248:251], v[212:215], v[52:55]
    ds_read_b64 v[134:135], v22 offset:640
    v_mfma_f32_16x16x32_bf16 v[84:87], v[212:215], v[252:255], v[84:87]
    ds_read_b64 v[136:137], v22 offset:768
    v_mfma_f32_16x16x32_bf16 v[56:59], v[248:251], v[216:219], v[56:59]
    ds_read_b64 v[138:139], v22 offset:896
    v_mfma_f32_16x16x32_bf16 v[88:91], v[216:219], v[252:255], v[88:91]
    ds_read_b128 v[176:179], v23 offset:0
    v_mfma_f32_16x16x32_bf16 v[60:63], v[248:251], v[220:223], v[60:63]
    ds_read_b128 v[180:183], v23 offset:512
    v_mfma_f32_16x16x32_bf16 v[92:95], v[220:223], v[252:255], v[92:95]
    v_mfma_f32_16x16x32_bf16 v[64:67], v[248:251], v[224:227], v[64:67]
    ds_read_b128 v[184:187], v23 offset:64
    v_mfma_f32_16x16x32_bf16 v[96:99], v[224:227], v[252:255], v[96:99]
    v_mfma_f32_16x16x32_bf16 v[68:71], v[248:251], v[228:231], v[68:71]
    ds_read_b128 v[188:191], v23 offset:576
    v_mfma_f32_16x16x32_bf16 v[100:103], v[228:231], v[252:255], v[100:103]
    v_mfma_f32_16x16x32_bf16 v[72:75], v[248:251], v[232:235], v[72:75]
    ds_read_b128 v[192:195], v23 offset:128
    v_mfma_f32_16x16x32_bf16 v[104:107], v[232:235], v[252:255], v[104:107]
    v_mfma_f32_16x16x32_bf16 v[76:79], v[248:251], v[236:239], v[76:79]
    ds_read_b128 v[196:199], v23 offset:640
    v_mfma_f32_16x16x32_bf16 v[108:111], v[236:239], v[252:255], v[108:111]
    s_waitcnt lgkmcnt(14)
    ds_read_b128 v[200:203], v23 offset:192
    s_waitcnt lgkmcnt(14)
    ds_read_b128 v[204:207], v23 offset:704
    s_waitcnt lgkmcnt(14)
    ds_read_b128 v[208:211], v23 offset:256
    s_waitcnt lgkmcnt(14)
    ds_read_b128 v[212:215], v23 offset:768
    s_waitcnt lgkmcnt(14)
    ds_read_b128 v[216:219], v23 offset:320
    s_waitcnt lgkmcnt(14)
    ds_read_b128 v[220:223], v23 offset:832
    s_waitcnt lgkmcnt(14)
    ds_read_b128 v[224:227], v23 offset:384
    s_waitcnt lgkmcnt(14)
    ds_read_b128 v[228:231], v23 offset:896
    s_waitcnt lgkmcnt(14)
    ds_read_b128 v[232:235], v23 offset:448
    s_waitcnt lgkmcnt(14)
    ds_read_b128 v[236:239], v23 offset:960
    s_waitcnt vmcnt(0)
    v_lshl_or_b32 v38, v121, 16, v120
    v_lshl_or_b32 v39, v123, 16, v122
    v_fmac_f32 v48, v112, v125
    v_fmac_f32 v49, v113, v125
    v_fmac_f32 v50, v114, v125
    v_fmac_f32 v51, v115, v125
    v_cvt_pk_bf16_f32 v140, v48, v49
    v_cvt_pk_bf16_f32 v141, v50, v51
    v_mul_f32 v124, 0x3fb8aa3b, v124
    v_fmac_f32 v52, v112, v127
    v_fmac_f32 v53, v113, v127
    v_fmac_f32 v54, v114, v127
    v_fmac_f32 v55, v115, v127
    v_cvt_pk_bf16_f32 v142, v52, v53
    v_cvt_pk_bf16_f32 v143, v54, v55
    v_mul_f32 v126, 0x3fb8aa3b, v126
    v_mfma_f32_16x16x16_bf16 v[48:51], v[38:39], v[140:141], 0
    v_fmac_f32 v56, v112, v129
    v_fmac_f32 v57, v113, v129
    v_fmac_f32 v58, v114, v129
    v_fmac_f32 v59, v115, v129
    v_cvt_pk_bf16_f32 v144, v56, v57
    v_cvt_pk_bf16_f32 v145, v58, v59
    v_mul_f32 v128, 0x3fb8aa3b, v128
    v_mfma_f32_16x16x16_bf16 v[52:55], v[38:39], v[142:143], 0
    v_fmac_f32 v60, v112, v131
    v_fmac_f32 v61, v113, v131
    v_fmac_f32 v62, v114, v131
    v_fmac_f32 v63, v115, v131
    v_cvt_pk_bf16_f32 v146, v60, v61
    v_cvt_pk_bf16_f32 v147, v62, v63
    v_mul_f32 v130, 0x3fb8aa3b, v130
    v_mfma_f32_16x16x16_bf16 v[56:59], v[38:39], v[144:145], 0
    v_fmac_f32 v64, v112, v133
    v_fmac_f32 v65, v113, v133
    v_fmac_f32 v66, v114, v133
    v_fmac_f32 v67, v115, v133
    v_cvt_pk_bf16_f32 v148, v64, v65
    v_cvt_pk_bf16_f32 v149, v66, v67
    v_mul_f32 v132, 0x3fb8aa3b, v132
    v_mfma_f32_16x16x16_bf16 v[60:63], v[38:39], v[146:147], 0
    v_fmac_f32 v68, v112, v135
    v_fmac_f32 v69, v113, v135
    v_fmac_f32 v70, v114, v135
    v_fmac_f32 v71, v115, v135
    v_cvt_pk_bf16_f32 v150, v68, v69
    v_cvt_pk_bf16_f32 v151, v70, v71
    v_mul_f32 v134, 0x3fb8aa3b, v134
    v_mfma_f32_16x16x16_bf16 v[64:67], v[38:39], v[148:149], 0
    v_fmac_f32 v72, v112, v137
    v_fmac_f32 v73, v113, v137
    v_fmac_f32 v74, v114, v137
    v_fmac_f32 v75, v115, v137
    v_cvt_pk_bf16_f32 v152, v72, v73
    v_cvt_pk_bf16_f32 v153, v74, v75
    v_mul_f32 v136, 0x3fb8aa3b, v136
    v_mfma_f32_16x16x16_bf16 v[68:71], v[38:39], v[150:151], 0
    v_fmac_f32 v76, v112, v139
    v_fmac_f32 v77, v113, v139
    v_fmac_f32 v78, v114, v139
    v_fmac_f32 v79, v115, v139
    v_cvt_pk_bf16_f32 v154, v76, v77
    v_cvt_pk_bf16_f32 v155, v78, v79
    v_mul_f32 v138, 0x3fb8aa3b, v138
    v_mfma_f32_16x16x16_bf16 v[72:75], v[38:39], v[152:153], 0
    v_mfma_f32_16x16x16_bf16 v[76:79], v[38:39], v[154:155], 0
    s_waitcnt lgkmcnt(0)
    v_fmac_f32 v80, v116, v180
    v_fmac_f32 v81, v117, v181
    v_fmac_f32 v82, v116, v182
    v_fmac_f32 v83, v117, v183
    v_mul_f32 v80, v80, v176
    v_mul_f32 v81, v81, v177
    v_mul_f32 v82, v82, v178
    v_mul_f32 v83, v83, v179
    v_cvt_pk_bf16_f32 v156, v80, v81
    v_cvt_pk_bf16_f32 v157, v82, v83
    v_fmac_f32 v84, v116, v188
    v_fmac_f32 v85, v117, v189
    v_fmac_f32 v86, v116, v190
    v_fmac_f32 v87, v117, v191
    v_mul_f32 v84, v84, v184
    v_mul_f32 v85, v85, v185
    v_mul_f32 v86, v86, v186
    v_mul_f32 v87, v87, v187
    v_cvt_pk_bf16_f32 v158, v84, v85
    v_cvt_pk_bf16_f32 v159, v86, v87
    v_fmac_f32 v88, v116, v196
    v_fmac_f32 v89, v117, v197
    v_fmac_f32 v90, v116, v198
    v_fmac_f32 v91, v117, v199
    v_mul_f32 v88, v88, v192
    v_mul_f32 v89, v89, v193
    v_mul_f32 v90, v90, v194
    v_mul_f32 v91, v91, v195
    v_cvt_pk_bf16_f32 v160, v88, v89
    v_cvt_pk_bf16_f32 v161, v90, v91
    v_fmac_f32 v92, v116, v204
    v_fmac_f32 v93, v117, v205
    v_fmac_f32 v94, v116, v206
    v_fmac_f32 v95, v117, v207
    v_mul_f32 v92, v92, v200
    v_mul_f32 v93, v93, v201
    v_mul_f32 v94, v94, v202
    v_mul_f32 v95, v95, v203
    v_cvt_pk_bf16_f32 v162, v92, v93
    v_cvt_pk_bf16_f32 v163, v94, v95
    v_fmac_f32 v96, v116, v212
    v_fmac_f32 v97, v117, v213
    v_fmac_f32 v98, v116, v214
    v_fmac_f32 v99, v117, v215
    v_mul_f32 v96, v96, v208
    v_mul_f32 v97, v97, v209
    v_mul_f32 v98, v98, v210
    v_mul_f32 v99, v99, v211
    v_cvt_pk_bf16_f32 v164, v96, v97
    v_cvt_pk_bf16_f32 v165, v98, v99
    v_fmac_f32 v100, v116, v220
    v_fmac_f32 v101, v117, v221
    v_fmac_f32 v102, v116, v222
    v_fmac_f32 v103, v117, v223
    v_mul_f32 v100, v100, v216
    v_mul_f32 v101, v101, v217
    v_mul_f32 v102, v102, v218
    v_mul_f32 v103, v103, v219
    v_cvt_pk_bf16_f32 v166, v100, v101
    v_cvt_pk_bf16_f32 v167, v102, v103
    v_fmac_f32 v104, v116, v228
    v_fmac_f32 v105, v117, v229
    v_fmac_f32 v106, v116, v230
    v_fmac_f32 v107, v117, v231
    v_mul_f32 v104, v104, v224
    v_mul_f32 v105, v105, v225
    v_mul_f32 v106, v106, v226
    v_mul_f32 v107, v107, v227
    v_cvt_pk_bf16_f32 v168, v104, v105
    v_cvt_pk_bf16_f32 v169, v106, v107
    v_fmac_f32 v108, v116, v236
    v_fmac_f32 v109, v117, v237
    v_fmac_f32 v110, v116, v238
    v_fmac_f32 v111, v117, v239
    v_mul_f32 v108, v108, v232
    v_mul_f32 v109, v109, v233
    v_mul_f32 v110, v110, v234
    v_mul_f32 v111, v111, v235
    v_cvt_pk_bf16_f32 v170, v108, v109
    v_cvt_pk_bf16_f32 v171, v110, v111
    v_max3_f32 v176, v48, v49, v50
    v_max3_f32 v200, v56, v57, v58
    v_max3_f32 v177, -v48, -v49, -v50
    v_max3_f32 v201, -v56, -v57, -v58
    v_max_f32 v176, v176, v51
    v_max_f32 v200, v200, v59
    v_max_f32_e64 v177, v177, -v51
    v_max_f32_e64 v201, v201, -v59
    v_max3_f32 v178, v52, v53, v54
    v_max3_f32 v202, v60, v61, v62
    v_max3_f32 v179, -v52, -v53, -v54
    v_max3_f32 v203, -v60, -v61, -v62
    v_max_f32 v178, v178, v55
    v_max_f32 v202, v202, v63
    v_max_f32_e64 v179, v179, -v55
    v_max_f32_e64 v203, v203, -v63
    v_permlane32_swap_b32 v176, v177
    v_permlane32_swap_b32 v200, v201
    v_permlane32_swap_b32 v178, v179
    v_permlane32_swap_b32 v202, v203
    v_max_f32 v176, v176, v177
    v_max_f32 v200, v200, v201
    v_max_f32 v178, v178, v179
    v_max_f32 v202, v202, v203
    s_nop 0
    v_permlane16_swap_b32 v176, v178
    v_permlane16_swap_b32 v200, v202
    v_max_f32 v176, v176, v178
    v_max_f32 v200, v200, v202
    v_mov_b32 v178, v176
    v_mov_b32 v202, v200
    s_nop 0
    v_permlane16_swap_b32 v176, v178
    v_permlane16_swap_b32 v200, v202
    v_mul_f32 v176, v176, v124
    v_mul_f32 v200, v200, v128
    v_mul_f32 v178, v178, v126
    v_mul_f32 v202, v202, v130
    v_mov_b32 v177, v176
    v_mov_b32 v201, v200
    v_mov_b32 v179, v178
    v_mov_b32 v203, v202
    v_permlane32_swap_b32 v176, v177
    v_permlane32_swap_b32 v200, v201
    v_permlane32_swap_b32 v178, v179
    v_permlane32_swap_b32 v202, v203
    v_fma_f32 v182, v48, v124, -v176
    v_fma_f32 v183, v49, v124, -v176
    v_fma_f32 v206, v56, v128, -v200
    v_fma_f32 v207, v57, v128, -v200
    v_fma_f32 v186, -v48, v124, -v177
    v_fma_f32 v187, -v49, v124, -v177
    v_fma_f32 v210, -v56, v128, -v201
    v_fma_f32 v211, -v57, v128, -v201
    v_fma_f32 v184, v50, v124, -v176
    v_fma_f32 v185, v51, v124, -v176
    v_fma_f32 v208, v58, v128, -v200
    v_fma_f32 v209, v59, v128, -v200
    v_fma_f32 v188, -v50, v124, -v177
    v_fma_f32 v189, -v51, v124, -v177
    v_fma_f32 v212, -v58, v128, -v201
    v_fma_f32 v213, -v59, v128, -v201
    v_fma_f32 v190, v52, v126, -v178
    v_fma_f32 v191, v53, v126, -v178
    v_fma_f32 v214, v60, v130, -v202
    v_fma_f32 v215, v61, v130, -v202
    v_fma_f32 v194, -v52, v126, -v179
    v_fma_f32 v195, -v53, v126, -v179
    v_fma_f32 v218, -v60, v130, -v203
    v_fma_f32 v219, -v61, v130, -v203
    v_fma_f32 v192, v54, v126, -v178
    v_fma_f32 v193, v55, v126, -v178
    v_fma_f32 v216, v62, v130, -v202
    v_fma_f32 v217, v63, v130, -v202
    v_fma_f32 v196, -v54, v126, -v179
    v_fma_f32 v197, -v55, v126, -v179
    v_fma_f32 v220, -v62, v130, -v203
    v_fma_f32 v221, -v63, v130, -v203
    v_exp_f32 v182, v182
    v_exp_f32 v206, v206
    v_exp_f32 v183, v183
    v_exp_f32 v207, v207
    v_exp_f32 v184, v184
    v_exp_f32 v208, v208
    v_exp_f32 v185, v185
    v_exp_f32 v209, v209
    v_exp_f32 v186, v186
    v_exp_f32 v210, v210
    v_exp_f32 v187, v187
    v_exp_f32 v211, v211
    v_exp_f32 v188, v188
    v_exp_f32 v212, v212
    v_exp_f32 v189, v189
    v_exp_f32 v213, v213
    v_exp_f32 v190, v190
    v_exp_f32 v214, v214
    v_exp_f32 v191, v191
    v_exp_f32 v215, v215
    v_exp_f32 v192, v192
    v_exp_f32 v216, v216
    v_exp_f32 v193, v193
    v_exp_f32 v217, v217
    v_exp_f32 v194, v194
    v_exp_f32 v218, v218
    v_exp_f32 v195, v195
    v_exp_f32 v219, v219
    v_exp_f32 v196, v196
    v_exp_f32 v220, v220
    v_exp_f32 v197, v197
    v_exp_f32 v221, v221
    v_add_f32 v180, v182, v184
    v_add_f32 v181, v183, v185
    v_add_f32 v204, v206, v208
    v_add_f32 v205, v207, v209
    v_add_f32 v176, v180, v181
    v_add_f32 v200, v204, v205
    v_add_f32 v180, v186, v188
    v_add_f32 v181, v187, v189
    v_add_f32 v204, v210, v212
    v_add_f32 v205, v211, v213
    v_add_f32 v177, v180, v181
    v_add_f32 v201, v204, v205
    v_add_f32 v180, v190, v192
    v_add_f32 v181, v191, v193
    v_add_f32 v204, v214, v216
    v_add_f32 v205, v215, v217
    v_add_f32 v178, v180, v181
    v_add_f32 v202, v204, v205
    v_add_f32 v180, v194, v196
    v_add_f32 v181, v195, v197
    v_add_f32 v204, v218, v220
    v_add_f32 v205, v219, v221
    v_add_f32 v179, v180, v181
    v_add_f32 v203, v204, v205
    v_permlane32_swap_b32 v176, v177
    v_permlane32_swap_b32 v200, v201
    v_permlane32_swap_b32 v178, v179
    v_permlane32_swap_b32 v202, v203
    v_add_f32 v176, v176, v177
    v_add_f32 v200, v200, v201
    v_add_f32 v178, v178, v179
    v_add_f32 v202, v202, v203
    s_nop 0
    v_permlane16_swap_b32 v176, v178
    v_permlane16_swap_b32 v200, v202
    v_add_f32 v176, v176, v178
    v_add_f32 v200, v200, v202
    v_rcp_f32 v176, v176
    v_rcp_f32 v200, v200
    v_mov_b32 v178, v176
    v_mov_b32 v202, v200
    s_nop 0
    v_permlane16_swap_b32 v176, v178
    v_permlane16_swap_b32 v200, v202
    v_mov_b32 v177, v176
    v_mov_b32 v201, v200
    v_mov_b32 v179, v178
    v_mov_b32 v203, v202
    v_permlane32_swap_b32 v176, v177
    v_permlane32_swap_b32 v200, v201
    v_permlane32_swap_b32 v178, v179
    v_permlane32_swap_b32 v202, v203
    v_mul_f32 v182, v182, v176
    v_mul_f32 v183, v183, v176
    v_mul_f32 v206, v206, v200
    v_mul_f32 v207, v207, v200
    v_mul_f32 v184, v184, v176
    v_mul_f32 v185, v185, v176
    v_mul_f32 v208, v208, v200
    v_mul_f32 v209, v209, v200
    v_cvt_pk_bf16_f32 v48, v182, v183
    v_cvt_pk_bf16_f32 v56, v206, v207
    v_cvt_pk_bf16_f32 v49, v184, v185
    v_cvt_pk_bf16_f32 v57, v208, v209
    v_mul_f32 v186, v186, v177
    v_mul_f32 v187, v187, v177
    v_mul_f32 v210, v210, v201
    v_mul_f32 v211, v211, v201
    v_mul_f32 v188, v188, v177
    v_mul_f32 v189, v189, v177
    v_mul_f32 v212, v212, v201
    v_mul_f32 v213, v213, v201
    v_cvt_pk_bf16_f32 v50, v186, v187
    v_cvt_pk_bf16_f32 v58, v210, v211
    v_cvt_pk_bf16_f32 v51, v188, v189
    v_cvt_pk_bf16_f32 v59, v212, v213
    v_mul_f32 v190, v190, v178
    v_mul_f32 v191, v191, v178
    v_mul_f32 v214, v214, v202
    v_mul_f32 v215, v215, v202
    v_mul_f32 v192, v192, v178
    v_mul_f32 v193, v193, v178
    v_mul_f32 v216, v216, v202
    v_mul_f32 v217, v217, v202
    v_cvt_pk_bf16_f32 v52, v190, v191
    v_cvt_pk_bf16_f32 v60, v214, v215
    v_cvt_pk_bf16_f32 v53, v192, v193
    v_cvt_pk_bf16_f32 v61, v216, v217
    v_mul_f32 v194, v194, v179
    v_mul_f32 v195, v195, v179
    v_mul_f32 v218, v218, v203
    v_mul_f32 v219, v219, v203
    v_mul_f32 v196, v196, v179
    v_mul_f32 v197, v197, v179
    v_mul_f32 v220, v220, v203
    v_mul_f32 v221, v221, v203
    v_cvt_pk_bf16_f32 v54, v194, v195
    v_cvt_pk_bf16_f32 v62, v218, v219
    v_cvt_pk_bf16_f32 v55, v196, v197
    v_cvt_pk_bf16_f32 v63, v220, v221
    v_mfma_f32_16x16x16_bf16 v[80:83], v[48:49], v[40:41], 0
    v_mfma_f32_16x16x16_bf16 v[96:99], v[50:51], v[40:41], 0
    v_mfma_f32_16x16x16_bf16 v[84:87], v[52:53], v[40:41], 0
    v_mfma_f32_16x16x16_bf16 v[100:103], v[54:55], v[40:41], 0
    v_mfma_f32_16x16x16_bf16 v[88:91], v[56:57], v[40:41], 0
    v_mfma_f32_16x16x16_bf16 v[104:107], v[58:59], v[40:41], 0
    v_mfma_f32_16x16x16_bf16 v[92:95], v[60:61], v[40:41], 0
    v_mfma_f32_16x16x16_bf16 v[108:111], v[62:63], v[40:41], 0
    v_max3_f32 v176, v64, v65, v66
    v_max3_f32 v200, v72, v73, v74
    v_max3_f32 v177, -v64, -v65, -v66
    v_max3_f32 v201, -v72, -v73, -v74
    v_max_f32 v176, v176, v67
    v_max_f32 v200, v200, v75
    v_max_f32_e64 v177, v177, -v67
    v_max_f32_e64 v201, v201, -v75
    v_max3_f32 v178, v68, v69, v70
    v_max3_f32 v202, v76, v77, v78
    v_max3_f32 v179, -v68, -v69, -v70
    v_max3_f32 v203, -v76, -v77, -v78
    v_max_f32 v178, v178, v71
    v_max_f32 v202, v202, v79
    v_max_f32_e64 v179, v179, -v71
    v_max_f32_e64 v203, v203, -v79
    v_permlane32_swap_b32 v176, v177
    v_permlane32_swap_b32 v200, v201
    v_permlane32_swap_b32 v178, v179
    v_permlane32_swap_b32 v202, v203
    v_max_f32 v176, v176, v177
    v_max_f32 v200, v200, v201
    v_max_f32 v178, v178, v179
    v_max_f32 v202, v202, v203
    s_nop 0
    v_permlane16_swap_b32 v176, v178
    v_permlane16_swap_b32 v200, v202
    v_max_f32 v176, v176, v178
    v_max_f32 v200, v200, v202
    v_mov_b32 v178, v176
    v_mov_b32 v202, v200
    s_nop 0
    v_permlane16_swap_b32 v176, v178
    v_permlane16_swap_b32 v200, v202
    v_mul_f32 v176, v176, v132
    v_mul_f32 v200, v200, v136
    v_mul_f32 v178, v178, v134
    v_mul_f32 v202, v202, v138
    v_mov_b32 v177, v176
    v_mov_b32 v201, v200
    v_mov_b32 v179, v178
    v_mov_b32 v203, v202
    v_permlane32_swap_b32 v176, v177
    v_permlane32_swap_b32 v200, v201
    v_permlane32_swap_b32 v178, v179
    v_permlane32_swap_b32 v202, v203
    v_fma_f32 v182, v64, v132, -v176
    v_fma_f32 v183, v65, v132, -v176
    v_fma_f32 v206, v72, v136, -v200
    v_fma_f32 v207, v73, v136, -v200
    v_fma_f32 v186, -v64, v132, -v177
    v_fma_f32 v187, -v65, v132, -v177
    v_fma_f32 v210, -v72, v136, -v201
    v_fma_f32 v211, -v73, v136, -v201
    v_fma_f32 v184, v66, v132, -v176
    v_fma_f32 v185, v67, v132, -v176
    v_fma_f32 v208, v74, v136, -v200
    v_fma_f32 v209, v75, v136, -v200
    v_fma_f32 v188, -v66, v132, -v177
    v_fma_f32 v189, -v67, v132, -v177
    v_fma_f32 v212, -v74, v136, -v201
    v_fma_f32 v213, -v75, v136, -v201
    v_fma_f32 v190, v68, v134, -v178
    v_fma_f32 v191, v69, v134, -v178
    v_fma_f32 v214, v76, v138, -v202
    v_fma_f32 v215, v77, v138, -v202
    v_fma_f32 v194, -v68, v134, -v179
    v_fma_f32 v195, -v69, v134, -v179
    v_fma_f32 v218, -v76, v138, -v203
    v_fma_f32 v219, -v77, v138, -v203
    v_fma_f32 v192, v70, v134, -v178
    v_fma_f32 v193, v71, v134, -v178
    v_fma_f32 v216, v78, v138, -v202
    v_fma_f32 v217, v79, v138, -v202
    v_fma_f32 v196, -v70, v134, -v179
    v_fma_f32 v197, -v71, v134, -v179
    v_fma_f32 v220, -v78, v138, -v203
    v_fma_f32 v221, -v79, v138, -v203
    v_exp_f32 v182, v182
    v_exp_f32 v206, v206
    v_exp_f32 v183, v183
    v_exp_f32 v207, v207
    v_exp_f32 v184, v184
    v_exp_f32 v208, v208
    v_exp_f32 v185, v185
    v_exp_f32 v209, v209
    v_exp_f32 v186, v186
    v_exp_f32 v210, v210
    v_exp_f32 v187, v187
    v_exp_f32 v211, v211
    v_exp_f32 v188, v188
    v_exp_f32 v212, v212
    v_exp_f32 v189, v189
    v_exp_f32 v213, v213
    v_exp_f32 v190, v190
    v_exp_f32 v214, v214
    v_exp_f32 v191, v191
    v_exp_f32 v215, v215
    v_exp_f32 v192, v192
    v_exp_f32 v216, v216
    v_exp_f32 v193, v193
    v_exp_f32 v217, v217
    v_exp_f32 v194, v194
    v_exp_f32 v218, v218
    v_exp_f32 v195, v195
    v_exp_f32 v219, v219
    v_exp_f32 v196, v196
    v_exp_f32 v220, v220
    v_exp_f32 v197, v197
    v_exp_f32 v221, v221
    v_add_f32 v180, v182, v184
    v_add_f32 v181, v183, v185
    v_add_f32 v204, v206, v208
    v_add_f32 v205, v207, v209
    v_add_f32 v176, v180, v181
    v_add_f32 v200, v204, v205
    v_add_f32 v180, v186, v188
    v_add_f32 v181, v187, v189
    v_add_f32 v204, v210, v212
    v_add_f32 v205, v211, v213
    v_add_f32 v177, v180, v181
    v_add_f32 v201, v204, v205
    v_add_f32 v180, v190, v192
    v_add_f32 v181, v191, v193
    v_add_f32 v204, v214, v216
    v_add_f32 v205, v215, v217
    v_add_f32 v178, v180, v181
    v_add_f32 v202, v204, v205
    v_add_f32 v180, v194, v196
    v_add_f32 v181, v195, v197
    v_add_f32 v204, v218, v220
    v_add_f32 v205, v219, v221
    v_add_f32 v179, v180, v181
    v_add_f32 v203, v204, v205
    v_permlane32_swap_b32 v176, v177
    v_permlane32_swap_b32 v200, v201
    v_permlane32_swap_b32 v178, v179
    v_permlane32_swap_b32 v202, v203
    v_add_f32 v176, v176, v177
    v_add_f32 v200, v200, v201
    v_add_f32 v178, v178, v179
    v_add_f32 v202, v202, v203
    s_nop 0
    v_permlane16_swap_b32 v176, v178
    v_permlane16_swap_b32 v200, v202
    v_add_f32 v176, v176, v178
    v_add_f32 v200, v200, v202
    v_rcp_f32 v176, v176
    v_rcp_f32 v200, v200
    v_mov_b32 v178, v176
    v_mov_b32 v202, v200
    s_nop 0
    v_permlane16_swap_b32 v176, v178
    v_permlane16_swap_b32 v200, v202
    v_mov_b32 v177, v176
    v_mov_b32 v201, v200
    v_mov_b32 v179, v178
    v_mov_b32 v203, v202
    v_permlane32_swap_b32 v176, v177
    v_permlane32_swap_b32 v200, v201
    v_permlane32_swap_b32 v178, v179
    v_permlane32_swap_b32 v202, v203
    v_mul_f32 v182, v182, v176
    v_mul_f32 v183, v183, v176
    v_mul_f32 v206, v206, v200
    v_mul_f32 v207, v207, v200
    v_mul_f32 v184, v184, v176
    v_mul_f32 v185, v185, v176
    v_mul_f32 v208, v208, v200
    v_mul_f32 v209, v209, v200
    v_cvt_pk_bf16_f32 v64, v182, v183
    v_cvt_pk_bf16_f32 v72, v206, v207
    v_cvt_pk_bf16_f32 v65, v184, v185
    v_cvt_pk_bf16_f32 v73, v208, v209
    v_mul_f32 v186, v186, v177
    v_mul_f32 v187, v187, v177
    v_mul_f32 v210, v210, v201
    v_mul_f32 v211, v211, v201
    v_mul_f32 v188, v188, v177
    v_mul_f32 v189, v189, v177
    v_mul_f32 v212, v212, v201
    v_mul_f32 v213, v213, v201
    v_cvt_pk_bf16_f32 v66, v186, v187
    v_cvt_pk_bf16_f32 v74, v210, v211
    v_cvt_pk_bf16_f32 v67, v188, v189
    v_cvt_pk_bf16_f32 v75, v212, v213
    v_mul_f32 v190, v190, v178
    v_mul_f32 v191, v191, v178
    v_mul_f32 v214, v214, v202
    v_mul_f32 v215, v215, v202
    v_mul_f32 v192, v192, v178
    v_mul_f32 v193, v193, v178
    v_mul_f32 v216, v216, v202
    v_mul_f32 v217, v217, v202
    v_cvt_pk_bf16_f32 v68, v190, v191
    v_cvt_pk_bf16_f32 v76, v214, v215
    v_cvt_pk_bf16_f32 v69, v192, v193
    v_cvt_pk_bf16_f32 v77, v216, v217
    v_mul_f32 v194, v194, v179
    v_mul_f32 v195, v195, v179
    v_mul_f32 v218, v218, v203
    v_mul_f32 v219, v219, v203
    v_mul_f32 v196, v196, v179
    v_mul_f32 v197, v197, v179
    v_mul_f32 v220, v220, v203
    v_mul_f32 v221, v221, v203
    v_cvt_pk_bf16_f32 v70, v194, v195
    v_cvt_pk_bf16_f32 v78, v218, v219
    v_cvt_pk_bf16_f32 v71, v196, v197
    v_cvt_pk_bf16_f32 v79, v220, v221
    v_cvt_pk_bf16_f32 v140, v80, v81
    v_cvt_pk_bf16_f32 v141, v82, v83
    v_cvt_pk_bf16_f32 v142, v84, v85
    v_cvt_pk_bf16_f32 v143, v86, v87
    v_cvt_pk_bf16_f32 v144, v88, v89
    v_cvt_pk_bf16_f32 v145, v90, v91
    v_cvt_pk_bf16_f32 v146, v92, v93
    v_cvt_pk_bf16_f32 v147, v94, v95
    v_cvt_pk_bf16_f32 v148, v96, v97
    v_cvt_pk_bf16_f32 v149, v98, v99
    v_cvt_pk_bf16_f32 v150, v100, v101
    v_cvt_pk_bf16_f32 v151, v102, v103
    v_cvt_pk_bf16_f32 v152, v104, v105
    v_cvt_pk_bf16_f32 v153, v106, v107
    v_cvt_pk_bf16_f32 v154, v108, v109
    v_cvt_pk_bf16_f32 v155, v110, v111
    v_mfma_f32_16x16x32_bf16 v[240:243], v[140:143], v[156:159], 0
    v_mfma_f32_16x16x32_bf16 v[248:251], v[140:143], v[44:47], 0
    v_mfma_f32_16x16x32_bf16 v[244:247], v[148:151], v[156:159], 0
    v_mfma_f32_16x16x32_bf16 v[252:255], v[148:151], v[44:47], 0
    v_mfma_f32_16x16x32_bf16 v[240:243], v[144:147], v[160:163], v[240:243]
    v_mfma_f32_16x16x32_bf16 v[248:251], v[144:147], v[44:47], v[248:251]
    v_mfma_f32_16x16x32_bf16 v[244:247], v[152:155], v[160:163], v[244:247]
    v_mfma_f32_16x16x32_bf16 v[252:255], v[152:155], v[44:47], v[252:255]
    v_mfma_f32_16x16x16_bf16 v[80:83], v[64:65], v[40:41], 0
    v_mfma_f32_16x16x16_bf16 v[96:99], v[66:67], v[40:41], 0
    v_mfma_f32_16x16x16_bf16 v[84:87], v[68:69], v[40:41], 0
    v_mfma_f32_16x16x16_bf16 v[100:103], v[70:71], v[40:41], 0
    v_mfma_f32_16x16x16_bf16 v[88:91], v[72:73], v[40:41], 0
    v_mfma_f32_16x16x16_bf16 v[104:107], v[74:75], v[40:41], 0
    v_mfma_f32_16x16x16_bf16 v[92:95], v[76:77], v[40:41], 0
    v_mfma_f32_16x16x16_bf16 v[108:111], v[78:79], v[40:41], 0
    s_lshl_b32 s52, s81, 4
    s_add_u32 s52, s52, s54
    s_lshl_b32 s68, s52, 10
    s_add_u32 s68, s68, 6291456
    s_lshl_b32 s69, s52, 7
    s_add_u32 s69, s69, 6815744
    v_lshlrev_b32 v13, 4, v3
    v_cvt_pk_bf16_f32 v140, v80, v81
    v_cvt_pk_bf16_f32 v141, v82, v83
    v_cvt_pk_bf16_f32 v142, v84, v85
    v_cvt_pk_bf16_f32 v143, v86, v87
    v_cvt_pk_bf16_f32 v144, v88, v89
    v_cvt_pk_bf16_f32 v145, v90, v91
    v_cvt_pk_bf16_f32 v146, v92, v93
    v_cvt_pk_bf16_f32 v147, v94, v95
    v_cvt_pk_bf16_f32 v148, v96, v97
    v_cvt_pk_bf16_f32 v149, v98, v99
    v_cvt_pk_bf16_f32 v150, v100, v101
    v_cvt_pk_bf16_f32 v151, v102, v103
    v_cvt_pk_bf16_f32 v152, v104, v105
    v_cvt_pk_bf16_f32 v153, v106, v107
    v_cvt_pk_bf16_f32 v154, v108, v109
    v_cvt_pk_bf16_f32 v155, v110, v111
    v_mfma_f32_16x16x32_bf16 v[240:243], v[140:143], v[164:167], v[240:243]
    v_mfma_f32_16x16x32_bf16 v[248:251], v[140:143], v[44:47], v[248:251]
    v_mfma_f32_16x16x32_bf16 v[244:247], v[148:151], v[164:167], v[244:247]
    v_mfma_f32_16x16x32_bf16 v[252:255], v[148:151], v[44:47], v[252:255]
    v_mfma_f32_16x16x32_bf16 v[240:243], v[144:147], v[168:171], v[240:243]
    v_mfma_f32_16x16x32_bf16 v[248:251], v[144:147], v[44:47], v[248:251]
    v_mfma_f32_16x16x32_bf16 v[244:247], v[152:155], v[168:171], v[244:247]
    v_mfma_f32_16x16x32_bf16 v[252:255], v[152:155], v[44:47], v[252:255]
    s_lshl_b32 s70, s55, 9
    s_add_u32 s70, s70, s54
    s_lshl_b32 s70, s70, 2
    s_add_u32 s70, s70, 7077888
    s_nop 0
    v_cvt_pk_bf16_f32 v48, v240, v241
    v_cvt_pk_bf16_f32 v49, v242, v243
    v_cvt_pk_bf16_f32 v50, v244, v245
    v_cvt_pk_bf16_f32 v51, v246, v247
    buffer_store_dwordx4 v[48:51], v7, s[36:39], s68 offen sc0 sc1
    s_mov_b32 exec_lo, 0x00010001
    s_mov_b32 exec_hi, 0x00010001
    buffer_store_dwordx4 v[248:251], v13, s[36:39], s69 offen sc0 sc1
    buffer_store_dwordx4 v[252:255], v13, s[36:39], s69 offen offset:64 sc0 sc1
    s_mov_b64 exec, -1
    s_lshl_b32 s59, s49, 12
    s_add_u32 s59, s59, 98304
    v_add_u32 v23, s59, v7
    v_lshl_add_u32 v10, v3, 2, v5
    v_bfe_u32 v11, v10, 1, 2
    v_lshlrev_b32 v10, 7, v10
    v_lshl_add_u32 v10, v6, 3, v10
    v_lshl_add_u32 v10, v11, 5, v10
    v_xor_b32 v11, 0, v10
    v_add_u32 v36, s59, v11
    v_add_u32 v32, s74, v11
    v_xor_b32 v11, 32, v10
    v_add_u32 v37, s59, v11
    v_add_u32 v33, s74, v11
    v_xor_b32 v11, 64, v10
    v_add_u32 v38, s59, v11
    v_add_u32 v34, s74, v11
    v_xor_b32 v11, 96, v10
    v_add_u32 v39, s59, v11
    v_add_u32 v35, s74, v11
    v_add_u32 v44, 0, v7
    v_add_u32 v45, 44032, v7
    v_add_u32 v46, 88064, v7
    v_add_u32 v47, 132096, v7
    s_mul_i32 s61, s65, 176128
    s_add_u32 s61, s61, 2097152
    s_lshl_b32 s73, s65, 5
    s_add_u32 s73, s73, s64
    s_lshl_b32 s73, s73, 7
    s_add_u32 s73, s73, 7110656
    s_mul_i32 s3, s49, 14
    s_and_b32 s3, s3, -4
    s_add_u32 s73, s73, s3
    s_waitcnt vmcnt(0)
    v_mov_b32 v15, 1
    s_mov_b64 exec, 1
    ds_add_u32 v17, v15 offset:8
    s_mov_b64 exec, -1
    s_cmp_lg_u32 s49, 0
    s_cbranch_scc1 L_pb23
    s_mov_b32 s53, 0
L_cw24:
    s_sleep 1
    ds_read_b32 v15, v17 offset:8
    s_waitcnt lgkmcnt(0)
    v_readfirstlane_b32 s3, v15
    s_add_u32 s53, s53, 1
    s_cmp_gt_u32 s53, 1000000
    s_nop 2
    s_cbranch_scc1 L_cw24x
    s_cmp_lt_u32 s3, 4
    s_cbranch_scc1 L_cw24
L_cw24x:
    v_lshlrev_b32 v14, 7, v1
    s_mov_b64 exec, 0xffff
    buffer_store_dword v18, v14, s[36:39], s70 offen sc0 sc1
    s_mov_b64 exec, -1
L_pb23:
    s_waitcnt lgkmcnt(0)
    s_setprio 0
    s_add_u32 s76, s76, 1
    s_cmp_eq_u32 s76, 11
    s_cselect_b32 s76, 0, s76
    s_add_u32 s76, s76, 1
    s_cmp_eq_u32 s76, 11
    s_cselect_b32 s76, 0, s76
    s_add_u32 s76, s76, 1
    s_cmp_eq_u32 s76, 11
    s_cselect_b32 s76, 0, s76
    s_add_u32 s76, s76, 1
    s_cmp_eq_u32 s76, 11
    s_cselect_b32 s76, 0, s76
    s_mov_b32 s53, 0
L_cw25:
    s_sleep 1
    ds_read_b32 v15, v17 offset:60
    s_waitcnt lgkmcnt(0)
    v_readfirstlane_b32 s3, v15
    s_add_u32 s53, s53, 1
    s_cmp_gt_u32 s53, 1000000
    s_nop 2
    s_cbranch_scc1 L_cw25x
    s_cmp_lt_u32 s3, 4
    s_cbranch_scc1 L_cw25
L_cw25x:
    ds_read_b64_tr_b16 v[176:177], v32 offset:0
    ds_read_b64_tr_b16 v[178:179], v32 offset:2048
    ds_read_b64_tr_b16 v[180:181], v33 offset:0
    ds_read_b64_tr_b16 v[182:183], v33 offset:2048
    ds_read_b64_tr_b16 v[184:185], v34 offset:0
    ds_read_b64_tr_b16 v[186:187], v34 offset:2048
    ds_read_b64_tr_b16 v[188:189], v35 offset:0
    ds_read_b64_tr_b16 v[190:191], v35 offset:2048
    ds_read_b64_tr_b16 v[192:193], v32 offset:4096
    ds_read_b64_tr_b16 v[194:195], v32 offset:6144
    ds_read_b64_tr_b16 v[196:197], v33 offset:4096
    ds_read_b64_tr_b16 v[198:199], v33 offset:6144
    ds_read_b64_tr_b16 v[200:201], v34 offset:4096
    ds_read_b64_tr_b16 v[202:203], v34 offset:6144
    ds_read_b64_tr_b16 v[204:205], v35 offset:4096
    s_waitcnt lgkmcnt(14)
    ds_read_b64_tr_b16 v[206:207], v35 offset:6144
    s_waitcnt lgkmcnt(14)
    ds_read_b64_tr_b16 v[208:209], v32 offset:8192
    s_waitcnt lgkmcnt(14)
    ds_read_b64_tr_b16 v[210:211], v32 offset:10240
    s_waitcnt lgkmcnt(14)
    ds_read_b64_tr_b16 v[212:213], v33 offset:8192
    s_waitcnt lgkmcnt(14)
    ds_read_b64_tr_b16 v[214:215], v33 offset:10240
    s_waitcnt lgkmcnt(14)
    ds_read_b64_tr_b16 v[216:217], v34 offset:8192
    s_waitcnt lgkmcnt(14)
    ds_read_b64_tr_b16 v[218:219], v34 offset:10240
    s_waitcnt lgkmcnt(14)
    ds_read_b64_tr_b16 v[220:221], v35 offset:8192
    s_waitcnt lgkmcnt(14)
    ds_read_b64_tr_b16 v[222:223], v35 offset:10240
    s_waitcnt lgkmcnt(14)
    ds_read_b64_tr_b16 v[224:225], v32 offset:12288
    s_waitcnt lgkmcnt(14)
    ds_read_b64_tr_b16 v[226:227], v32 offset:14336
    s_waitcnt lgkmcnt(14)
    ds_read_b64_tr_b16 v[228:229], v33 offset:12288
    s_waitcnt lgkmcnt(14)
    ds_read_b64_tr_b16 v[230:231], v33 offset:14336
    s_waitcnt lgkmcnt(14)
    ds_read_b64_tr_b16 v[232:233], v34 offset:12288
    s_waitcnt lgkmcnt(14)
    ds_read_b64_tr_b16 v[234:235], v34 offset:14336
    s_waitcnt lgkmcnt(14)
    ds_read_b64_tr_b16 v[236:237], v35 offset:12288
    s_waitcnt lgkmcnt(14)
    ds_read_b64_tr_b16 v[238:239], v35 offset:14336
    s_waitcnt lgkmcnt(0)
    s_lshl_b32 s58, s76, 17
    s_add_u32 s58, s58, s78
    s_add_u32 m0, s74, 12288
    s_nop 0
    buffer_load_dwordx4 v28, s[44:47], s58 offen lds
    s_add_u32 s76, s76, 1
    s_cmp_eq_u32 s76, 11
    s_cselect_b32 s76, 0, s76
    buffer_load_dwordx4 v29, s[44:47], s58 offen offset:1024 lds
    buffer_load_dwordx4 v30, s[44:47], s58 offen offset:2048 lds
    buffer_load_dwordx4 v31, s[44:47], s58 offen offset:3072 lds
    s_lshl_b32 s58, s76, 17
    s_add_u32 s58, s58, s78
    s_add_u32 m0, s74, 0
    s_nop 0
    buffer_load_dwordx4 v28, s[44:47], s58 offen lds
    s_add_u32 s76, s76, 1
    s_cmp_eq_u32 s76, 11
    s_cselect_b32 s76, 0, s76
    buffer_load_dwordx4 v29, s[44:47], s58 offen offset:1024 lds
    buffer_load_dwordx4 v30, s[44:47], s58 offen offset:2048 lds
    buffer_load_dwordx4 v31, s[44:47], s58 offen offset:3072 lds
    s_lshl_b32 s58, s76, 17
    s_add_u32 s58, s58, s78
    s_add_u32 m0, s74, 4096
    s_nop 0
    buffer_load_dwordx4 v28, s[44:47], s58 offen lds
    s_add_u32 s76, s76, 1
    s_cmp_eq_u32 s76, 11
    s_cselect_b32 s76, 0, s76
    buffer_load_dwordx4 v29, s[44:47], s58 offen offset:1024 lds
    buffer_load_dwordx4 v30, s[44:47], s58 offen offset:2048 lds
    buffer_load_dwordx4 v31, s[44:47], s58 offen offset:3072 lds
    s_lshl_b32 s58, s76, 17
    s_add_u32 s58, s58, s78
    s_add_u32 m0, s74, 8192
    s_nop 0
    buffer_load_dwordx4 v28, s[44:47], s58 offen lds
    s_add_u32 s76, s76, 1
    s_cmp_eq_u32 s76, 11
    s_cselect_b32 s76, 0, s76
    buffer_load_dwordx4 v29, s[44:47], s58 offen offset:1024 lds
    buffer_load_dwordx4 v30, s[44:47], s58 offen offset:2048 lds
    buffer_load_dwordx4 v31, s[44:47], s58 offen offset:3072 lds
    s_waitcnt vmcnt(12)
    ds_read_b64_tr_b16 v[240:241], v32 offset:12288
    ds_read_b64_tr_b16 v[242:243], v32 offset:14336
    ds_read_b64_tr_b16 v[244:245], v33 offset:12288
    ds_read_b64_tr_b16 v[246:247], v33 offset:14336
    ds_read_b64_tr_b16 v[248:249], v34 offset:12288
    ds_read_b64_tr_b16 v[250:251], v34 offset:14336
    ds_read_b64_tr_b16 v[252:253], v35 offset:12288
    ds_read_b64_tr_b16 v[254:255], v35 offset:14336
    s_waitcnt lgkmcnt(0)
    s_lshl_b32 s58, s76, 17
    s_add_u32 s58, s58, s78
    s_add_u32 m0, s74, 12288
    s_nop 0
    buffer_load_dwordx4 v28, s[44:47], s58 offen lds
    s_add_u32 s76, s76, 1
    s_cmp_eq_u32 s76, 11
    s_cselect_b32 s76, 0, s76
    buffer_load_dwordx4 v29, s[44:47], s58 offen offset:1024 lds
    buffer_load_dwordx4 v30, s[44:47], s58 offen offset:2048 lds
    buffer_load_dwordx4 v31, s[44:47], s58 offen offset:3072 lds
    s_mov_b32 s53, 0
L_cw26:
    s_sleep 1
    ds_read_b32 v15, v17 offset:40
    s_waitcnt lgkmcnt(0)
    v_readfirstlane_b32 s3, v15
    s_add_u32 s53, s53, 1
    s_cmp_gt_u32 s53, 1000000
    s_nop 2
    s_cbranch_scc1 L_cw26x
    s_cmp_lt_u32 s3, 4
    s_cbranch_scc1 L_cw26
L_cw26x:
    s_lshl_b32 s58, s76, 17
    s_add_u32 s58, s58, s78
    s_add_u32 m0, s59, 0
    s_nop 0
    buffer_load_dwordx4 v28, s[44:47], s58 offen lds
    s_add_u32 s76, s76, 1
    s_cmp_eq_u32 s76, 11
    s_cselect_b32 s76, 0, s76
    buffer_load_dwordx4 v29, s[44:47], s58 offen offset:1024 lds
    buffer_load_dwordx4 v30, s[44:47], s58 offen offset:2048 lds
    buffer_load_dwordx4 v31, s[44:47], s58 offen offset:3072 lds
    s_lshl_b32 s58, s76, 17
    s_add_u32 s58, s58, s78
    s_add_u32 m0, s59, 32768
    s_nop 0
    buffer_load_dwordx4 v28, s[44:47], s58 offen lds
    s_add_u32 s76, s76, 1
    s_cmp_eq_u32 s76, 11
    s_cselect_b32 s76, 0, s76
    buffer_load_dwordx4 v29, s[44:47], s58 offen offset:1024 lds
    buffer_load_dwordx4 v30, s[44:47], s58 offen offset:2048 lds
    buffer_load_dwordx4 v31, s[44:47], s58 offen offset:3072 lds
    s_branch L_Y
.p2alignl 6, 0xbf800000
L_AQ:
    s_mov_b32 s44, s18
    s_mov_b32 s45, s19
    s_mov_b32 s46, 5636096
    s_mov_b32 s47, 0x20000
    v_lshlrev_b32 v8, 1, v3
    v_and_b32 v10, 7, v1
    v_xor_b32 v8, v8, v10
    v_lshlrev_b32 v8, 4, v8
    v_lshrrev_b32 v11, 3, v1
    v_lshl_add_u32 v28, v11, 12, v8
    v_add_u32 v29, 31744, v28
    v_add_u32 v30, 63488, v28
    v_add_u32 v31, 95232, v28
    s_and_b32 s3, s65, 3
    s_mul_i32 s76, s3, 3
    s_and_b32 s3, s64, 7
    s_add_u32 s76, s76, s3
    s_and_b32 s3, s50, 1
    s_mul_i32 s3, s3, 4
    s_add_u32 s76, s76, s3
    s_cmp_ge_u32 s76, 11
    s_cselect_b32 s3, 11, 0
    s_sub_u32 s76, s76, s3
    s_mov_b32 s77, s76
    s_mul_i32 s78, s49, 1441792
    s_lshl_b32 s3, s64, 7
    s_add_u32 s78, s78, s3
    s_lshl_b32 s74, s49, 14
    s_add_u32 s74, s74, 32768
    s_mul_i32 s75, s49, 11
    v_mov_b32 v172, v28
    v_mov_b32 v173, v29
    v_mov_b32 v174, v30
    v_mov_b32 v175, v31
    s_mov_b32 s44, s10
    s_mov_b32 s45, s11
    s_mov_b32 s46, 524288
    s_mov_b32 s47, 0x20000
    v_lshlrev_b32 v8, 1, v3
    v_and_b32 v10, 7, v1
    v_xor_b32 v8, v8, v10
    v_lshlrev_b32 v8, 4, v8
    v_lshrrev_b32 v11, 3, v1
    v_lshl_add_u32 v28, v11, 10, v8
    v_add_u32 v29, 7168, v28
    v_add_u32 v30, 14336, v28
    v_add_u32 v31, 21504, v28
    s_lshl_b32 s79, s49, 17
    s_lshl_b32 s3, s65, 7
    s_add_u32 s79, s79, s3
    s_cmp_eq_u32 s49, 0
    s_cselect_b32 s66, 0, 2130706432
    s_setprio 0
    s_waitcnt vmcnt(5)
    s_barrier
    ds_read_b64_tr_b16 v[240:241], v36 offset:0
    ds_read_b64_tr_b16 v[242:243], v36 offset:512
    ds_read_b128 v[176:179], v32 offset:0
    ds_read_b128 v[180:183], v32 offset:2048
    ds_read_b128 v[184:187], v32 offset:4096
    ds_read_b128 v[188:191], v32 offset:6144
    ds_read_b128 v[192:195], v32 offset:8192
    ds_read_b128 v[196:199], v32 offset:10240
    ds_read_b128 v[200:203], v32 offset:12288
    ds_read_b128 v[204:207], v32 offset:14336
    s_waitcnt lgkmcnt(8)
    v_mfma_f32_16x16x32_bf16 v[112:115], v[240:243], v[44:47], 0
    ds_read_b64_tr_b16 v[248:249], v36 offset:12288
    ds_read_b64_tr_b16 v[250:251], v36 offset:12800
    s_waitcnt lgkmcnt(9)
    v_mfma_f32_16x16x32_bf16 v[48:51], v[240:243], v[176:179], 0
    ds_read_b128 v[208:211], v33 offset:0
    ds_read_b128 v[212:215], v33 offset:2048
    s_lshl_b32 s57, s97, 8
    s_add_u32 s57, s57, s60
    s_add_u32 m0, s59, 81920
    s_nop 0
    buffer_load_dwordx4 v24, s[28:31], s57 offen lds
    s_waitcnt lgkmcnt(10)
    v_mfma_f32_16x16x32_bf16 v[52:55], v[240:243], v[180:183], 0
    ds_read_b128 v[216:219], v33 offset:4096
    ds_read_b128 v[220:223], v33 offset:6144
    buffer_load_dwordx4 v25, s[28:31], s57 offen offset:1024 lds
    s_waitcnt lgkmcnt(11)
    v_mfma_f32_16x16x32_bf16 v[56:59], v[240:243], v[184:187], 0
    ds_read_b128 v[224:227], v33 offset:8192
    ds_read_b128 v[228:231], v33 offset:10240
    s_mul_i32 s58, s97, 393216
    s_add_u32 s58, s58, s61
    s_add_u32 m0, s82, 81920
    s_nop 0
    buffer_load_dwordx4 v26, s[32:35], s58 offen lds
    s_waitcnt lgkmcnt(12)
    v_mfma_f32_16x16x32_bf16 v[60:63], v[240:243], v[188:191], 0
    ds_read_b128 v[232:235], v33 offset:12288
    ds_read_b128 v[236:239], v33 offset:14336
    buffer_load_dwordx4 v26, s[32:35], s58 offen offset:1024 lds
    s_waitcnt lgkmcnt(13)
    v_mfma_f32_16x16x32_bf16 v[64:67], v[240:243], v[192:195], 0
    buffer_load_dwordx4 v26, s[32:35], s58 offen offset:2048 lds
    s_waitcnt lgkmcnt(12)
    v_mfma_f32_16x16x32_bf16 v[68:71], v[240:243], v[196:199], 0
    s_waitcnt lgkmcnt(11)
    v_mfma_f32_16x16x32_bf16 v[72:75], v[240:243], v[200:203], 0
    s_waitcnt lgkmcnt(10)
    v_mfma_f32_16x16x32_bf16 v[76:79], v[240:243], v[204:207], 0
    s_waitcnt lgkmcnt(0)
    s_waitcnt vmcnt(5)
    s_barrier
    v_mfma_f32_16x16x32_bf16 v[112:115], v[248:251], v[44:47], v[112:115]
    ds_read_b64_tr_b16 v[240:241], v36 offset:40960
    ds_read_b64_tr_b16 v[242:243], v36 offset:41472
    v_mfma_f32_16x16x32_bf16 v[48:51], v[248:251], v[208:211], v[48:51]
    ds_read_b128 v[176:179], v32 offset:40960
    ds_read_b128 v[180:183], v32 offset:43008
    s_lshl_b32 s57, s97, 8
    s_add_u32 s57, s57, s62
    s_add_u32 m0, s59, 0
    s_nop 0
    buffer_load_dwordx4 v24, s[28:31], s57 offen lds
    v_mfma_f32_16x16x32_bf16 v[52:55], v[248:251], v[212:215], v[52:55]
    ds_read_b128 v[184:187], v32 offset:45056
    ds_read_b128 v[188:191], v32 offset:47104
    buffer_load_dwordx4 v25, s[28:31], s57 offen offset:1024 lds
    v_mfma_f32_16x16x32_bf16 v[56:59], v[248:251], v[216:219], v[56:59]
    ds_read_b128 v[192:195], v32 offset:49152
    ds_read_b128 v[196:199], v32 offset:51200
    s_mul_i32 s58, s97, 393216
    s_add_u32 s58, s58, s63
    s_add_u32 m0, s82, 0
    s_nop 0
    buffer_load_dwordx4 v26, s[32:35], s58 offen lds
    v_mfma_f32_16x16x32_bf16 v[60:63], v[248:251], v[220:223], v[60:63]
    ds_read_b128 v[200:203], v32 offset:53248
    ds_read_b128 v[204:207], v32 offset:55296
    buffer_load_dwordx4 v26, s[32:35], s58 offen offset:1024 lds
    v_mfma_f32_16x16x32_bf16 v[64:67], v[248:251], v[224:227], v[64:67]
    buffer_load_dwordx4 v26, s[32:35], s58 offen offset:2048 lds
    v_mfma_f32_16x16x32_bf16 v[68:71], v[248:251], v[228:231], v[68:71]
    v_mfma_f32_16x16x32_bf16 v[72:75], v[248:251], v[232:235], v[72:75]
    v_mfma_f32_16x16x32_bf16 v[76:79], v[248:251], v[236:239], v[76:79]
    s_waitcnt lgkmcnt(8)
    v_mfma_f32_16x16x32_bf16 v[112:115], v[240:243], v[44:47], v[112:115]
    ds_read_b64_tr_b16 v[248:249], v36 offset:53248
    ds_read_b64_tr_b16 v[250:251], v36 offset:53760
    s_waitcnt lgkmcnt(9)
    v_mfma_f32_16x16x32_bf16 v[48:51], v[240:243], v[176:179], v[48:51]
    ds_read_b128 v[208:211], v33 offset:40960
    ds_read_b128 v[212:215], v33 offset:43008
    s_lshl_b32 s57, s97, 8
    s_add_u32 s57, s57, s62
    s_add_u32 s57, s57, 4294901760
    s_add_u32 m0, s59, 4294959104
    s_nop 0
    buffer_load_dwordx4 v24, s[28:31], s57 offen lds
    s_waitcnt lgkmcnt(10)
    v_mfma_f32_16x16x32_bf16 v[52:55], v[240:243], v[180:183], v[52:55]
    ds_read_b128 v[216:219], v33 offset:45056
    ds_read_b128 v[220:223], v33 offset:47104
    buffer_load_dwordx4 v25, s[28:31], s57 offen offset:1024 lds
    s_waitcnt lgkmcnt(11)
    v_mfma_f32_16x16x32_bf16 v[56:59], v[240:243], v[184:187], v[56:59]
    ds_read_b128 v[224:227], v33 offset:49152
    ds_read_b128 v[228:231], v33 offset:51200
    s_mul_i32 s58, s97, 393216
    s_add_u32 s58, s58, s63
    s_add_u32 s58, s58, 4294868992
    s_add_u32 m0, s82, 4294955008
    s_nop 0
    buffer_load_dwordx4 v26, s[32:35], s58 offen lds
    s_waitcnt lgkmcnt(12)
    v_mfma_f32_16x16x32_bf16 v[60:63], v[240:243], v[188:191], v[60:63]
    ds_read_b128 v[232:235], v33 offset:53248
    ds_read_b128 v[236:239], v33 offset:55296
    buffer_load_dwordx4 v26, s[32:35], s58 offen offset:1024 lds
    s_waitcnt lgkmcnt(13)
    v_mfma_f32_16x16x32_bf16 v[64:67], v[240:243], v[192:195], v[64:67]
    buffer_load_dwordx4 v26, s[32:35], s58 offen offset:2048 lds
    s_waitcnt lgkmcnt(12)
    v_mfma_f32_16x16x32_bf16 v[68:71], v[240:243], v[196:199], v[68:71]
    s_waitcnt lgkmcnt(11)
    v_mfma_f32_16x16x32_bf16 v[72:75], v[240:243], v[200:203], v[72:75]
    s_waitcnt lgkmcnt(10)
    v_mfma_f32_16x16x32_bf16 v[76:79], v[240:243], v[204:207], v[76:79]
    s_waitcnt lgkmcnt(0)
    s_waitcnt vmcnt(10)
    s_barrier
    v_mfma_f32_16x16x32_bf16 v[112:115], v[248:251], v[44:47], v[112:115]
    ds_read_b64_tr_b16 v[240:241], v37 offset:0
    ds_read_b64_tr_b16 v[242:243], v37 offset:512
    v_mfma_f32_16x16x32_bf16 v[48:51], v[248:251], v[208:211], v[48:51]
    ds_read_b128 v[176:179], v34 offset:0
    ds_read_b128 v[180:183], v34 offset:2048
    s_lshl_b32 s57, s98, 8
    s_add_u32 s57, s57, s60
    s_add_u32 m0, s59, 40960
    s_nop 0
    buffer_load_dwordx4 v24, s[28:31], s57 offen lds
    v_mfma_f32_16x16x32_bf16 v[52:55], v[248:251], v[212:215], v[52:55]
    ds_read_b128 v[184:187], v34 offset:4096
    ds_read_b128 v[188:191], v34 offset:6144
    buffer_load_dwordx4 v25, s[28:31], s57 offen offset:1024 lds
    v_mfma_f32_16x16x32_bf16 v[56:59], v[248:251], v[216:219], v[56:59]
    ds_read_b128 v[192:195], v34 offset:8192
    ds_read_b128 v[196:199], v34 offset:10240
    s_mul_i32 s58, s98, 393216
    s_add_u32 s58, s58, s61
    s_add_u32 m0, s82, 40960
    s_nop 0
    buffer_load_dwordx4 v26, s[32:35], s58 offen lds
    v_mfma_f32_16x16x32_bf16 v[60:63], v[248:251], v[220:223], v[60:63]
    ds_read_b128 v[200:203], v34 offset:12288
    ds_read_b128 v[204:207], v34 offset:14336
    buffer_load_dwordx4 v26, s[32:35], s58 offen offset:1024 lds
    v_mfma_f32_16x16x32_bf16 v[64:67], v[248:251], v[224:227], v[64:67]
    buffer_load_dwordx4 v26, s[32:35], s58 offen offset:2048 lds
    v_mfma_f32_16x16x32_bf16 v[68:71], v[248:251], v[228:231], v[68:71]
    v_mfma_f32_16x16x32_bf16 v[72:75], v[248:251], v[232:235], v[72:75]
    v_mfma_f32_16x16x32_bf16 v[76:79], v[248:251], v[236:239], v[76:79]
    s_waitcnt lgkmcnt(8)
    v_mfma_f32_16x16x32_bf16 v[112:115], v[240:243], v[44:47], v[112:115]
    ds_read_b64_tr_b16 v[248:249], v37 offset:12288
    ds_read_b64_tr_b16 v[250:251], v37 offset:12800
    s_waitcnt lgkmcnt(9)
    v_mfma_f32_16x16x32_bf16 v[48:51], v[240:243], v[176:179], v[48:51]
    ds_read_b128 v[208:211], v35 offset:0
    ds_read_b128 v[212:215], v35 offset:2048
    s_lshl_b32 s57, s98, 8
    s_add_u32 s57, s57, s60
    s_add_u32 s57, s57, 4294901760
    s_add_u32 m0, s59, 32768
    s_nop 0
    buffer_load_dwordx4 v24, s[28:31], s57 offen lds
    s_waitcnt lgkmcnt(10)
    v_mfma_f32_16x16x32_bf16 v[52:55], v[240:243], v[180:183], v[52:55]
    ds_read_b128 v[216:219], v35 offset:4096
    ds_read_b128 v[220:223], v35 offset:6144
    buffer_load_dwordx4 v25, s[28:31], s57 offen offset:1024 lds
    s_waitcnt lgkmcnt(11)
    v_mfma_f32_16x16x32_bf16 v[56:59], v[240:243], v[184:187], v[56:59]
    ds_read_b128 v[224:227], v35 offset:8192
    ds_read_b128 v[228:231], v35 offset:10240
    s_mul_i32 s58, s98, 393216
    s_add_u32 s58, s58, s61
    s_add_u32 s58, s58, 4294868992
    s_add_u32 m0, s82, 28672
    s_nop 0
    buffer_load_dwordx4 v26, s[32:35], s58 offen lds
    s_waitcnt lgkmcnt(12)
    v_mfma_f32_16x16x32_bf16 v[60:63], v[240:243], v[188:191], v[60:63]
    ds_read_b128 v[232:235], v35 offset:12288
    ds_read_b128 v[236:239], v35 offset:14336
    buffer_load_dwordx4 v26, s[32:35], s58 offen offset:1024 lds
    s_waitcnt lgkmcnt(13)
    v_mfma_f32_16x16x32_bf16 v[64:67], v[240:243], v[192:195], v[64:67]
    buffer_load_dwordx4 v26, s[32:35], s58 offen offset:2048 lds
    s_waitcnt lgkmcnt(12)
    v_mfma_f32_16x16x32_bf16 v[68:71], v[240:243], v[196:199], v[68:71]
    s_waitcnt lgkmcnt(11)
    v_mfma_f32_16x16x32_bf16 v[72:75], v[240:243], v[200:203], v[72:75]
    s_waitcnt lgkmcnt(10)
    v_mfma_f32_16x16x32_bf16 v[76:79], v[240:243], v[204:207], v[76:79]
    s_waitcnt lgkmcnt(0)
    s_waitcnt vmcnt(10)
    s_barrier
    s_and_b32 s3, s50, 1
    s_lshl_b32 s3, s3, 7
    s_add_u32 s70, s3, s66
    v_mfma_f32_16x16x32_bf16 v[112:115], v[248:251], v[44:47], v[112:115]
    ds_read_b64_tr_b16 v[240:241], v36 offset:0
    ds_read_b64_tr_b16 v[242:243], v36 offset:512
    v_mfma_f32_16x16x32_bf16 v[48:51], v[248:251], v[208:211], v[48:51]
    ds_read_b128 v[176:179], v32 offset:0
    ds_read_b128 v[180:183], v32 offset:2048
    s_lshl_b32 s57, s98, 8
    s_add_u32 s57, s57, s62
    s_add_u32 m0, s59, 81920
    s_nop 0
    buffer_load_dwordx4 v24, s[28:31], s57 offen lds
    v_mfma_f32_16x16x32_bf16 v[52:55], v[248:251], v[212:215], v[52:55]
    ds_read_b128 v[184:187], v32 offset:4096
    ds_read_b128 v[188:191], v32 offset:6144
    buffer_load_dwordx4 v25, s[28:31], s57 offen offset:1024 lds
    v_mfma_f32_16x16x32_bf16 v[56:59], v[248:251], v[216:219], v[56:59]
    ds_read_b128 v[192:195], v32 offset:8192
    ds_read_b128 v[196:199], v32 offset:10240
    s_mul_i32 s58, s98, 393216
    s_add_u32 s58, s58, s63
    s_add_u32 m0, s82, 81920
    s_nop 0
    buffer_load_dwordx4 v26, s[32:35], s58 offen lds
    v_mfma_f32_16x16x32_bf16 v[60:63], v[248:251], v[220:223], v[60:63]
    ds_read_b128 v[200:203], v32 offset:12288
    ds_read_b128 v[204:207], v32 offset:14336
    buffer_load_dwordx4 v26, s[32:35], s58 offen offset:1024 lds
    v_mfma_f32_16x16x32_bf16 v[64:67], v[248:251], v[224:227], v[64:67]
    buffer_load_dwordx4 v26, s[32:35], s58 offen offset:2048 lds
    v_mfma_f32_16x16x32_bf16 v[68:71], v[248:251], v[228:231], v[68:71]
    buffer_load_dwordx2 v[18:19], v16, s[40:43], s70 offen sc0 sc1
    v_mfma_f32_16x16x32_bf16 v[72:75], v[248:251], v[232:235], v[72:75]
    v_mfma_f32_16x16x32_bf16 v[76:79], v[248:251], v[236:239], v[76:79]
    s_waitcnt lgkmcnt(8)
    v_mfma_f32_16x16x32_bf16 v[112:115], v[240:243], v[44:47], v[112:115]
    ds_read_b64_tr_b16 v[248:249], v36 offset:12288
    ds_read_b64_tr_b16 v[250:251], v36 offset:12800
    s_waitcnt lgkmcnt(9)
    v_mfma_f32_16x16x32_bf16 v[48:51], v[240:243], v[176:179], v[48:51]
    ds_read_b128 v[208:211], v33 offset:0
    ds_read_b128 v[212:215], v33 offset:2048
    s_lshl_b32 s57, s98, 8
    s_add_u32 s57, s57, s62
    s_add_u32 s57, s57, 4294901760
    s_add_u32 m0, s59, 73728
    s_nop 0
    buffer_load_dwordx4 v24, s[28:31], s57 offen lds
    s_waitcnt lgkmcnt(10)
    v_mfma_f32_16x16x32_bf16 v[52:55], v[240:243], v[180:183], v[52:55]
    ds_read_b128 v[216:219], v33 offset:4096
    ds_read_b128 v[220:223], v33 offset:6144
    buffer_load_dwordx4 v25, s[28:31], s57 offen offset:1024 lds
    s_waitcnt lgkmcnt(11)
    v_mfma_f32_16x16x32_bf16 v[56:59], v[240:243], v[184:187], v[56:59]
    ds_read_b128 v[224:227], v33 offset:8192
    ds_read_b128 v[228:231], v33 offset:10240
    s_mul_i32 s58, s98, 393216
    s_add_u32 s58, s58, s63
    s_add_u32 s58, s58, 4294868992
    s_add_u32 m0, s82, 69632
    s_nop 0
    buffer_load_dwordx4 v26, s[32:35], s58 offen lds
    s_waitcnt lgkmcnt(12)
    v_mfma_f32_16x16x32_bf16 v[60:63], v[240:243], v[188:191], v[60:63]
    ds_read_b128 v[232:235], v33 offset:12288
    ds_read_b128 v[236:239], v33 offset:14336
    buffer_load_dwordx4 v26, s[32:35], s58 offen offset:1024 lds
    s_waitcnt lgkmcnt(13)
    v_mfma_f32_16x16x32_bf16 v[64:67], v[240:243], v[192:195], v[64:67]
    buffer_load_dwordx4 v26, s[32:35], s58 offen offset:2048 lds
    s_waitcnt lgkmcnt(12)
    v_mfma_f32_16x16x32_bf16 v[68:71], v[240:243], v[196:199], v[68:71]
    s_waitcnt lgkmcnt(11)
    v_mfma_f32_16x16x32_bf16 v[72:75], v[240:243], v[200:203], v[72:75]
    s_waitcnt lgkmcnt(10)
    v_mfma_f32_16x16x32_bf16 v[76:79], v[240:243], v[204:207], v[76:79]
    s_waitcnt lgkmcnt(0)
    s_waitcnt vmcnt(11)
    s_barrier
    v_mfma_f32_16x16x32_bf16 v[112:115], v[248:251], v[44:47], v[112:115]
    ds_read_b64_tr_b16 v[240:241], v36 offset:40960
    ds_read_b64_tr_b16 v[242:243], v36 offset:41472
    v_mfma_f32_16x16x32_bf16 v[48:51], v[248:251], v[208:211], v[48:51]
    ds_read_b128 v[176:179], v32 offset:40960
    ds_read_b128 v[180:183], v32 offset:43008
    s_lshl_b32 s57, s99, 8
    s_add_u32 s57, s57, s60
    s_add_u32 m0, s59, 0
    s_nop 0
    buffer_load_dwordx4 v24, s[28:31], s57 offen nt lds
    v_mfma_f32_16x16x32_bf16 v[52:55], v[248:251], v[212:215], v[52:55]
    ds_read_b128 v[184:187], v32 offset:45056
    ds_read_b128 v[188:191], v32 offset:47104
    buffer_load_dwordx4 v25, s[28:31], s57 offen offset:1024 nt lds
    v_mfma_f32_16x16x32_bf16 v[56:59], v[248:251], v[216:219], v[56:59]
    ds_read_b128 v[192:195], v32 offset:49152
    ds_read_b128 v[196:199], v32 offset:51200
    s_mul_i32 s58, s99, 393216
    s_add_u32 s58, s58, s61
    s_add_u32 m0, s82, 0
    s_nop 0
    buffer_load_dwordx4 v26, s[32:35], s58 offen nt lds
    v_mfma_f32_16x16x32_bf16 v[60:63], v[248:251], v[220:223], v[60:63]
    ds_read_b128 v[200:203], v32 offset:53248
    ds_read_b128 v[204:207], v32 offset:55296
    buffer_load_dwordx4 v26, s[32:35], s58 offen offset:1024 nt lds
    v_mfma_f32_16x16x32_bf16 v[64:67], v[248:251], v[224:227], v[64:67]
    buffer_load_dwordx4 v26, s[32:35], s58 offen offset:2048 nt lds
    v_mfma_f32_16x16x32_bf16 v[68:71], v[248:251], v[228:231], v[68:71]
    v_mfma_f32_16x16x32_bf16 v[72:75], v[248:251], v[232:235], v[72:75]
    v_mfma_f32_16x16x32_bf16 v[76:79], v[248:251], v[236:239], v[76:79]
    s_waitcnt lgkmcnt(8)
    v_mfma_f32_16x16x32_bf16 v[112:115], v[240:243], v[44:47], v[112:115]
    ds_read_b64_tr_b16 v[248:249], v36 offset:53248
    ds_read_b64_tr_b16 v[250:251], v36 offset:53760
    s_waitcnt lgkmcnt(9)
    v_mfma_f32_16x16x32_bf16 v[48:51], v[240:243], v[176:179], v[48:51]
    ds_read_b128 v[208:211], v33 offset:40960
    ds_read_b128 v[212:215], v33 offset:43008
    s_lshl_b32 s57, s99, 8
    s_add_u32 s57, s57, s60
    s_add_u32 s57, s57, 4294901760
    s_add_u32 m0, s59, 4294959104
    s_nop 0
    buffer_load_dwordx4 v24, s[28:31], s57 offen nt lds
    s_waitcnt lgkmcnt(10)
    v_mfma_f32_16x16x32_bf16 v[52:55], v[240:243], v[180:183], v[52:55]
    ds_read_b128 v[216:219], v33 offset:45056
    ds_read_b128 v[220:223], v33 offset:47104
    buffer_load_dwordx4 v25, s[28:31], s57 offen offset:1024 nt lds
    s_waitcnt lgkmcnt(11)
    v_mfma_f32_16x16x32_bf16 v[56:59], v[240:243], v[184:187], v[56:59]
    ds_read_b128 v[224:227], v33 offset:49152
    ds_read_b128 v[228:231], v33 offset:51200
    s_mul_i32 s58, s99, 393216
    s_add_u32 s58, s58, s61
    s_add_u32 s58, s58, 4294868992
    s_add_u32 m0, s82, 4294955008
    s_nop 0
    buffer_load_dwordx4 v26, s[32:35], s58 offen nt lds
    s_waitcnt lgkmcnt(12)
    v_mfma_f32_16x16x32_bf16 v[60:63], v[240:243], v[188:191], v[60:63]
    ds_read_b128 v[232:235], v33 offset:53248
    ds_read_b128 v[236:239], v33 offset:55296
    buffer_load_dwordx4 v26, s[32:35], s58 offen offset:1024 nt lds
    s_waitcnt lgkmcnt(13)
    v_mfma_f32_16x16x32_bf16 v[64:67], v[240:243], v[192:195], v[64:67]
    buffer_load_dwordx4 v26, s[32:35], s58 offen offset:2048 nt lds
    s_waitcnt lgkmcnt(12)
    v_mfma_f32_16x16x32_bf16 v[68:71], v[240:243], v[196:199], v[68:71]
    s_waitcnt lgkmcnt(11)
    v_mfma_f32_16x16x32_bf16 v[72:75], v[240:243], v[200:203], v[72:75]
    s_waitcnt lgkmcnt(10)
    v_mfma_f32_16x16x32_bf16 v[76:79], v[240:243], v[204:207], v[76:79]
    s_waitcnt lgkmcnt(0)
    s_waitcnt vmcnt(10)
    s_barrier
    v_mfma_f32_16x16x32_bf16 v[112:115], v[248:251], v[44:47], v[112:115]
    ds_read_b64_tr_b16 v[240:241], v37 offset:0
    ds_read_b64_tr_b16 v[242:243], v37 offset:512
    v_mfma_f32_16x16x32_bf16 v[48:51], v[248:251], v[208:211], v[48:51]
    ds_read_b128 v[176:179], v34 offset:0
    ds_read_b128 v[180:183], v34 offset:2048
    s_lshl_b32 s57, s99, 8
    s_add_u32 s57, s57, s62
    s_add_u32 m0, s59, 40960
    s_nop 0
    buffer_load_dwordx4 v24, s[28:31], s57 offen nt lds
    v_mfma_f32_16x16x32_bf16 v[52:55], v[248:251], v[212:215], v[52:55]
    ds_read_b128 v[184:187], v34 offset:4096
    ds_read_b128 v[188:191], v34 offset:6144
    buffer_load_dwordx4 v25, s[28:31], s57 offen offset:1024 nt lds
    v_mfma_f32_16x16x32_bf16 v[56:59], v[248:251], v[216:219], v[56:59]
    ds_read_b128 v[192:195], v34 offset:8192
    ds_read_b128 v[196:199], v34 offset:10240
    s_mul_i32 s58, s99, 393216
    s_add_u32 s58, s58, s63
    s_add_u32 m0, s82, 40960
    s_nop 0
    buffer_load_dwordx4 v26, s[32:35], s58 offen nt lds
    v_mfma_f32_16x16x32_bf16 v[60:63], v[248:251], v[220:223], v[60:63]
    ds_read_b128 v[200:203], v34 offset:12288
    ds_read_b128 v[204:207], v34 offset:14336
    buffer_load_dwordx4 v26, s[32:35], s58 offen offset:1024 nt lds
    v_mfma_f32_16x16x32_bf16 v[64:67], v[248:251], v[224:227], v[64:67]
    buffer_load_dwordx4 v26, s[32:35], s58 offen offset:2048 nt lds
    v_mfma_f32_16x16x32_bf16 v[68:71], v[248:251], v[228:231], v[68:71]
    v_mfma_f32_16x16x32_bf16 v[72:75], v[248:251], v[232:235], v[72:75]
    v_mfma_f32_16x16x32_bf16 v[76:79], v[248:251], v[236:239], v[76:79]
    s_cmp_lg_u32 s49, 0
    s_nop 6
    s_cbranch_scc1 L_e27x
    s_mov_b32 s53, 0
L_e27:
    v_readfirstlane_b32 s3, v18
    s_nop 0
    s_cmp_lg_u32 s3, 0
    s_nop 2
    s_cbranch_scc1 L_e27y
    buffer_load_dwordx2 v[18:19], v16, s[40:43], s70 offen sc0 sc1
    s_waitcnt vmcnt(0)
    s_add_u32 s53, s53, 1
    s_cmp_le_u32 s53, 30000
    s_cbranch_scc1 L_e27
L_e27y:
L_e27x:
    s_lshl_b32 s73, s51, 2
    s_lshr_b32 s3, s54, 2
    s_add_u32 s73, s73, s3
    s_lshl_b32 s73, s73, 7
    s_add_u32 s73, s73, 7176192
    s_add_u32 s3, s73, s66
    buffer_load_dword v84, v16, s[36:39], s3 offen sc0 sc1
    s_waitcnt lgkmcnt(8)
    v_mfma_f32_16x16x32_bf16 v[112:115], v[240:243], v[44:47], v[112:115]
    ds_read_b64_tr_b16 v[248:249], v37 offset:12288
    ds_read_b64_tr_b16 v[250:251], v37 offset:12800
    s_waitcnt lgkmcnt(9)
    v_mfma_f32_16x16x32_bf16 v[48:51], v[240:243], v[176:179], v[48:51]
    ds_read_b128 v[208:211], v35 offset:0
    ds_read_b128 v[212:215], v35 offset:2048
    s_lshl_b32 s57, s99, 8
    s_add_u32 s57, s57, s62
    s_add_u32 s57, s57, 4294901760
    s_add_u32 m0, s59, 32768
    s_nop 0
    buffer_load_dwordx4 v24, s[28:31], s57 offen nt lds
    s_waitcnt lgkmcnt(10)
    v_mfma_f32_16x16x32_bf16 v[52:55], v[240:243], v[180:183], v[52:55]
    ds_read_b128 v[216:219], v35 offset:4096
    ds_read_b128 v[220:223], v35 offset:6144
    buffer_load_dwordx4 v25, s[28:31], s57 offen offset:1024 nt lds
    s_waitcnt lgkmcnt(11)
    v_mfma_f32_16x16x32_bf16 v[56:59], v[240:243], v[184:187], v[56:59]
    ds_read_b128 v[224:227], v35 offset:8192
    ds_read_b128 v[228:231], v35 offset:10240
    s_mul_i32 s58, s99, 393216
    s_add_u32 s58, s58, s63
    s_add_u32 s58, s58, 4294868992
    s_add_u32 m0, s82, 28672
    s_nop 0
    buffer_load_dwordx4 v26, s[32:35], s58 offen nt lds
    s_waitcnt lgkmcnt(12)
    v_mfma_f32_16x16x32_bf16 v[60:63], v[240:243], v[188:191], v[60:63]
    ds_read_b128 v[232:235], v35 offset:12288
    ds_read_b128 v[236:239], v35 offset:14336
    buffer_load_dwordx4 v26, s[32:35], s58 offen offset:1024 nt lds
    s_waitcnt lgkmcnt(13)
    v_mfma_f32_16x16x32_bf16 v[64:67], v[240:243], v[192:195], v[64:67]
    buffer_load_dwordx4 v26, s[32:35], s58 offen offset:2048 nt lds
    s_waitcnt lgkmcnt(12)
    v_mfma_f32_16x16x32_bf16 v[68:71], v[240:243], v[196:199], v[68:71]
    s_waitcnt lgkmcnt(11)
    v_mfma_f32_16x16x32_bf16 v[72:75], v[240:243], v[200:203], v[72:75]
    s_waitcnt lgkmcnt(10)
    v_mfma_f32_16x16x32_bf16 v[76:79], v[240:243], v[204:207], v[76:79]
    s_waitcnt lgkmcnt(0)
    s_waitcnt vmcnt(11)
    s_barrier
    s_mov_b32 s32, s8
    s_mov_b32 s33, s9
    s_mov_b32 s34, 16384
    s_mov_b32 s35, 0x20000
    s_lshl_b32 s52, s81, 9
    v_mfma_f32_16x16x32_bf16 v[112:115], v[248:251], v[44:47], v[112:115]
    ds_read_b64_tr_b16 v[240:241], v36 offset:0
    ds_read_b64_tr_b16 v[242:243], v36 offset:512
    v_mfma_f32_16x16x32_bf16 v[48:51], v[248:251], v[208:211], v[48:51]
    ds_read_b128 v[176:179], v32 offset:0
    ds_read_b128 v[180:183], v32 offset:2048
    buffer_load_ushort v120, v42, s[32:35], s52 offen offset:0
    v_mfma_f32_16x16x32_bf16 v[52:55], v[248:251], v[212:215], v[52:55]
    ds_read_b128 v[184:187], v32 offset:4096
    ds_read_b128 v[188:191], v32 offset:6144
    buffer_load_ushort v121, v42, s[32:35], s52 offen offset:32
    v_mfma_f32_16x16x32_bf16 v[56:59], v[248:251], v[216:219], v[56:59]
    ds_read_b128 v[192:195], v32 offset:8192
    ds_read_b128 v[196:199], v32 offset:10240
    buffer_load_ushort v122, v42, s[32:35], s52 offen offset:64
    v_mfma_f32_16x16x32_bf16 v[60:63], v[248:251], v[220:223], v[60:63]
    ds_read_b128 v[200:203], v32 offset:12288
    ds_read_b128 v[204:207], v32 offset:14336
    buffer_load_ushort v123, v42, s[32:35], s52 offen offset:96
    v_mfma_f32_16x16x32_bf16 v[64:67], v[248:251], v[224:227], v[64:67]
    v_mfma_f32_16x16x32_bf16 v[68:71], v[248:251], v[228:231], v[68:71]
    v_mfma_f32_16x16x32_bf16 v[72:75], v[248:251], v[232:235], v[72:75]
    v_mfma_f32_16x16x32_bf16 v[76:79], v[248:251], v[236:239], v[76:79]
    s_waitcnt vmcnt(9)
    v_readfirstlane_b32 s3, v84
    s_cmp_eq_u32 s49, 0
    s_cselect_b32 s3, s3, 32
    s_cmp_eq_u32 s3, 32
    s_nop 2
    s_cbranch_scc1 L_ct28
    s_waitcnt lgkmcnt(0)
    s_mov_b32 s12, 32
    s_add_u32 s100, s26, s73
    s_addc_u32 s101, s27, 0
    s_mov_b32 s53, 0
L_sp29:
    s_load_dword s84, s[100:101], 0 glc
    s_add_u32 s53, s53, 1
    s_waitcnt lgkmcnt(0)
    s_xor_b32 s13, s84, s12
    s_cmp_gt_u32 s53, 30000
    s_cbranch_scc1 L_sp29x
    s_cmp_lg_u32 s13, 0
    s_cbranch_scc1 L_sp29
L_sp29x:
L_ct28:
    s_lshl_b32 s68, s54, 10
    s_add_u32 s68, s68, 7012352
    s_add_u32 s68, s68, s66
    buffer_load_dwordx4 v[80:83], v7, s[36:39], s68 offen sc1
    s_waitcnt lgkmcnt(8)
    v_mfma_f32_16x16x32_bf16 v[112:115], v[240:243], v[44:47], v[112:115]
    ds_read_b64_tr_b16 v[248:249], v36 offset:12288
    ds_read_b64_tr_b16 v[250:251], v36 offset:12800
    s_waitcnt lgkmcnt(9)
    v_mfma_f32_16x16x32_bf16 v[48:51], v[240:243], v[176:179], v[48:51]
    ds_read_b128 v[208:211], v33 offset:0
    ds_read_b128 v[212:215], v33 offset:2048
    s_waitcnt lgkmcnt(10)
    v_mfma_f32_16x16x32_bf16 v[52:55], v[240:243], v[180:183], v[52:55]
    ds_read_b128 v[216:219], v33 offset:4096
    ds_read_b128 v[220:223], v33 offset:6144
    s_waitcnt lgkmcnt(11)
    v_mfma_f32_16x16x32_bf16 v[56:59], v[240:243], v[184:187], v[56:59]
    ds_read_b128 v[224:227], v33 offset:8192
    ds_read_b128 v[228:231], v33 offset:10240
    s_waitcnt lgkmcnt(12)
    v_mfma_f32_16x16x32_bf16 v[60:63], v[240:243], v[188:191], v[60:63]
    ds_read_b128 v[232:235], v33 offset:12288
    ds_read_b128 v[236:239], v33 offset:14336
    s_waitcnt lgkmcnt(13)
    v_mfma_f32_16x16x32_bf16 v[64:67], v[240:243], v[192:195], v[64:67]
    s_waitcnt lgkmcnt(12)
    v_mfma_f32_16x16x32_bf16 v[68:71], v[240:243], v[196:199], v[68:71]
    s_waitcnt lgkmcnt(11)
    v_mfma_f32_16x16x32_bf16 v[72:75], v[240:243], v[200:203], v[72:75]
    s_waitcnt lgkmcnt(10)
    v_mfma_f32_16x16x32_bf16 v[76:79], v[240:243], v[204:207], v[76:79]
    s_waitcnt lgkmcnt(0)
    s_waitcnt vmcnt(5)
    s_barrier
    v_mfma_f32_16x16x32_bf16 v[112:115], v[248:251], v[44:47], v[112:115]
    ds_read_b64_tr_b16 v[240:241], v36 offset:40960
    ds_read_b64_tr_b16 v[242:243], v36 offset:41472
    v_mfma_f32_16x16x32_bf16 v[48:51], v[248:251], v[208:211], v[48:51]
    ds_read_b128 v[176:179], v32 offset:40960
    ds_read_b128 v[180:183], v32 offset:43008
    v_mfma_f32_16x16x32_bf16 v[52:55], v[248:251], v[212:215], v[52:55]
    ds_read_b128 v[184:187], v32 offset:45056
    ds_read_b128 v[188:191], v32 offset:47104
    v_mfma_f32_16x16x32_bf16 v[56:59], v[248:251], v[216:219], v[56:59]
    ds_read_b128 v[192:195], v32 offset:49152
    ds_read_b128 v[196:199], v32 offset:51200
    v_mfma_f32_16x16x32_bf16 v[60:63], v[248:251], v[220:223], v[60:63]
    ds_read_b128 v[200:203], v32 offset:53248
    ds_read_b128 v[204:207], v32 offset:55296
    v_mfma_f32_16x16x32_bf16 v[64:67], v[248:251], v[224:227], v[64:67]
    v_mfma_f32_16x16x32_bf16 v[68:71], v[248:251], v[228:231], v[68:71]
    v_mfma_f32_16x16x32_bf16 v[72:75], v[248:251], v[232:235], v[72:75]
    v_mfma_f32_16x16x32_bf16 v[76:79], v[248:251], v[236:239], v[76:79]
    s_waitcnt lgkmcnt(8)
    v_mfma_f32_16x16x32_bf16 v[112:115], v[240:243], v[44:47], v[112:115]
    ds_read_b64_tr_b16 v[248:249], v36 offset:53248
    ds_read_b64_tr_b16 v[250:251], v36 offset:53760
    s_waitcnt lgkmcnt(9)
    v_mfma_f32_16x16x32_bf16 v[48:51], v[240:243], v[176:179], v[48:51]
    ds_read_b128 v[208:211], v33 offset:40960
    ds_read_b128 v[212:215], v33 offset:43008
    s_waitcnt lgkmcnt(10)
    v_mfma_f32_16x16x32_bf16 v[52:55], v[240:243], v[180:183], v[52:55]
    ds_read_b128 v[216:219], v33 offset:45056
    ds_read_b128 v[220:223], v33 offset:47104
    s_waitcnt lgkmcnt(11)
    v_mfma_f32_16x16x32_bf16 v[56:59], v[240:243], v[184:187], v[56:59]
    ds_read_b128 v[224:227], v33 offset:49152
    ds_read_b128 v[228:231], v33 offset:51200
    s_waitcnt lgkmcnt(12)
    v_mfma_f32_16x16x32_bf16 v[60:63], v[240:243], v[188:191], v[60:63]
    ds_read_b128 v[232:235], v33 offset:53248
    ds_read_b128 v[236:239], v33 offset:55296
    s_waitcnt lgkmcnt(13)
    v_mfma_f32_16x16x32_bf16 v[64:67], v[240:243], v[192:195], v[64:67]
    s_waitcnt lgkmcnt(12)
    v_mfma_f32_16x16x32_bf16 v[68:71], v[240:243], v[196:199], v[68:71]
    s_waitcnt lgkmcnt(11)
    v_mfma_f32_16x16x32_bf16 v[72:75], v[240:243], v[200:203], v[72:75]
    s_waitcnt lgkmcnt(10)
    v_mfma_f32_16x16x32_bf16 v[76:79], v[240:243], v[204:207], v[76:79]
    s_waitcnt vmcnt(0)
    v_add_u32 v8, 147456, v7
    s_cmp_lg_u32 s49, 0
    s_nop 4
    s_cbranch_scc1 L_st30
    ds_write_b128 v8, v[80:83]
    s_nop 1
    v_lshlrev_b32 v8, 3, v1
    v_add_u32 v8, 149504, v8
    ds_write2_b32 v8, v80, v82 offset0:0 offset1:1
    ds_write2_b32 v8, v81, v83 offset0:128 offset1:129
    ds_write_b64 v17, v[18:19] offset:16
L_st30:
    s_waitcnt lgkmcnt(0)
    s_barrier
    v_mfma_f32_16x16x32_bf16 v[112:115], v[248:251], v[44:47], v[112:115]
    ds_read_b64 v[18:19], v17 offset:16
    ds_read_b64 v[124:125], v22 offset:0
    v_mfma_f32_16x16x32_bf16 v[48:51], v[248:251], v[208:211], v[48:51]
    ds_read_b64 v[126:127], v22 offset:128
    ds_read_b64 v[128:129], v22 offset:256
    v_mfma_f32_16x16x32_bf16 v[52:55], v[248:251], v[212:215], v[52:55]
    ds_read_b64 v[130:131], v22 offset:384
    ds_read_b64 v[132:133], v22 offset:512
    v_mfma_f32_16x16x32_bf16 v[56:59], v[248:251], v[216:219], v[56:59]
    ds_read_b64 v[134:135], v22 offset:640
    ds_read_b64 v[136:137], v22 offset:768
    v_mfma_f32_16x16x32_bf16 v[60:63], v[248:251], v[220:223], v[60:63]
    ds_read_b64 v[138:139], v22 offset:896
    v_mfma_f32_16x16x32_bf16 v[64:67], v[248:251], v[224:227], v[64:67]
    v_mfma_f32_16x16x32_bf16 v[68:71], v[248:251], v[228:231], v[68:71]
    v_mfma_f32_16x16x32_bf16 v[72:75], v[248:251], v[232:235], v[72:75]
    v_mfma_f32_16x16x32_bf16 v[76:79], v[248:251], v[236:239], v[76:79]
    s_lshl_b32 s69, s49, 12
    s_mov_b32 s40, s18
    s_mov_b32 s41, s19
    s_mov_b32 s42, 5636096
    s_mov_b32 s43, 0x20000
    v_lshl_or_b32 v38, v121, 16, v120
    v_lshl_or_b32 v39, v123, 16, v122
    s_waitcnt lgkmcnt(0)
    v_fmac_f32 v48, v112, v125
    v_fmac_f32 v49, v113, v125
    v_fmac_f32 v50, v114, v125
    v_fmac_f32 v51, v115, v125
    v_cvt_pk_bf16_f32 v140, v48, v49
    v_cvt_pk_bf16_f32 v141, v50, v51
    v_mul_f32 v124, 0x3fb8aa3b, v124
    v_fmac_f32 v52, v112, v127
    v_fmac_f32 v53, v113, v127
    v_fmac_f32 v54, v114, v127
    v_fmac_f32 v55, v115, v127
    v_cvt_pk_bf16_f32 v142, v52, v53
    v_cvt_pk_bf16_f32 v143, v54, v55
    v_mul_f32 v126, 0x3fb8aa3b, v126
    s_lshl_b32 s58, s76, 17
    s_add_u32 s58, s58, s78
    s_add_u32 m0, s74, 0
    s_add_u32 s76, s76, 1
    s_cmp_eq_u32 s76, 11
    s_cselect_b32 s76, 0, s76
    buffer_load_dwordx4 v172, s[40:43], s58 offen offset:0 lds
    v_mfma_f32_16x16x16_bf16 v[48:51], v[38:39], v[140:141], 0
    v_fmac_f32 v56, v112, v129
    v_fmac_f32 v57, v113, v129
    v_fmac_f32 v58, v114, v129
    v_fmac_f32 v59, v115, v129
    v_cvt_pk_bf16_f32 v144, v56, v57
    v_cvt_pk_bf16_f32 v145, v58, v59
    v_mul_f32 v128, 0x3fb8aa3b, v128
    v_mfma_f32_16x16x16_bf16 v[52:55], v[38:39], v[142:143], 0
    v_fmac_f32 v60, v112, v131
    v_fmac_f32 v61, v113, v131
    v_fmac_f32 v62, v114, v131
    v_fmac_f32 v63, v115, v131
    v_cvt_pk_bf16_f32 v146, v60, v61
    v_cvt_pk_bf16_f32 v147, v62, v63
    v_mul_f32 v130, 0x3fb8aa3b, v130
    buffer_load_dwordx4 v173, s[40:43], s58 offen offset:1024 lds
    v_mfma_f32_16x16x16_bf16 v[56:59], v[38:39], v[144:145], 0
    v_fmac_f32 v64, v112, v133
    v_fmac_f32 v65, v113, v133
    v_fmac_f32 v66, v114, v133
    v_fmac_f32 v67, v115, v133
    v_cvt_pk_bf16_f32 v148, v64, v65
    v_cvt_pk_bf16_f32 v149, v66, v67
    v_mul_f32 v132, 0x3fb8aa3b, v132
    v_mfma_f32_16x16x16_bf16 v[60:63], v[38:39], v[146:147], 0
    v_fmac_f32 v68, v112, v135
    v_fmac_f32 v69, v113, v135
    v_fmac_f32 v70, v114, v135
    v_fmac_f32 v71, v115, v135
    v_cvt_pk_bf16_f32 v150, v68, v69
    v_cvt_pk_bf16_f32 v151, v70, v71
    v_mul_f32 v134, 0x3fb8aa3b, v134
    buffer_load_dwordx4 v174, s[40:43], s58 offen offset:2048 lds
    v_mfma_f32_16x16x16_bf16 v[64:67], v[38:39], v[148:149], 0
    v_fmac_f32 v72, v112, v137
    v_fmac_f32 v73, v113, v137
    v_fmac_f32 v74, v114, v137
    v_fmac_f32 v75, v115, v137
    v_cvt_pk_bf16_f32 v152, v72, v73
    v_cvt_pk_bf16_f32 v153, v74, v75
    v_mul_f32 v136, 0x3fb8aa3b, v136
    v_mfma_f32_16x16x16_bf16 v[68:71], v[38:39], v[150:151], 0
    v_fmac_f32 v76, v112, v139
    v_fmac_f32 v77, v113, v139
    v_fmac_f32 v78, v114, v139
    v_fmac_f32 v79, v115, v139
    v_cvt_pk_bf16_f32 v154, v76, v77
    v_cvt_pk_bf16_f32 v155, v78, v79
    v_mul_f32 v138, 0x3fb8aa3b, v138
    buffer_load_dwordx4 v175, s[40:43], s58 offen offset:3072 lds
    v_mfma_f32_16x16x16_bf16 v[72:75], v[38:39], v[152:153], 0
    v_mfma_f32_16x16x16_bf16 v[76:79], v[38:39], v[154:155], 0
    v_max3_f32 v80, v48, v49, v50
    v_max3_f32 v140, v56, v57, v58
    v_max3_f32 v81, -v48, -v49, -v50
    v_max3_f32 v141, -v56, -v57, -v58
    v_max_f32 v80, v80, v51
    v_max_f32 v140, v140, v59
    v_max_f32_e64 v81, v81, -v51
    v_max_f32_e64 v141, v141, -v59
    v_max3_f32 v82, v52, v53, v54
    v_max3_f32 v142, v60, v61, v62
    s_lshl_b32 s58, s76, 17
    s_add_u32 s58, s58, s78
    s_add_u32 m0, s74, 4096
    s_add_u32 s76, s76, 1
    s_cmp_eq_u32 s76, 11
    s_cselect_b32 s76, 0, s76
    buffer_load_dwordx4 v172, s[40:43], s58 offen offset:0 lds
    v_max3_f32 v83, -v52, -v53, -v54
    v_max3_f32 v143, -v60, -v61, -v62
    v_max_f32 v82, v82, v55
    v_max_f32 v142, v142, v63
    v_max_f32_e64 v83, v83, -v55
    v_max_f32_e64 v143, v143, -v63
    v_permlane32_swap_b32 v80, v81
    v_permlane32_swap_b32 v140, v141
    v_permlane32_swap_b32 v82, v83
    v_permlane32_swap_b32 v142, v143
    buffer_load_dwordx4 v173, s[40:43], s58 offen offset:1024 lds
    v_max_f32 v80, v80, v81
    v_max_f32 v140, v140, v141
    v_max_f32 v82, v82, v83
    v_max_f32 v142, v142, v143
    s_nop 0
    v_permlane16_swap_b32 v80, v82
    v_permlane16_swap_b32 v140, v142
    v_max_f32 v80, v80, v82
    v_max_f32 v140, v140, v142
    v_mov_b32 v82, v80
    v_mov_b32 v142, v140
    buffer_load_dwordx4 v174, s[40:43], s58 offen offset:2048 lds
    v_permlane16_swap_b32 v80, v82
    v_permlane16_swap_b32 v140, v142
    v_mul_f32 v80, v80, v124
    v_mul_f32 v140, v140, v128
    v_mul_f32 v82, v82, v126
    v_mul_f32 v142, v142, v130
    v_mov_b32 v81, v80
    v_mov_b32 v141, v140
    v_mov_b32 v83, v82
    v_mov_b32 v143, v142
    buffer_load_dwordx4 v175, s[40:43], s58 offen offset:3072 lds
    v_permlane32_swap_b32 v80, v81
    v_permlane32_swap_b32 v140, v141
    v_permlane32_swap_b32 v82, v83
    v_permlane32_swap_b32 v142, v143
    v_fma_f32 v86, v48, v124, -v80
    v_fma_f32 v87, v49, v124, -v80
    v_fma_f32 v146, v56, v128, -v140
    v_fma_f32 v147, v57, v128, -v140
    v_fma_f32 v90, -v48, v124, -v81
    v_fma_f32 v91, -v49, v124, -v81
    v_fma_f32 v150, -v56, v128, -v141
    v_fma_f32 v151, -v57, v128, -v141
    v_fma_f32 v88, v50, v124, -v80
    v_fma_f32 v89, v51, v124, -v80
    v_fma_f32 v148, v58, v128, -v140
    v_fma_f32 v149, v59, v128, -v140
    s_lshl_b32 s58, s76, 17
    s_add_u32 s58, s58, s78
    s_add_u32 m0, s74, 8192
    s_add_u32 s76, s76, 1
    s_cmp_eq_u32 s76, 11
    s_cselect_b32 s76, 0, s76
    buffer_load_dwordx4 v172, s[40:43], s58 offen offset:0 lds
    v_fma_f32 v92, -v50, v124, -v81
    v_fma_f32 v93, -v51, v124, -v81
    v_fma_f32 v152, -v58, v128, -v141
    v_fma_f32 v153, -v59, v128, -v141
    v_fma_f32 v94, v52, v126, -v82
    v_fma_f32 v95, v53, v126, -v82
    v_fma_f32 v154, v60, v130, -v142
    v_fma_f32 v155, v61, v130, -v142
    v_fma_f32 v98, -v52, v126, -v83
    v_fma_f32 v99, -v53, v126, -v83
    v_fma_f32 v158, -v60, v130, -v143
    v_fma_f32 v159, -v61, v130, -v143
    v_fma_f32 v96, v54, v126, -v82
    v_fma_f32 v97, v55, v126, -v82
    v_fma_f32 v156, v62, v130, -v142
    v_fma_f32 v157, v63, v130, -v142
    v_fma_f32 v100, -v54, v126, -v83
    v_fma_f32 v101, -v55, v126, -v83
    v_fma_f32 v160, -v62, v130, -v143
    v_fma_f32 v161, -v63, v130, -v143
    buffer_load_dwordx4 v173, s[40:43], s58 offen offset:1024 lds
    v_exp_f32 v86, v86
    v_exp_f32 v146, v146
    v_exp_f32 v87, v87
    v_exp_f32 v147, v147
    v_exp_f32 v88, v88
    v_exp_f32 v148, v148
    v_exp_f32 v89, v89
    v_exp_f32 v149, v149
    v_exp_f32 v90, v90
    v_exp_f32 v150, v150
    buffer_load_dwordx4 v174, s[40:43], s58 offen offset:2048 lds
    v_exp_f32 v91, v91
    v_exp_f32 v151, v151
    v_exp_f32 v92, v92
    v_exp_f32 v152, v152
    v_exp_f32 v93, v93
    v_exp_f32 v153, v153
    v_exp_f32 v94, v94
    v_exp_f32 v154, v154
    v_exp_f32 v95, v95
    v_exp_f32 v155, v155
    buffer_load_dwordx4 v175, s[40:43], s58 offen offset:3072 lds
    v_exp_f32 v96, v96
    v_exp_f32 v156, v156
    v_exp_f32 v97, v97
    v_exp_f32 v157, v157
    v_exp_f32 v98, v98
    v_exp_f32 v158, v158
    v_exp_f32 v99, v99
    v_exp_f32 v159, v159
    v_exp_f32 v100, v100
    v_exp_f32 v160, v160
    s_lshl_b32 s58, s76, 17
    s_add_u32 s58, s58, s78
    s_add_u32 m0, s74, 12288
    s_add_u32 s76, s76, 1
    s_cmp_eq_u32 s76, 11
    s_cselect_b32 s76, 0, s76
    buffer_load_dwordx4 v172, s[40:43], s58 offen offset:0 lds
    v_exp_f32 v101, v101
    v_exp_f32 v161, v161
    v_add_f32 v84, v86, v88
    v_add_f32 v85, v87, v89
    v_add_f32 v144, v146, v148
    v_add_f32 v145, v147, v149
    v_add_f32 v80, v84, v85
    v_add_f32 v140, v144, v145
    v_add_f32 v84, v90, v92
    v_add_f32 v85, v91, v93
    v_add_f32 v144, v150, v152
    v_add_f32 v145, v151, v153
    v_add_f32 v81, v84, v85
    v_add_f32 v141, v144, v145
    buffer_load_dwordx4 v173, s[40:43], s58 offen offset:1024 lds
    v_add_f32 v84, v94, v96
    v_add_f32 v85, v95, v97
    v_add_f32 v144, v154, v156
    v_add_f32 v145, v155, v157
    v_add_f32 v82, v84, v85
    v_add_f32 v142, v144, v145
    v_add_f32 v84, v98, v100
    v_add_f32 v85, v99, v101
    v_add_f32 v144, v158, v160
    v_add_f32 v145, v159, v161
    v_add_f32 v83, v84, v85
    v_add_f32 v143, v144, v145
    v_permlane32_swap_b32 v80, v81
    v_permlane32_swap_b32 v140, v141
    buffer_load_dwordx4 v174, s[40:43], s58 offen offset:2048 lds
    v_permlane32_swap_b32 v82, v83
    v_permlane32_swap_b32 v142, v143
    v_add_f32 v80, v80, v81
    v_add_f32 v140, v140, v141
    v_add_f32 v82, v82, v83
    v_add_f32 v142, v142, v143
    s_nop 0
    v_permlane16_swap_b32 v80, v82
    v_permlane16_swap_b32 v140, v142
    v_add_f32 v80, v80, v82
    v_add_f32 v140, v140, v142
    buffer_load_dwordx4 v175, s[40:43], s58 offen offset:3072 lds
    v_rcp_f32 v80, v80
    v_rcp_f32 v140, v140
    v_mov_b32 v82, v80
    v_mov_b32 v142, v140
    s_nop 0
    v_permlane16_swap_b32 v80, v82
    v_permlane16_swap_b32 v140, v142
    v_mov_b32 v81, v80
    v_mov_b32 v141, v140
    v_mov_b32 v83, v82
    v_mov_b32 v143, v142
    s_add_u32 s58, s79, 0
    s_add_u32 m0, s69, 98304
    s_nop 0
    buffer_load_dwordx4 v28, s[44:47], s58 offen offset:0 lds
    v_permlane32_swap_b32 v80, v81
    v_permlane32_swap_b32 v140, v141
    v_permlane32_swap_b32 v82, v83
    v_permlane32_swap_b32 v142, v143
    v_mul_f32 v86, v86, v80
    v_mul_f32 v87, v87, v80
    v_mul_f32 v146, v146, v140
    v_mul_f32 v147, v147, v140
    v_mul_f32 v88, v88, v80
    v_mul_f32 v89, v89, v80
    v_mul_f32 v148, v148, v140
    v_mul_f32 v149, v149, v140
    v_cvt_pk_bf16_f32 v48, v86, v87
    v_cvt_pk_bf16_f32 v56, v146, v147
    buffer_load_dwordx4 v29, s[44:47], s58 offen offset:1024 lds
    v_cvt_pk_bf16_f32 v49, v88, v89
    v_cvt_pk_bf16_f32 v57, v148, v149
    v_mul_f32 v90, v90, v81
    v_mul_f32 v91, v91, v81
    v_mul_f32 v150, v150, v141
    v_mul_f32 v151, v151, v141
    v_mul_f32 v92, v92, v81
    v_mul_f32 v93, v93, v81
    v_mul_f32 v152, v152, v141
    v_mul_f32 v153, v153, v141
    v_cvt_pk_bf16_f32 v50, v90, v91
    v_cvt_pk_bf16_f32 v58, v150, v151
    v_cvt_pk_bf16_f32 v51, v92, v93
    v_cvt_pk_bf16_f32 v59, v152, v153
    buffer_load_dwordx4 v30, s[44:47], s58 offen offset:2048 lds
    v_mul_f32 v94, v94, v82
    v_mul_f32 v95, v95, v82
    v_mul_f32 v154, v154, v142
    v_mul_f32 v155, v155, v142
    v_mul_f32 v96, v96, v82
    v_mul_f32 v97, v97, v82
    v_mul_f32 v156, v156, v142
    v_mul_f32 v157, v157, v142
    v_cvt_pk_bf16_f32 v52, v94, v95
    v_cvt_pk_bf16_f32 v60, v154, v155
    v_cvt_pk_bf16_f32 v53, v96, v97
    v_cvt_pk_bf16_f32 v61, v156, v157
    v_mul_f32 v98, v98, v83
    v_mul_f32 v99, v99, v83
    v_mul_f32 v158, v158, v143
    v_mul_f32 v159, v159, v143
    buffer_load_dwordx4 v31, s[44:47], s58 offen offset:3072 lds
    v_mul_f32 v100, v100, v83
    v_mul_f32 v101, v101, v83
    v_mul_f32 v160, v160, v143
    v_mul_f32 v161, v161, v143
    v_cvt_pk_bf16_f32 v54, v98, v99
    v_cvt_pk_bf16_f32 v62, v158, v159
    v_cvt_pk_bf16_f32 v55, v100, v101
    v_cvt_pk_bf16_f32 v63, v160, v161
    v_max3_f32 v80, v64, v65, v66
    v_max3_f32 v140, v72, v73, v74
    v_max3_f32 v81, -v64, -v65, -v66
    v_max3_f32 v141, -v72, -v73, -v74
    s_add_u32 s58, s79, 32768
    s_add_u32 m0, s69, 114688
    s_nop 0
    buffer_load_dwordx4 v28, s[44:47], s58 offen offset:0 lds
    v_max_f32 v80, v80, v67
    v_max_f32 v140, v140, v75
    v_max_f32_e64 v81, v81, -v67
    v_max_f32_e64 v141, v141, -v75
    v_max3_f32 v82, v68, v69, v70
    v_max3_f32 v142, v76, v77, v78
    v_max3_f32 v83, -v68, -v69, -v70
    v_max3_f32 v143, -v76, -v77, -v78
    v_max_f32 v82, v82, v71
    v_max_f32 v142, v142, v79
    buffer_load_dwordx4 v29, s[44:47], s58 offen offset:1024 lds
    v_max_f32_e64 v83, v83, -v71
    v_max_f32_e64 v143, v143, -v79
    v_permlane32_swap_b32 v80, v81
    v_permlane32_swap_b32 v140, v141
    v_permlane32_swap_b32 v82, v83
    v_permlane32_swap_b32 v142, v143
    v_max_f32 v80, v80, v81
    v_max_f32 v140, v140, v141
    v_max_f32 v82, v82, v83
    v_max_f32 v142, v142, v143
    buffer_load_dwordx4 v30, s[44:47], s58 offen offset:2048 lds
    v_permlane16_swap_b32 v80, v82
    v_permlane16_swap_b32 v140, v142
    v_max_f32 v80, v80, v82
    v_max_f32 v140, v140, v142
    v_mov_b32 v82, v80
    v_mov_b32 v142, v140
    s_nop 0
    v_permlane16_swap_b32 v80, v82
    v_permlane16_swap_b32 v140, v142
    v_mul_f32 v80, v80, v132
    v_mul_f32 v140, v140, v136
    buffer_load_dwordx4 v31, s[44:47], s58 offen offset:3072 lds
    v_mul_f32 v82, v82, v134
    v_mul_f32 v142, v142, v138
    v_mov_b32 v81, v80
    v_mov_b32 v141, v140
    v_mov_b32 v83, v82
    v_mov_b32 v143, v142
    v_permlane32_swap_b32 v80, v81
    v_permlane32_swap_b32 v140, v141
    v_permlane32_swap_b32 v82, v83
    v_permlane32_swap_b32 v142, v143
    s_add_u32 s58, s79, 65536
    s_add_u32 m0, s69, 131072
    s_nop 0
    buffer_load_dwordx4 v28, s[44:47], s58 offen offset:0 lds
    v_fma_f32 v86, v64, v132, -v80
    v_fma_f32 v87, v65, v132, -v80
    v_fma_f32 v146, v72, v136, -v140
    v_fma_f32 v147, v73, v136, -v140
    v_fma_f32 v90, -v64, v132, -v81
    v_fma_f32 v91, -v65, v132, -v81
    v_fma_f32 v150, -v72, v136, -v141
    v_fma_f32 v151, -v73, v136, -v141
    v_fma_f32 v88, v66, v132, -v80
    v_fma_f32 v89, v67, v132, -v80
    v_fma_f32 v148, v74, v136, -v140
    v_fma_f32 v149, v75, v136, -v140
    v_fma_f32 v92, -v66, v132, -v81
    v_fma_f32 v93, -v67, v132, -v81
    v_fma_f32 v152, -v74, v136, -v141
    v_fma_f32 v153, -v75, v136, -v141
    v_fma_f32 v94, v68, v134, -v82
    v_fma_f32 v95, v69, v134, -v82
    v_fma_f32 v154, v76, v138, -v142
    v_fma_f32 v155, v77, v138, -v142
    buffer_load_dwordx4 v29, s[44:47], s58 offen offset:1024 lds
    v_fma_f32 v98, -v68, v134, -v83
    v_fma_f32 v99, -v69, v134, -v83
    v_fma_f32 v158, -v76, v138, -v143
    v_fma_f32 v159, -v77, v138, -v143
    v_fma_f32 v96, v70, v134, -v82
    v_fma_f32 v97, v71, v134, -v82
    v_fma_f32 v156, v78, v138, -v142
    v_fma_f32 v157, v79, v138, -v142
    v_fma_f32 v100, -v70, v134, -v83
    v_fma_f32 v101, -v71, v134, -v83
    v_fma_f32 v160, -v78, v138, -v143
    v_fma_f32 v161, -v79, v138, -v143
    v_exp_f32 v86, v86
    v_exp_f32 v146, v146
    v_exp_f32 v87, v87
    v_exp_f32 v147, v147
    buffer_load_dwordx4 v30, s[44:47], s58 offen offset:2048 lds
    v_exp_f32 v88, v88
    v_exp_f32 v148, v148
    v_exp_f32 v89, v89
    v_exp_f32 v149, v149
    v_exp_f32 v90, v90
    v_exp_f32 v150, v150
    v_exp_f32 v91, v91
    v_exp_f32 v151, v151
    v_exp_f32 v92, v92
    v_exp_f32 v152, v152
    buffer_load_dwordx4 v31, s[44:47], s58 offen offset:3072 lds
    v_exp_f32 v93, v93
    v_exp_f32 v153, v153
    v_exp_f32 v94, v94
    v_exp_f32 v154, v154
    v_exp_f32 v95, v95
    v_exp_f32 v155, v155
    v_exp_f32 v96, v96
    v_exp_f32 v156, v156
    v_exp_f32 v97, v97
    v_exp_f32 v157, v157
    s_add_u32 s58, s79, 98304
    s_add_u32 m0, s69, 16384
    s_nop 0
    buffer_load_dwordx4 v28, s[44:47], s58 offen offset:0 lds
    v_exp_f32 v98, v98
    v_exp_f32 v158, v158
    v_exp_f32 v99, v99
    v_exp_f32 v159, v159
    v_exp_f32 v100, v100
    v_exp_f32 v160, v160
    v_exp_f32 v101, v101
    v_exp_f32 v161, v161
    v_add_f32 v84, v86, v88
    v_add_f32 v85, v87, v89
    v_add_f32 v144, v146, v148
    v_add_f32 v145, v147, v149
    buffer_load_dwordx4 v29, s[44:47], s58 offen offset:1024 lds
    v_add_f32 v80, v84, v85
    v_add_f32 v140, v144, v145
    v_add_f32 v84, v90, v92
    v_add_f32 v85, v91, v93
    v_add_f32 v144, v150, v152
    v_add_f32 v145, v151, v153
    v_add_f32 v81, v84, v85
    v_add_f32 v141, v144, v145
    v_add_f32 v84, v94, v96
    v_add_f32 v85, v95, v97
    v_add_f32 v144, v154, v156
    v_add_f32 v145, v155, v157
    v_add_f32 v82, v84, v85
    v_add_f32 v142, v144, v145
    buffer_load_dwordx4 v30, s[44:47], s58 offen offset:2048 lds
    v_add_f32 v84, v98, v100
    v_add_f32 v85, v99, v101
    v_add_f32 v144, v158, v160
    v_add_f32 v145, v159, v161
    v_add_f32 v83, v84, v85
    v_add_f32 v143, v144, v145
    v_permlane32_swap_b32 v80, v81
    v_permlane32_swap_b32 v140, v141
    v_permlane32_swap_b32 v82, v83
    v_permlane32_swap_b32 v142, v143
    v_add_f32 v80, v80, v81
    v_add_f32 v140, v140, v141
    buffer_load_dwordx4 v31, s[44:47], s58 offen offset:3072 lds
    v_add_f32 v82, v82, v83
    v_add_f32 v142, v142, v143
    s_nop 0
    v_permlane16_swap_b32 v80, v82
    v_permlane16_swap_b32 v140, v142
    v_add_f32 v80, v80, v82
    v_add_f32 v140, v140, v142
    v_rcp_f32 v80, v80
    v_rcp_f32 v140, v140
    v_mov_b32 v82, v80
    v_mov_b32 v142, v140
    s_nop 0
    v_permlane16_swap_b32 v80, v82
    v_permlane16_swap_b32 v140, v142
    v_mov_b32 v81, v80
    v_mov_b32 v141, v140
    v_mov_b32 v83, v82
    v_mov_b32 v143, v142
    v_permlane32_swap_b32 v80, v81
    v_permlane32_swap_b32 v140, v141
    v_permlane32_swap_b32 v82, v83
    v_permlane32_swap_b32 v142, v143
    v_mul_f32 v86, v86, v80
    v_mul_f32 v87, v87, v80
    v_mul_f32 v146, v146, v140
    v_mul_f32 v147, v147, v140
    v_mul_f32 v88, v88, v80
    v_mul_f32 v89, v89, v80
    v_mul_f32 v148, v148, v140
    v_mul_f32 v149, v149, v140
    v_cvt_pk_bf16_f32 v64, v86, v87
    v_cvt_pk_bf16_f32 v72, v146, v147
    v_cvt_pk_bf16_f32 v65, v88, v89
    v_cvt_pk_bf16_f32 v73, v148, v149
    v_mul_f32 v90, v90, v81
    v_mul_f32 v91, v91, v81
    v_mul_f32 v150, v150, v141
    v_mul_f32 v151, v151, v141
    v_mul_f32 v92, v92, v81
    v_mul_f32 v93, v93, v81
    v_mul_f32 v152, v152, v141
    v_mul_f32 v153, v153, v141
    v_cvt_pk_bf16_f32 v66, v90, v91
    v_cvt_pk_bf16_f32 v74, v150, v151
    v_cvt_pk_bf16_f32 v67, v92, v93
    v_cvt_pk_bf16_f32 v75, v152, v153
    v_mul_f32 v94, v94, v82
    v_mul_f32 v95, v95, v82
    v_mul_f32 v154, v154, v142
    v_mul_f32 v155, v155, v142
    v_mul_f32 v96, v96, v82
    v_mul_f32 v97, v97, v82
    v_mul_f32 v156, v156, v142
    v_mul_f32 v157, v157, v142
    v_cvt_pk_bf16_f32 v68, v94, v95
    v_cvt_pk_bf16_f32 v76, v154, v155
    v_cvt_pk_bf16_f32 v69, v96, v97
    v_cvt_pk_bf16_f32 v77, v156, v157
    v_mul_f32 v98, v98, v83
    v_mul_f32 v99, v99, v83
    v_mul_f32 v158, v158, v143
    v_mul_f32 v159, v159, v143
    v_mul_f32 v100, v100, v83
    v_mul_f32 v101, v101, v83
    v_mul_f32 v160, v160, v143
    v_mul_f32 v161, v161, v143
    v_cvt_pk_bf16_f32 v70, v98, v99
    v_cvt_pk_bf16_f32 v78, v158, v159
    v_cvt_pk_bf16_f32 v71, v100, v101
    v_cvt_pk_bf16_f32 v79, v160, v161
    s_setprio 2
    s_waitcnt vmcnt(16)
    v_mov_b32 v15, 1
    s_mov_b64 exec, 1
    ds_add_u32 v17, v15 offset:60
    s_mov_b64 exec, -1
    s_lshl_b32 s73, s55, 4
    s_add_u32 s73, s73, s54
    s_lshl_b32 s73, s73, 7
    s_add_u32 s73, s73, 7077888
    s_lshl_b32 s52, s81, 14
    s_add_u32 s52, s52, 6291456
    v_lshlrev_b32 v9, 4, v3
    v_lshl_add_u32 v9, v4, 7, v9
    s_lshl_b32 s68, s81, 11
    s_add_u32 s68, s68, 6815744
    s_waitcnt lgkmcnt(0)
    v_readfirstlane_b32 s12, v18
    s_add_u32 s100, s26, s73
    s_addc_u32 s101, s27, 0
    s_mov_b32 s53, 0
    s_nop 1
L_sp31:
    s_load_dwordx16 s[84:99], s[100:101], 0 glc
    s_add_u32 s53, s53, 1
    s_waitcnt lgkmcnt(0)
    s_xor_b32 s13, s84, s12
    s_xor_b32 s3, s85, s12
    s_or_b32 s13, s13, s3
    s_xor_b32 s3, s86, s12
    s_or_b32 s13, s13, s3
    s_xor_b32 s3, s87, s12
    s_or_b32 s13, s13, s3
    s_xor_b32 s3, s88, s12
    s_or_b32 s13, s13, s3
    s_xor_b32 s3, s89, s12
    s_or_b32 s13, s13, s3
    s_xor_b32 s3, s90, s12
    s_or_b32 s13, s13, s3
    s_xor_b32 s3, s91, s12
    s_or_b32 s13, s13, s3
    s_xor_b32 s3, s92, s12
    s_or_b32 s13, s13, s3
    s_xor_b32 s3, s93, s12
    s_or_b32 s13, s13, s3
    s_xor_b32 s3, s94, s12
    s_or_b32 s13, s13, s3
    s_xor_b32 s3, s95, s12
    s_or_b32 s13, s13, s3
    s_xor_b32 s3, s96, s12
    s_or_b32 s13, s13, s3
    s_xor_b32 s3, s97, s12
    s_or_b32 s13, s13, s3
    s_xor_b32 s3, s98, s12
    s_or_b32 s13, s13, s3
    s_xor_b32 s3, s99, s12
    s_or_b32 s13, s13, s3
    s_cmp_gt_u32 s53, 30000
    s_cbranch_scc1 L_sp31x
    s_cmp_lg_u32 s13, 0
    s_cbranch_scc1 L_sp31
L_sp31x:
    buffer_load_dwordx4 v[144:147], v9, s[36:39], s68 offen sc1
    buffer_load_dwordx4 v[148:151], v9, s[36:39], s68 offen offset:64 sc1
    buffer_load_dwordx4 v[80:83], v7, s[36:39], s52 offen offset:0 sc1
    buffer_load_dwordx4 v[84:87], v7, s[36:39], s52 offen offset:1024 sc1
    buffer_load_dwordx4 v[88:91], v7, s[36:39], s52 offen offset:2048 sc1
    buffer_load_dwordx4 v[92:95], v7, s[36:39], s52 offen offset:3072 sc1
    s_add_u32 s52, s52, 4096
    buffer_load_dwordx4 v[96:99], v7, s[36:39], s52 offen offset:0 sc1
    buffer_load_dwordx4 v[100:103], v7, s[36:39], s52 offen offset:1024 sc1
    buffer_load_dwordx4 v[104:107], v7, s[36:39], s52 offen offset:2048 sc1
    buffer_load_dwordx4 v[108:111], v7, s[36:39], s52 offen offset:3072 sc1
    s_add_u32 s52, s52, 4096
    buffer_load_dwordx4 v[112:115], v7, s[36:39], s52 offen offset:0 sc1
    buffer_load_dwordx4 v[116:119], v7, s[36:39], s52 offen offset:1024 sc1
    buffer_load_dwordx4 v[120:123], v7, s[36:39], s52 offen offset:2048 sc1
    buffer_load_dwordx4 v[124:127], v7, s[36:39], s52 offen offset:3072 sc1
    s_add_u32 s52, s52, 4096
    buffer_load_dwordx4 v[128:131], v7, s[36:39], s52 offen offset:0 sc1
    buffer_load_dwordx4 v[132:135], v7, s[36:39], s52 offen offset:1024 sc1
    buffer_load_dwordx4 v[136:139], v7, s[36:39], s52 offen offset:2048 sc1
    buffer_load_dwordx4 v[140:143], v7, s[36:39], s52 offen offset:3072 sc1
    v_mov_b32 v15, 1
    s_mov_b64 exec, 1
    ds_add_u32 v17, v15 offset:56
    s_mov_b64 exec, -1
    v_mov_b32 v10, 0x00003f80
    v_mov_b32 v11, 0x3f800000
    v_mov_b32 v152, 0
    v_mov_b32 v153, 0
    v_mov_b32 v154, 0
    v_mov_b32 v155, 0
    v_mov_b32 v156, 0
    v_mov_b32 v157, 0
    v_mov_b32 v158, 0
    v_mov_b32 v159, 0
    s_lshl_b32 s52, s54, 17
    s_lshl_b32 s3, s81, 9
    s_add_u32 s52, s52, s3
    s_add_u32 s52, s52, 4194304
    v_lshrrev_b32 v12, 5, v1
    v_and_b32 v13, 511, v7
    v_lshl_add_u32 v12, v12, 14, v13
    s_waitcnt vmcnt(16)
    v_add_f32_dpp v144, v144, v144 row_ror:8 row_mask:0xf bank_mask:0xf
    v_add_f32_dpp v145, v145, v145 row_ror:8 row_mask:0xf bank_mask:0xf
    v_add_f32_dpp v146, v146, v146 row_ror:8 row_mask:0xf bank_mask:0xf
    v_add_f32_dpp v147, v147, v147 row_ror:8 row_mask:0xf bank_mask:0xf
    v_add_f32_dpp v148, v148, v148 row_ror:8 row_mask:0xf bank_mask:0xf
    v_add_f32_dpp v149, v149, v149 row_ror:8 row_mask:0xf bank_mask:0xf
    v_add_f32_dpp v150, v150, v150 row_ror:8 row_mask:0xf bank_mask:0xf
    v_add_f32_dpp v151, v151, v151 row_ror:8 row_mask:0xf bank_mask:0xf
    v_add_f32_dpp v144, v144, v144 row_ror:4 row_mask:0xf bank_mask:0xf
    v_add_f32_dpp v145, v145, v145 row_ror:4 row_mask:0xf bank_mask:0xf
    v_add_f32_dpp v146, v146, v146 row_ror:4 row_mask:0xf bank_mask:0xf
    v_add_f32_dpp v147, v147, v147 row_ror:4 row_mask:0xf bank_mask:0xf
    v_add_f32_dpp v148, v148, v148 row_ror:4 row_mask:0xf bank_mask:0xf
    v_add_f32_dpp v149, v149, v149 row_ror:4 row_mask:0xf bank_mask:0xf
    v_add_f32_dpp v150, v150, v150 row_ror:4 row_mask:0xf bank_mask:0xf
    v_add_f32_dpp v151, v151, v151 row_ror:4 row_mask:0xf bank_mask:0xf
    v_add_f32_dpp v144, v144, v144 row_ror:2 row_mask:0xf bank_mask:0xf
    v_add_f32_dpp v145, v145, v145 row_ror:2 row_mask:0xf bank_mask:0xf
    v_add_f32_dpp v146, v146, v146 row_ror:2 row_mask:0xf bank_mask:0xf
    v_add_f32_dpp v147, v147, v147 row_ror:2 row_mask:0xf bank_mask:0xf
    v_add_f32_dpp v148, v148, v148 row_ror:2 row_mask:0xf bank_mask:0xf
    v_add_f32_dpp v149, v149, v149 row_ror:2 row_mask:0xf bank_mask:0xf
    v_add_f32_dpp v150, v150, v150 row_ror:2 row_mask:0xf bank_mask:0xf
    v_add_f32_dpp v151, v151, v151 row_ror:2 row_mask:0xf bank_mask:0xf
    v_add_f32_dpp v144, v144, v144 row_ror:1 row_mask:0xf bank_mask:0xf
    v_add_f32_dpp v145, v145, v145 row_ror:1 row_mask:0xf bank_mask:0xf
    v_add_f32_dpp v146, v146, v146 row_ror:1 row_mask:0xf bank_mask:0xf
    v_add_f32_dpp v147, v147, v147 row_ror:1 row_mask:0xf bank_mask:0xf
    v_add_f32_dpp v148, v148, v148 row_ror:1 row_mask:0xf bank_mask:0xf
    v_add_f32_dpp v149, v149, v149 row_ror:1 row_mask:0xf bank_mask:0xf
    v_add_f32_dpp v150, v150, v150 row_ror:1 row_mask:0xf bank_mask:0xf
    v_add_f32_dpp v151, v151, v151 row_ror:1 row_mask:0xf bank_mask:0xf
    v_cvt_pk_bf16_f32 v160, v144, v145
    v_cvt_pk_bf16_f32 v161, v146, v147
    v_cvt_pk_bf16_f32 v162, v148, v149
    v_cvt_pk_bf16_f32 v163, v150, v151
    s_waitcnt vmcnt(15)
    v_dot2c_f32_bf16 v152, v80, v10
    v_dot2c_f32_bf16 v153, v80, v11
    v_dot2c_f32_bf16 v154, v81, v10
    v_dot2c_f32_bf16 v155, v81, v11
    v_dot2c_f32_bf16 v156, v82, v10
    v_dot2c_f32_bf16 v157, v82, v11
    v_dot2c_f32_bf16 v158, v83, v10
    v_dot2c_f32_bf16 v159, v83, v11
    s_waitcnt vmcnt(14)
    v_dot2c_f32_bf16 v152, v84, v10
    v_dot2c_f32_bf16 v153, v84, v11
    v_dot2c_f32_bf16 v154, v85, v10
    v_dot2c_f32_bf16 v155, v85, v11
    v_dot2c_f32_bf16 v156, v86, v10
    v_dot2c_f32_bf16 v157, v86, v11
    v_dot2c_f32_bf16 v158, v87, v10
    v_dot2c_f32_bf16 v159, v87, v11
    s_waitcnt vmcnt(13)
    v_dot2c_f32_bf16 v152, v88, v10
    v_dot2c_f32_bf16 v153, v88, v11
    v_dot2c_f32_bf16 v154, v89, v10
    v_dot2c_f32_bf16 v155, v89, v11
    v_dot2c_f32_bf16 v156, v90, v10
    v_dot2c_f32_bf16 v157, v90, v11
    v_dot2c_f32_bf16 v158, v91, v10
    v_dot2c_f32_bf16 v159, v91, v11
    s_waitcnt vmcnt(12)
    v_dot2c_f32_bf16 v152, v92, v10
    v_dot2c_f32_bf16 v153, v92, v11
    v_dot2c_f32_bf16 v154, v93, v10
    v_dot2c_f32_bf16 v155, v93, v11
    v_dot2c_f32_bf16 v156, v94, v10
    v_dot2c_f32_bf16 v157, v94, v11
    v_dot2c_f32_bf16 v158, v95, v10
    v_dot2c_f32_bf16 v159, v95, v11
    s_waitcnt vmcnt(11)
    v_dot2c_f32_bf16 v152, v96, v10
    v_dot2c_f32_bf16 v153, v96, v11
    v_dot2c_f32_bf16 v154, v97, v10
    v_dot2c_f32_bf16 v155, v97, v11
    v_dot2c_f32_bf16 v156, v98, v10
    v_dot2c_f32_bf16 v157, v98, v11
    v_dot2c_f32_bf16 v158, v99, v10
    v_dot2c_f32_bf16 v159, v99, v11
    s_waitcnt vmcnt(10)
    v_dot2c_f32_bf16 v152, v100, v10
    v_dot2c_f32_bf16 v153, v100, v11
    v_dot2c_f32_bf16 v154, v101, v10
    v_dot2c_f32_bf16 v155, v101, v11
    v_dot2c_f32_bf16 v156, v102, v10
    v_dot2c_f32_bf16 v157, v102, v11
    v_dot2c_f32_bf16 v158, v103, v10
    v_dot2c_f32_bf16 v159, v103, v11
    s_waitcnt vmcnt(9)
    v_dot2c_f32_bf16 v152, v104, v10
    v_dot2c_f32_bf16 v153, v104, v11
    v_dot2c_f32_bf16 v154, v105, v10
    v_dot2c_f32_bf16 v155, v105, v11
    v_dot2c_f32_bf16 v156, v106, v10
    v_dot2c_f32_bf16 v157, v106, v11
    v_dot2c_f32_bf16 v158, v107, v10
    v_dot2c_f32_bf16 v159, v107, v11
    s_waitcnt vmcnt(8)
    v_dot2c_f32_bf16 v152, v108, v10
    v_dot2c_f32_bf16 v153, v108, v11
    v_dot2c_f32_bf16 v154, v109, v10
    v_dot2c_f32_bf16 v155, v109, v11
    v_dot2c_f32_bf16 v156, v110, v10
    v_dot2c_f32_bf16 v157, v110, v11
    v_dot2c_f32_bf16 v158, v111, v10
    v_dot2c_f32_bf16 v159, v111, v11
    s_waitcnt vmcnt(7)
    v_dot2c_f32_bf16 v152, v112, v10
    v_dot2c_f32_bf16 v153, v112, v11
    v_dot2c_f32_bf16 v154, v113, v10
    v_dot2c_f32_bf16 v155, v113, v11
    v_dot2c_f32_bf16 v156, v114, v10
    v_dot2c_f32_bf16 v157, v114, v11
    v_dot2c_f32_bf16 v158, v115, v10
    v_dot2c_f32_bf16 v159, v115, v11
    s_waitcnt vmcnt(6)
    v_dot2c_f32_bf16 v152, v116, v10
    v_dot2c_f32_bf16 v153, v116, v11
    v_dot2c_f32_bf16 v154, v117, v10
    v_dot2c_f32_bf16 v155, v117, v11
    v_dot2c_f32_bf16 v156, v118, v10
    v_dot2c_f32_bf16 v157, v118, v11
    v_dot2c_f32_bf16 v158, v119, v10
    v_dot2c_f32_bf16 v159, v119, v11
    s_waitcnt vmcnt(5)
    v_dot2c_f32_bf16 v152, v120, v10
    v_dot2c_f32_bf16 v153, v120, v11
    v_dot2c_f32_bf16 v154, v121, v10
    v_dot2c_f32_bf16 v155, v121, v11
    v_dot2c_f32_bf16 v156, v122, v10
    v_dot2c_f32_bf16 v157, v122, v11
    v_dot2c_f32_bf16 v158, v123, v10
    v_dot2c_f32_bf16 v159, v123, v11
    s_waitcnt vmcnt(4)
    v_dot2c_f32_bf16 v152, v124, v10
    v_dot2c_f32_bf16 v153, v124, v11
    v_dot2c_f32_bf16 v154, v125, v10
    v_dot2c_f32_bf16 v155, v125, v11
    v_dot2c_f32_bf16 v156, v126, v10
    v_dot2c_f32_bf16 v157, v126, v11
    v_dot2c_f32_bf16 v158, v127, v10
    v_dot2c_f32_bf16 v159, v127, v11
    s_waitcnt vmcnt(3)
    v_dot2c_f32_bf16 v152, v128, v10
    v_dot2c_f32_bf16 v153, v128, v11
    v_dot2c_f32_bf16 v154, v129, v10
    v_dot2c_f32_bf16 v155, v129, v11
    v_dot2c_f32_bf16 v156, v130, v10
    v_dot2c_f32_bf16 v157, v130, v11
    v_dot2c_f32_bf16 v158, v131, v10
    v_dot2c_f32_bf16 v159, v131, v11
    s_waitcnt vmcnt(2)
    v_dot2c_f32_bf16 v152, v132, v10
    v_dot2c_f32_bf16 v153, v132, v11
    v_dot2c_f32_bf16 v154, v133, v10
    v_dot2c_f32_bf16 v155, v133, v11
    v_dot2c_f32_bf16 v156, v134, v10
    v_dot2c_f32_bf16 v157, v134, v11
    v_dot2c_f32_bf16 v158, v135, v10
    v_dot2c_f32_bf16 v159, v135, v11
    s_waitcnt vmcnt(1)
    v_dot2c_f32_bf16 v152, v136, v10
    v_dot2c_f32_bf16 v153, v136, v11
    v_dot2c_f32_bf16 v154, v137, v10
    v_dot2c_f32_bf16 v155, v137, v11
    v_dot2c_f32_bf16 v156, v138, v10
    v_dot2c_f32_bf16 v157, v138, v11
    v_dot2c_f32_bf16 v158, v139, v10
    v_dot2c_f32_bf16 v159, v139, v11
    s_waitcnt vmcnt(0)
    v_dot2c_f32_bf16 v152, v140, v10
    v_dot2c_f32_bf16 v153, v140, v11
    v_dot2c_f32_bf16 v154, v141, v10
    v_dot2c_f32_bf16 v155, v141, v11
    v_dot2c_f32_bf16 v156, v142, v10
    v_dot2c_f32_bf16 v157, v142, v11
    v_dot2c_f32_bf16 v158, v143, v10
    v_dot2c_f32_bf16 v159, v143, v11
    v_cvt_pk_bf16_f32 v164, v152, v153
    v_cvt_pk_bf16_f32 v165, v154, v155
    v_cvt_pk_bf16_f32 v166, v156, v157
    v_cvt_pk_bf16_f32 v167, v158, v159
    v_mfma_f32_16x16x32_bf16 v[112:115], v[160:163], v[48:51], 0
    v_mfma_f32_16x16x32_bf16 v[116:119], v[160:163], v[52:55], 0
    v_mfma_f32_16x16x32_bf16 v[120:123], v[160:163], v[56:59], 0
    v_mfma_f32_16x16x32_bf16 v[124:127], v[160:163], v[60:63], 0
    v_mfma_f32_16x16x32_bf16 v[128:131], v[160:163], v[64:67], 0
    v_mfma_f32_16x16x32_bf16 v[132:135], v[160:163], v[68:71], 0
    v_mfma_f32_16x16x32_bf16 v[136:139], v[160:163], v[72:75], 0
    v_mfma_f32_16x16x32_bf16 v[140:143], v[160:163], v[76:79], 0
    v_mfma_f32_16x16x32_bf16 v[80:83], v[164:167], v[48:51], 0
    v_add_f32 v112, 0x358637bd, v112
    v_rcp_f32 v112, v112
    v_mfma_f32_16x16x32_bf16 v[84:87], v[164:167], v[52:55], 0
    v_add_f32 v116, 0x358637bd, v116
    v_rcp_f32 v116, v116
    v_mfma_f32_16x16x32_bf16 v[88:91], v[164:167], v[56:59], 0
    v_add_f32 v120, 0x358637bd, v120
    v_rcp_f32 v120, v120
    v_mfma_f32_16x16x32_bf16 v[92:95], v[164:167], v[60:63], 0
    v_add_f32 v124, 0x358637bd, v124
    v_rcp_f32 v124, v124
    v_mfma_f32_16x16x32_bf16 v[96:99], v[164:167], v[64:67], 0
    v_add_f32 v128, 0x358637bd, v128
    v_rcp_f32 v128, v128
    v_mfma_f32_16x16x32_bf16 v[100:103], v[164:167], v[68:71], 0
    v_add_f32 v132, 0x358637bd, v132
    v_rcp_f32 v132, v132
    v_mfma_f32_16x16x32_bf16 v[104:107], v[164:167], v[72:75], 0
    v_add_f32 v136, 0x358637bd, v136
    v_rcp_f32 v136, v136
    v_mfma_f32_16x16x32_bf16 v[108:111], v[164:167], v[76:79], 0
    v_add_f32 v140, 0x358637bd, v140
    v_rcp_f32 v140, v140
    v_mul_f32 v80, v80, v112
    v_mul_f32 v81, v81, v112
    v_mul_f32 v82, v82, v112
    v_mul_f32 v83, v83, v112
    v_cvt_pk_bf16_f32 v144, v80, v81
    v_cvt_pk_bf16_f32 v145, v82, v83
    v_mul_f32 v84, v84, v116
    v_mul_f32 v85, v85, v116
    v_mul_f32 v86, v86, v116
    v_mul_f32 v87, v87, v116
    v_cvt_pk_bf16_f32 v146, v84, v85
    v_cvt_pk_bf16_f32 v147, v86, v87
    s_add_u32 s3, s52, 0
    v_permlane32_swap_b32 v144, v146
    v_permlane32_swap_b32 v145, v147
    buffer_store_dwordx4 v[144:147], v12, s[36:39], s3 offen sc0 sc1
    v_mul_f32 v88, v88, v120
    v_mul_f32 v89, v89, v120
    v_mul_f32 v90, v90, v120
    v_mul_f32 v91, v91, v120
    v_cvt_pk_bf16_f32 v148, v88, v89
    v_cvt_pk_bf16_f32 v149, v90, v91
    v_mul_f32 v92, v92, v124
    v_mul_f32 v93, v93, v124
    v_mul_f32 v94, v94, v124
    v_mul_f32 v95, v95, v124
    v_cvt_pk_bf16_f32 v150, v92, v93
    v_cvt_pk_bf16_f32 v151, v94, v95
    s_add_u32 s3, s52, 32768
    v_permlane32_swap_b32 v148, v150
    v_permlane32_swap_b32 v149, v151
    buffer_store_dwordx4 v[148:151], v12, s[36:39], s3 offen sc0 sc1
    v_mul_f32 v96, v96, v128
    v_mul_f32 v97, v97, v128
    v_mul_f32 v98, v98, v128
    v_mul_f32 v99, v99, v128
    v_cvt_pk_bf16_f32 v152, v96, v97
    v_cvt_pk_bf16_f32 v153, v98, v99
    v_mul_f32 v100, v100, v132
    v_mul_f32 v101, v101, v132
    v_mul_f32 v102, v102, v132
    v_mul_f32 v103, v103, v132
    v_cvt_pk_bf16_f32 v154, v100, v101
    v_cvt_pk_bf16_f32 v155, v102, v103
    s_add_u32 s3, s52, 65536
    v_permlane32_swap_b32 v152, v154
    v_permlane32_swap_b32 v153, v155
    buffer_store_dwordx4 v[152:155], v12, s[36:39], s3 offen sc0 sc1
    v_mul_f32 v104, v104, v136
    v_mul_f32 v105, v105, v136
    v_mul_f32 v106, v106, v136
    v_mul_f32 v107, v107, v136
    v_cvt_pk_bf16_f32 v156, v104, v105
    v_cvt_pk_bf16_f32 v157, v106, v107
    v_mul_f32 v108, v108, v140
    v_mul_f32 v109, v109, v140
    v_mul_f32 v110, v110, v140
    v_mul_f32 v111, v111, v140
    v_cvt_pk_bf16_f32 v158, v108, v109
    v_cvt_pk_bf16_f32 v159, v110, v111
    s_add_u32 s3, s52, 98304
    v_permlane32_swap_b32 v156, v158
    v_permlane32_swap_b32 v157, v159
    buffer_store_dwordx4 v[156:159], v12, s[36:39], s3 offen sc0 sc1
    s_lshl_b32 s70, s54, 9
    s_add_u32 s70, s70, s55
    s_lshl_b32 s70, s70, 2
    s_add_u32 s70, s70, 7143424
    s_lshl_b32 s83, s49, 12
    s_add_u32 s83, s83, 114688
    v_add_u32 v252, s83, v7
    v_mov_b32 v43, 0xbfb8aa3b
    v_lshl_add_u32 v10, v3, 2, v5
    v_bfe_u32 v11, v10, 1, 2
    v_and_b32 v9, 8, v10
    v_add_u32 v10, v10, v9
    v_lshlrev_b32 v10, 7, v10
    v_lshlrev_b32 v11, 1, v11
    v_xor_b32 v11, v11, v6
    v_lshl_add_u32 v10, v11, 4, v10
    v_add_u32 v40, s83, v10
    v_xor_b32 v41, 64, v40
    s_mov_b32 s40, s20
    s_mov_b32 s41, s21
    s_mov_b32 s42, 4096
    s_mov_b32 s43, 0x20000
    v_lshl_add_u32 v39, v2, 4, v4
    v_lshlrev_b32 v38, 1, v39
    v_lshlrev_b32 v39, 10, v39
    v_lshl_add_u32 v39, v3, 4, v39
    s_lshl_b32 s67, s64, 16
    s_lshl_b32 s3, s65, 7
    s_add_u32 s67, s67, s3
    v_subrev_u32 v13, 16384, v40
    v_subrev_u32 v14, 16384, v41
    ds_read_b64_tr_b16 v[176:177], v13 offset:0
    ds_read_b64_tr_b16 v[178:179], v13 offset:1024
    ds_read_b64_tr_b16 v[180:181], v13 offset:8
    ds_read_b64_tr_b16 v[182:183], v13 offset:1032
    ds_read_b64_tr_b16 v[184:185], v14 offset:0
    ds_read_b64_tr_b16 v[186:187], v14 offset:1024
    ds_read_b64_tr_b16 v[188:189], v14 offset:8
    ds_read_b64_tr_b16 v[190:191], v14 offset:1032
    ds_read_b64_tr_b16 v[192:193], v13 offset:16384
    ds_read_b64_tr_b16 v[194:195], v13 offset:17408
    ds_read_b64_tr_b16 v[196:197], v13 offset:16392
    ds_read_b64_tr_b16 v[198:199], v13 offset:17416
    ds_read_b64_tr_b16 v[200:201], v14 offset:16384
    ds_read_b64_tr_b16 v[202:203], v14 offset:17408
    ds_read_b64_tr_b16 v[204:205], v14 offset:16392
    s_waitcnt lgkmcnt(14)
    ds_read_b64_tr_b16 v[206:207], v14 offset:17416
    s_waitcnt lgkmcnt(14)
    ds_read_b64_tr_b16 v[208:209], v13 offset:32768
    s_waitcnt lgkmcnt(14)
    ds_read_b64_tr_b16 v[210:211], v13 offset:33792
    s_waitcnt lgkmcnt(14)
    ds_read_b64_tr_b16 v[212:213], v13 offset:32776
    s_waitcnt lgkmcnt(14)
    ds_read_b64_tr_b16 v[214:215], v13 offset:33800
    s_waitcnt lgkmcnt(14)
    ds_read_b64_tr_b16 v[216:217], v14 offset:32768
    s_waitcnt lgkmcnt(14)
    ds_read_b64_tr_b16 v[218:219], v14 offset:33792
    s_waitcnt lgkmcnt(14)
    ds_read_b64_tr_b16 v[220:221], v14 offset:32776
    s_waitcnt lgkmcnt(14)
    ds_read_b64_tr_b16 v[222:223], v14 offset:33800
    v_subrev_u32 v13, 98304, v40
    v_subrev_u32 v14, 98304, v41
    s_waitcnt lgkmcnt(14)
    ds_read_b64_tr_b16 v[224:225], v13 offset:0
    s_waitcnt lgkmcnt(14)
    ds_read_b64_tr_b16 v[226:227], v13 offset:1024
    s_waitcnt lgkmcnt(14)
    ds_read_b64_tr_b16 v[228:229], v13 offset:8
    s_waitcnt lgkmcnt(14)
    ds_read_b64_tr_b16 v[230:231], v13 offset:1032
    s_waitcnt lgkmcnt(14)
    ds_read_b64_tr_b16 v[232:233], v14 offset:0
    s_waitcnt lgkmcnt(14)
    ds_read_b64_tr_b16 v[234:235], v14 offset:1024
    s_waitcnt lgkmcnt(14)
    ds_read_b64_tr_b16 v[236:237], v14 offset:8
    s_waitcnt lgkmcnt(14)
    ds_read_b64_tr_b16 v[238:239], v14 offset:1032
    v_mov_b32 v15, 1
    s_mov_b64 exec, 1
    ds_add_u32 v17, v15 offset:40
    s_mov_b64 exec, -1
    v_and_b32 v22, 7, v1
    v_lshlrev_b32 v22, 3, v22
    s_lshl_b32 s73, s64, 3
    s_add_u32 s73, s73, s65
    s_lshl_b32 s73, s73, 7
    s_add_u32 s73, s73, 7143424
    v_lshl_add_u32 v8, v2, 14, v7
    v_xor_b32 v24, 0, v8
    v_xor_b32 v25, 16384, v8
    v_xor_b32 v26, 32768, v8
    v_xor_b32 v27, 49152, v8
    s_lshl_b32 s57, s64, 16
    s_lshl_b32 s3, s49, 12
    s_add_u32 s57, s57, s3
    s_add_u32 s57, s57, 4194304
    s_waitcnt vmcnt(0)
    v_mov_b32 v15, 1
    s_mov_b64 exec, 1
    ds_add_u32 v17, v15 offset:12
    s_mov_b64 exec, -1
    s_cmp_lg_u32 s49, 0
    s_cbranch_scc1 L_pb32
    s_mov_b32 s53, 0
L_cw33:
    s_sleep 1
    ds_read_b32 v15, v17 offset:12
    s_waitcnt lgkmcnt(0)
    v_readfirstlane_b32 s3, v15
    s_add_u32 s53, s53, 1
    s_cmp_gt_u32 s53, 1000000
    s_nop 2
    s_cbranch_scc1 L_cw33x
    s_cmp_lt_u32 s3, 4
    s_cbranch_scc1 L_cw33
L_cw33x:
    v_lshlrev_b32 v14, 7, v1
    s_mov_b64 exec, 0xffff
    buffer_store_dword v18, v14, s[36:39], s70 offen sc0 sc1
    s_mov_b64 exec, -1
L_pb32:
    s_waitcnt lgkmcnt(0)
    buffer_load_dwordx4 v[240:243], v39, s[28:31], s67 offen
    buffer_load_dwordx4 v[244:247], v39, s[28:31], s67 offen offset:64
    s_lshl_b32 s3, s64, 7
    buffer_load_ushort v38, v38, s[40:43], s3 offen
    s_branch L_X
L_done:
    s_endpgm
.section .rodata,"a"
.p2align 6
.amdhsa_kernel recurrent_scan__linear_kernel_hedgehog__mixer_token_mlp__prompt_kernel
  .amdhsa_next_free_vgpr 256
  .amdhsa_next_free_sgpr 102
  .amdhsa_accum_offset 256
  .amdhsa_group_segment_fixed_size 0
  .amdhsa_kernarg_size 96
  .amdhsa_user_sgpr_count 2
  .amdhsa_user_sgpr_kernarg_segment_ptr 1
  .amdhsa_system_sgpr_workgroup_id_x 1
.end_amdhsa_kernel
```
